```python
import torch

def _softmax(x, axis=-1):
    return torch.softmax(x, dim=axis)
def _gelu(x):
    return torch.nn.functional.gelu(x, approximate="tanh")
def _silu(x):
    return torch.nn.functional.silu(x)
def _sigmoid(x):
    return torch.sigmoid(x)
def _layernorm(x, axis=-1, eps=1e-5):
    m = x.mean(dim=axis, keepdim=True)
    v = x.var(dim=axis, keepdim=True, unbiased=False)
    return (x - m) / torch.sqrt(v + eps)
def _scatter_add(tgt, idx, src, axis=0):
    return tgt.clone().index_add_(axis, idx, src)
def _segment_sum(src, seg, n):
    out = torch.zeros((n,) + src.shape[1:], dtype=src.dtype)
    return out.index_add_(0, seg, src)
def _pad(x, pw):
    flat = tuple(v for pair in reversed(pw) for v in pair)
    return torch.nn.functional.pad(x, flat)

kernel_name = 'sequential_preLN__linear_attn_block__glu_gated_glu__prompt'

def setup_inputs():

    _w = (lambda a: (lambda t: t.to(torch.bfloat16) if t.is_floating_point() else t)(torch.as_tensor(a)))
    def _A_setup():
        B, S, D = 1, 2048, 576
        return {
            "x": _w((lambda *s: torch.randn(*s, dtype=torch.bfloat16) * 0.05)(B, S, D)),
            "wqkv": _w((lambda *s: torch.randn(*s, dtype=torch.bfloat16) * 0.05)(D, 3 * D)),
            "wo": _w((lambda *s: torch.randn(*s, dtype=torch.bfloat16) * 0.05)(D, D)),
        }
    _A_in = _A_setup()

    def _B_setup():
        B, S, D, F = 1, 2048, 576, 4608
        return {
            "x": _w((lambda *s: torch.randn(*s, dtype=torch.bfloat16) * 0.05)(B, S, D)),
            "w_gate": _w((lambda *s: torch.randn(*s, dtype=torch.bfloat16) * 0.05)(D, F)),
            "w_up": _w((lambda *s: torch.randn(*s, dtype=torch.bfloat16) * 0.05)(D, F)),
            "w_down": _w((lambda *s: torch.randn(*s, dtype=torch.bfloat16) * 0.05)(F, D)),
        }
    _B_in = _B_setup()

    return {
        "A_x": _A_in["x"],
        "A_wqkv": _A_in["wqkv"],
        "A_wo": _A_in["wo"],
        "B_x": _B_in["x"],
        "B_w_gate": _B_in["w_gate"],
        "B_w_up": _B_in["w_up"],
        "B_w_down": _B_in["w_down"],
    }

def reference(A_x, A_wqkv, A_wo, B_x, B_w_gate, B_w_up, B_w_down):
    def _A_ref(x, wqkv, wo):
        B, S, D = x.shape
        H = 32; Dh = D // H
        qkv = (lambda x, *d: x.permute(*d))((x @ wqkv).reshape(B, S, 3, H, Dh), 2, 0, 3, 1, 4)
        q, k, v = qkv[0], qkv[1], qkv[2]
        phi = lambda t: torch.where(t > 0, t + 1, torch.exp(t)) + 1e-6
        pq, pk = phi(q), phi(k)
        kv = torch.einsum("bhsd,bhse->bhde", pk, v)
        z = torch.einsum("bhsd->bhd", pk)
        num = torch.einsum("bhqd,bhde->bhqe", pq, kv)
        den = torch.einsum("bhqd,bhd->bhq", pq, z)[..., None] + 1e-6
        o = num / den
        return (lambda x, *d: x.permute(*d))(o, 0, 2, 1, 3).reshape(B, S, D) @ wo

    def _B_ref(x, w_gate, w_up, w_down):
        g = torch.einsum("bsd,df->bsf", x, w_gate)
        u = torch.einsum("bsd,df->bsf", x, w_up)
        h = _sigmoid(g) * u
        return torch.einsum("bsf,fd->bsd", h, w_down)

    x = A_x
    h = x + _A_ref(_layernorm(x, axis=-1), A_wqkv, A_wo)
    h2 = h + _B_ref(_layernorm(h, axis=-1), B_w_gate, B_w_up, B_w_down)
    return h2
```

```asm
; @launch kernel=k1_kernel grid=(256,1,1) block=(512,1,1) lds=161792
; @launch kernel=k2_kernel grid=(256,1,1) block=(256,1,1) lds=155648
; @launch kernel=k3_kernel grid=(256,1,1) block=(768,1,1) lds=152576
; @launch kernel=k4_kernel grid=(256,1,1) block=(768,1,1) lds=143616
.amdgcn_target "amdgcn-amd-amdhsa--gfx950"
.text
.globl k1_kernel
.p2align 8
.type k1_kernel,@function
k1_kernel:
  s_cmp_ge_u32 s2, 256
  s_cbranch_scc1 k1_end
  s_load_dwordx4 s[4:7], s[0:1], 0
  s_load_dwordx4 s[8:11], s[0:1], 64
  s_load_dwordx2 s[48:49], s[0:1], 16
  s_load_dwordx4 s[52:55], s[0:1], 32
  v_lshrrev_b32 v1, 6, v0
  v_mov_b32 v111, v0
  v_readfirstlane_b32 s3, v1
  v_and_b32 v0, 63, v0
  s_and_b32 s12, s2, 3
  s_lshl_b32 s12, s12, 2
  s_lshr_b32 s14, s2, 3
  s_and_b32 s15, s14, 3
  s_add_u32 s12, s12, s15
  s_bfe_u32 s13, s2, 0x10002
  s_lshl_b32 s13, s13, 3
  s_lshr_b32 s14, s14, 2
  s_add_u32 s13, s13, s14
  s_and_b32 s14, s3, 3
  s_lshr_b32 s15, s3, 2
  s_lshl_b32 s35, s13, 7
  s_lshl_b32 s36, s3, 3
  s_add_u32 s35, s35, s36
  v_lshrrev_b32 v17, 3, v0
  v_add_u32 v17, s35, v17
  v_mul_u32_u24 v17, 1152, v17
  s_and_b32 s36, s3, 1
  s_lshl_b32 s36, s36, 2
  v_lshrrev_b32 v18, 4, v0
  v_or_b32 v18, s36, v18
  v_and_b32 v19, 7, v0
  v_xor_b32 v18, v18, v19
  v_lshl_add_u32 v1, v18, 4, v17
  s_mul_i32 s37, s12, 72
  s_and_b32 s33, s37, 8
  s_andn2_b32 s37, s37, 15
  s_lshl_b32 s38, s3, 6
  v_add_u32 v17, s38, v0
  v_mul_u32_u24 v18, 4370, v17
  v_lshrrev_b32 v18, 16, v18
  v_mul_u32_u24 v19, 15, v18
  v_sub_u32 v19, v17, v19
  v_mul_u32_u24 v20, 13, v19
  v_lshrrev_b32 v20, 6, v20
  v_mul_u32_u24 v21, 5, v20
  v_sub_u32 v21, v19, v21
  v_add_u32 v20, 1, v20
  v_cmp_eq_u32 vcc, 3, v20
  s_nop 1
  v_cndmask_b32_e64 v20, v20, 0, vcc
  v_mul_u32_u24 v20, 1152, v20
  v_lshl_add_u32 v20, v21, 4, v20
  v_and_b32 v21, 0x38, v18
  v_and_b32 v22, 1, v18
  v_lshl_or_b32 v21, v22, 2, v21
  v_bfe_u32 v22, v18, 1, 2
  v_or_b32 v21, v21, v22
  v_mul_u32_u24 v21, 3456, v21
  v_add3_u32 v2, v21, v20, s37
  v_add_u32 v17, s38, v0
  v_add_u32 v17, 512, v17
  v_mul_u32_u24 v18, 4370, v17
  v_lshrrev_b32 v18, 16, v18
  v_mul_u32_u24 v19, 15, v18
  v_sub_u32 v19, v17, v19
  v_mul_u32_u24 v20, 13, v19
  v_lshrrev_b32 v20, 6, v20
  v_mul_u32_u24 v21, 5, v20
  v_sub_u32 v21, v19, v21
  v_add_u32 v20, 1, v20
  v_cmp_eq_u32 vcc, 3, v20
  s_nop 1
  v_cndmask_b32_e64 v20, v20, 0, vcc
  v_mul_u32_u24 v20, 1152, v20
  v_lshl_add_u32 v20, v21, 4, v20
  v_and_b32 v21, 0x38, v18
  v_and_b32 v22, 1, v18
  v_lshl_or_b32 v21, v22, 2, v21
  v_bfe_u32 v22, v18, 1, 2
  v_or_b32 v21, v21, v22
  v_mul_u32_u24 v21, 3456, v21
  v_add3_u32 v3, v21, v20, s37
  s_lshl_b32 s32, s3, 10
  s_lshr_b32 s62, s2, 5
  s_mul_i32 s62, s62, 1
  s_bfe_u32 s63, s2, 0x20003
  s_mul_i32 s63, s63, 4
  s_add_u32 s62, s62, s63
  s_mul_i32 s63, s62, 57
  s_lshr_b32 s63, s63, 9
  s_mul_i32 s63, s63, 9
  s_sub_u32 s62, s62, s63
  s_waitcnt lgkmcnt(0)
  s_mov_b32 s16, s4
  s_mov_b32 s17, s5
  s_mov_b32 s18, 0x240000
  s_mov_b32 s19, 0x00020000
  s_mov_b32 s20, s6
  s_mov_b32 s21, s7
  s_mov_b32 s22, 0x1e6000
  s_mov_b32 s23, 0x00020000
  s_add_u32 s64, s62, 0
  s_cmp_ge_u32 s64, 9
  s_cselect_b32 s65, 9, 0
  s_sub_u32 s64, s64, s65
  s_lshl_b32 s65, s64, 7
  s_mul_i32 s64, s64, 221184
  s_cmp_eq_u32 s3, 7
  s_cbranch_scc1 k1_sk1
  s_add_u32 m0, s32, 24576
  s_mov_b32 s34, s64
  buffer_load_dwordx4 v3, s[20:23], s34 offen lds
k1_sk1:
  s_add_u32 m0, s32, 16384
  s_mov_b32 s34, s64
  buffer_load_dwordx4 v2, s[20:23], s34 offen lds
  s_add_u32 m0, s32, 0
  s_add_u32 s34, s65, 0
  buffer_load_dwordx4 v1, s[16:19], s34 offen lds
  s_add_u32 m0, s32, 8192
  s_add_u32 s34, s65, 73728
  buffer_load_dwordx4 v1, s[16:19], s34 offen lds
  v_lshlrev_b32 v110, 4, v0
  s_mov_b32 m0, 160768
  s_barrier
  s_add_u32 s64, s62, 1
  s_cmp_ge_u32 s64, 9
  s_cselect_b32 s65, 9, 0
  s_sub_u32 s64, s64, s65
  s_lshl_b32 s65, s64, 7
  s_mul_i32 s64, s64, 221184
  s_cmp_eq_u32 s3, 7
  s_cbranch_scc1 k1_sk2
  s_add_u32 m0, s32, 56320
  s_mov_b32 s34, s64
  buffer_load_dwordx4 v3, s[20:23], s34 offen lds
k1_sk2:
  s_add_u32 m0, s32, 48128
  s_mov_b32 s34, s64
  buffer_load_dwordx4 v2, s[20:23], s34 offen lds
  s_add_u32 m0, s32, 31744
  s_add_u32 s34, s65, 0
  buffer_load_dwordx4 v1, s[16:19], s34 offen lds
  s_add_u32 m0, s32, 39936
  s_add_u32 s34, s65, 73728
  buffer_load_dwordx4 v1, s[16:19], s34 offen lds
  s_mov_b32 s50, 663552
  s_mov_b32 s51, 0x00020000
  s_mov_b32 s56, s54
  s_mov_b32 s57, s55
  s_mov_b32 s58, 5308416
  s_mov_b32 s59, 0x00020000
  s_mov_b32 s54, 5308416
  s_mov_b32 s55, 0x00020000
  s_mul_i32 s60, s2, 20736
  s_add_u32 s60, s60, s32
  s_mul_i32 s61, s2, 2592
  s_add_u32 s61, s61, s32
  s_cmp_lt_u32 s2, 128
  s_cselect_b32 s24, s52, s56
  s_cselect_b32 s25, s53, s57
  s_mov_b32 s26, 5308416
  s_mov_b32 s27, 0x00020000
  s_and_b32 s72, s2, 127
  s_mul_i32 s72, s72, 41472
  s_lshl_b32 s73, s3, 13
  s_add_u32 s72, s72, s73
  v_lshlrev_b32 v105, 7, v0
  v_and_b32 v16, 15, v0
  v_lshrrev_b32 v17, 4, v0
  v_bfe_u32 v18, v0, 1, 3
  v_xor_b32 v18, v18, v17
  v_lshlrev_b32 v18, 4, v18
  v_lshl_add_u32 v18, v16, 7, v18
  s_lshl_b32 s34, s14, 12
  v_add_u32 v4, s34, v18
  v_xor_b32 v5, 64, v4
  v_bfe_u32 v18, v0, 2, 3
  v_lshlrev_b32 v18, 1, v18
  v_lshrrev_b32 v19, 5, v0
  v_lshl_add_u32 v18, v19, 4, v18
  v_mul_u32_u24 v18, 240, v18
  v_and_b32 v19, 3, v0
  v_lshl_add_u32 v18, v19, 3, v18
  s_add_u32 s34, s33, 16384
  v_add_u32 v6, s34, v18
  s_lshl_b32 s34, s14, 6
  v_add_u32 v7, s34, v6
  v_mov_b32 v188, 0x3f803f80
  v_mov_b32 v189, 0x3f803f80
  v_mov_b32 v190, 0x3f803f80
  v_mov_b32 v191, 0x3f803f80
  v_add_u32 v8, 0, v111
  v_min_u32 v9, 683, v8
  v_cmp_le_u32 vcc, 342, v9
  s_nop 1
  v_cndmask_b32_e64 v10, 0, 1, vcc
  v_mul_u32_u24 v11, 342, v10
  v_sub_u32 v11, v9, v11
  v_mul_u32_u24 v12, 3450, v11
  v_lshrrev_b32 v12, 16, v12
  v_mul_u32_u24 v13, 19, v12
  v_sub_u32 v13, v11, v13
  v_mul_u32_u24 v14, 18, v10
  v_add_u32 v12, v12, v14
  v_add3_u32 v15, v13, v14, 8
  v_cmp_eq_u32 vcc, 18, v13
  s_nop 1
  v_cndmask_b32_e64 v15, v15, 48, vcc
  v_lshrrev_b32 v16, 4, v12
  v_lshrrev_b32 v17, 4, v15
  v_lshl_add_u32 v16, v16, 2, v17
  v_lshlrev_b32 v16, 10, v16
  v_bfe_u32 v17, v12, 2, 2
  v_lshl_add_u32 v16, v17, 8, v16
  v_and_b32 v17, 15, v15
  v_lshl_add_u32 v16, v17, 4, v16
  v_and_b32 v17, 3, v12
  v_lshl_add_u32 v106, v17, 2, v16
  v_cmp_lt_u32 vcc, 683, v8
  v_mov_b32 v12, 350
  v_mul_u32_u24 v10, 22528, v10
  v_cndmask_b32 v11, v11, v12, vcc
  v_lshl_add_u32 v108, v11, 2, v10
  v_add_u32 v8, 512, v111
  v_min_u32 v9, 683, v8
  v_cmp_le_u32 vcc, 342, v9
  s_nop 1
  v_cndmask_b32_e64 v10, 0, 1, vcc
  v_mul_u32_u24 v11, 342, v10
  v_sub_u32 v11, v9, v11
  v_mul_u32_u24 v12, 3450, v11
  v_lshrrev_b32 v12, 16, v12
  v_mul_u32_u24 v13, 19, v12
  v_sub_u32 v13, v11, v13
  v_mul_u32_u24 v14, 18, v10
  v_add_u32 v12, v12, v14
  v_add3_u32 v15, v13, v14, 8
  v_cmp_eq_u32 vcc, 18, v13
  s_nop 1
  v_cndmask_b32_e64 v15, v15, 48, vcc
  v_lshrrev_b32 v16, 4, v12
  v_lshrrev_b32 v17, 4, v15
  v_lshl_add_u32 v16, v16, 2, v17
  v_lshlrev_b32 v16, 10, v16
  v_bfe_u32 v17, v12, 2, 2
  v_lshl_add_u32 v16, v17, 8, v16
  v_and_b32 v17, 15, v15
  v_lshl_add_u32 v16, v17, 4, v16
  v_and_b32 v17, 3, v12
  v_lshl_add_u32 v107, v17, 2, v16
  v_cmp_lt_u32 vcc, 683, v8
  v_mov_b32 v12, 350
  v_mul_u32_u24 v10, 22528, v10
  v_cndmask_b32 v11, v11, v12, vcc
  v_lshl_add_u32 v109, v11, 2, v10
  s_cmp_lg_u32 s3, 7
  s_cbranch_scc1 k1_clr3
  s_add_u32 s68, s10, 0x540000
  s_addc_u32 s69, s11, 0
  s_mov_b32 s70, 0x10000
  s_mov_b32 s71, 0x00020000
  v_mov_b32 v8, -1
  v_lshlrev_b32 v9, 2, v0
  s_lshl_b32 s34, s2, 8
  buffer_store_dword v8, v9, s[68:71], s34 offen
k1_clr3:
  s_waitcnt vmcnt(3)
  s_barrier
  s_cmp_eq_u32 s15, 0
  s_cbranch_scc0 k1_qmain
  ds_read_b128 v[8:11], v4 offset:0
  ds_read_b128 v[12:15], v4 offset:2048
  ds_read_b64_tr_b16 v[24:25], v6 offset:0
  ds_read_b64_tr_b16 v[26:27], v6 offset:240
  ds_read_b64_tr_b16 v[28:29], v6 offset:32
  ds_read_b64_tr_b16 v[30:31], v6 offset:272
  ds_read_b64_tr_b16 v[32:33], v6 offset:64
  ds_read_b64_tr_b16 v[34:35], v6 offset:304
  ds_read_b64_tr_b16 v[36:37], v6 offset:96
  ds_read_b64_tr_b16 v[38:39], v6 offset:336
  ds_read_b64_tr_b16 v[40:41], v6 offset:128
  ds_read_b64_tr_b16 v[42:43], v6 offset:368
  ds_read_b128 v[16:19], v5 offset:0
  ds_read_b128 v[20:23], v5 offset:2048
  ds_read_b64_tr_b16 v[44:45], v6 offset:7680
  ds_read_b64_tr_b16 v[46:47], v6 offset:7920
  ds_read_b64_tr_b16 v[48:49], v6 offset:7712
  ds_read_b64_tr_b16 v[50:51], v6 offset:7952
  ds_read_b64_tr_b16 v[52:53], v6 offset:7744
  ds_read_b64_tr_b16 v[54:55], v6 offset:7984
  ds_read_b64_tr_b16 v[56:57], v6 offset:7776
  ds_read_b64_tr_b16 v[58:59], v6 offset:8016
  ds_read_b64_tr_b16 v[60:61], v6 offset:7808
  ds_read_b64_tr_b16 v[62:63], v6 offset:8048
  s_add_u32 s64, s62, 2
  s_cmp_ge_u32 s64, 9
  s_cselect_b32 s65, 9, 0
  s_sub_u32 s64, s64, s65
  s_lshl_b32 s65, s64, 7
  s_mul_i32 s64, s64, 221184
  s_cmp_eq_u32 s3, 7
  s_cbranch_scc1 k1_sk4
  s_add_u32 m0, s32, 88064
  s_mov_b32 s34, s64
  buffer_load_dwordx4 v3, s[20:23], s34 offen lds
k1_sk4:
  s_add_u32 m0, s32, 79872
  s_mov_b32 s34, s64
  buffer_load_dwordx4 v2, s[20:23], s34 offen lds
  s_add_u32 m0, s32, 63488
  s_add_u32 s34, s65, 0
  buffer_load_dwordx4 v1, s[16:19], s34 offen lds
  s_add_u32 m0, s32, 71680
  s_add_u32 s34, s65, 73728
  buffer_load_dwordx4 v1, s[16:19], s34 offen lds
  s_waitcnt lgkmcnt(12)
  v_mfma_f32_16x16x32_bf16 v[64:67], v[8:11], v[24:27], 0
  v_mfma_f32_16x16x32_bf16 v[84:87], v[12:15], v[24:27], 0
  v_mfma_f32_16x16x32_bf16 v[68:71], v[8:11], v[28:31], 0
  v_mfma_f32_16x16x32_bf16 v[88:91], v[12:15], v[28:31], 0
  v_mfma_f32_16x16x32_bf16 v[72:75], v[8:11], v[32:35], 0
  v_mfma_f32_16x16x32_bf16 v[92:95], v[12:15], v[32:35], 0
  v_mfma_f32_16x16x32_bf16 v[76:79], v[8:11], v[36:39], 0
  v_mfma_f32_16x16x32_bf16 v[96:99], v[12:15], v[36:39], 0
  v_mfma_f32_16x16x32_bf16 v[80:83], v[8:11], v[40:43], 0
  v_mfma_f32_16x16x32_bf16 v[100:103], v[12:15], v[40:43], 0
  s_waitcnt lgkmcnt(0)
  s_waitcnt vmcnt(3)
  s_barrier
  v_add_u32 v4, 31744, v4
  v_add_u32 v5, 31744, v5
  v_add_u32 v6, 31744, v6
  v_add_u32 v7, 31744, v7
  ds_read_b128 v[8:11], v4 offset:0
  ds_read_b128 v[12:15], v4 offset:2048
  ds_read_b64_tr_b16 v[24:25], v6 offset:0
  ds_read_b64_tr_b16 v[26:27], v6 offset:240
  ds_read_b64_tr_b16 v[28:29], v6 offset:32
  ds_read_b64_tr_b16 v[30:31], v6 offset:272
  ds_read_b64_tr_b16 v[32:33], v6 offset:64
  ds_read_b64_tr_b16 v[34:35], v6 offset:304
  ds_read_b64_tr_b16 v[36:37], v6 offset:96
  ds_read_b64_tr_b16 v[38:39], v6 offset:336
  ds_read_b64_tr_b16 v[40:41], v6 offset:128
  ds_read_b64_tr_b16 v[42:43], v6 offset:368
  s_add_u32 s64, s62, 3
  s_cmp_ge_u32 s64, 9
  s_cselect_b32 s65, 9, 0
  s_sub_u32 s64, s64, s65
  s_lshl_b32 s65, s64, 7
  s_mul_i32 s64, s64, 221184
  s_cmp_eq_u32 s3, 7
  s_cbranch_scc1 k1_sk5
  s_add_u32 m0, s32, 119808
  s_mov_b32 s34, s64
  buffer_load_dwordx4 v3, s[20:23], s34 offen lds
k1_sk5:
  s_add_u32 m0, s32, 111616
  s_mov_b32 s34, s64
  buffer_load_dwordx4 v2, s[20:23], s34 offen lds
  s_add_u32 m0, s32, 95232
  s_add_u32 s34, s65, 0
  buffer_load_dwordx4 v1, s[16:19], s34 offen lds
  s_add_u32 m0, s32, 103424
  s_add_u32 s34, s65, 73728
  buffer_load_dwordx4 v1, s[16:19], s34 offen lds
  v_mfma_f32_16x16x32_bf16 v[64:67], v[16:19], v[44:47], v[64:67]
  v_mfma_f32_16x16x32_bf16 v[84:87], v[20:23], v[44:47], v[84:87]
  v_mfma_f32_16x16x32_bf16 v[68:71], v[16:19], v[48:51], v[68:71]
  v_mfma_f32_16x16x32_bf16 v[88:91], v[20:23], v[48:51], v[88:91]
  v_mfma_f32_16x16x32_bf16 v[72:75], v[16:19], v[52:55], v[72:75]
  v_mfma_f32_16x16x32_bf16 v[92:95], v[20:23], v[52:55], v[92:95]
  v_mfma_f32_16x16x32_bf16 v[76:79], v[16:19], v[56:59], v[76:79]
  v_mfma_f32_16x16x32_bf16 v[96:99], v[20:23], v[56:59], v[96:99]
  v_mfma_f32_16x16x32_bf16 v[80:83], v[16:19], v[60:63], v[80:83]
  v_mfma_f32_16x16x32_bf16 v[100:103], v[20:23], v[60:63], v[100:103]
  ds_read_b128 v[16:19], v5 offset:0
  ds_read_b128 v[20:23], v5 offset:2048
  ds_read_b64_tr_b16 v[44:45], v6 offset:7680
  ds_read_b64_tr_b16 v[46:47], v6 offset:7920
  ds_read_b64_tr_b16 v[48:49], v6 offset:7712
  ds_read_b64_tr_b16 v[50:51], v6 offset:7952
  ds_read_b64_tr_b16 v[52:53], v6 offset:7744
  ds_read_b64_tr_b16 v[54:55], v6 offset:7984
  ds_read_b64_tr_b16 v[56:57], v6 offset:7776
  ds_read_b64_tr_b16 v[58:59], v6 offset:8016
  ds_read_b64_tr_b16 v[60:61], v6 offset:7808
  ds_read_b64_tr_b16 v[62:63], v6 offset:8048
  s_add_u32 s64, s62, 4
  s_cmp_ge_u32 s64, 9
  s_cselect_b32 s65, 9, 0
  s_sub_u32 s64, s64, s65
  s_lshl_b32 s65, s64, 7
  s_mul_i32 s64, s64, 221184
  s_cmp_eq_u32 s3, 7
  s_cbranch_scc1 k1_sk6
  s_add_u32 m0, s32, 151552
  s_mov_b32 s34, s64
  buffer_load_dwordx4 v3, s[20:23], s34 offen lds
k1_sk6:
  s_add_u32 m0, s32, 143360
  s_mov_b32 s34, s64
  buffer_load_dwordx4 v2, s[20:23], s34 offen lds
  s_add_u32 m0, s32, 126976
  s_add_u32 s34, s65, 0
  buffer_load_dwordx4 v1, s[16:19], s34 offen lds
  s_add_u32 m0, s32, 135168
  s_add_u32 s34, s65, 73728
  buffer_load_dwordx4 v1, s[16:19], s34 offen lds
  s_waitcnt lgkmcnt(12)
  v_mfma_f32_16x16x32_bf16 v[64:67], v[8:11], v[24:27], v[64:67]
  v_mfma_f32_16x16x32_bf16 v[84:87], v[12:15], v[24:27], v[84:87]
  v_mfma_f32_16x16x32_bf16 v[68:71], v[8:11], v[28:31], v[68:71]
  v_mfma_f32_16x16x32_bf16 v[88:91], v[12:15], v[28:31], v[88:91]
  v_mfma_f32_16x16x32_bf16 v[72:75], v[8:11], v[32:35], v[72:75]
  v_mfma_f32_16x16x32_bf16 v[92:95], v[12:15], v[32:35], v[92:95]
  v_mfma_f32_16x16x32_bf16 v[76:79], v[8:11], v[36:39], v[76:79]
  v_mfma_f32_16x16x32_bf16 v[96:99], v[12:15], v[36:39], v[96:99]
  v_mfma_f32_16x16x32_bf16 v[80:83], v[8:11], v[40:43], v[80:83]
  v_mfma_f32_16x16x32_bf16 v[100:103], v[12:15], v[40:43], v[100:103]
  s_waitcnt lgkmcnt(0)
  s_waitcnt vmcnt(6)
  s_barrier
  v_add_u32 v4, 31744, v4
  v_add_u32 v5, 31744, v5
  v_add_u32 v6, 31744, v6
  v_add_u32 v7, 31744, v7
  ds_read_b128 v[8:11], v4 offset:0
  ds_read_b128 v[12:15], v4 offset:2048
  ds_read_b64_tr_b16 v[24:25], v6 offset:0
  ds_read_b64_tr_b16 v[26:27], v6 offset:240
  ds_read_b64_tr_b16 v[28:29], v6 offset:32
  ds_read_b64_tr_b16 v[30:31], v6 offset:272
  ds_read_b64_tr_b16 v[32:33], v6 offset:64
  ds_read_b64_tr_b16 v[34:35], v6 offset:304
  ds_read_b64_tr_b16 v[36:37], v6 offset:96
  ds_read_b64_tr_b16 v[38:39], v6 offset:336
  ds_read_b64_tr_b16 v[40:41], v6 offset:128
  ds_read_b64_tr_b16 v[42:43], v6 offset:368
  s_add_u32 s64, s62, 5
  s_cmp_ge_u32 s64, 9
  s_cselect_b32 s65, 9, 0
  s_sub_u32 s64, s64, s65
  s_lshl_b32 s65, s64, 7
  s_mul_i32 s64, s64, 221184
  s_cmp_eq_u32 s3, 7
  s_cbranch_scc1 k1_sk7
  s_add_u32 m0, s32, 24576
  s_mov_b32 s34, s64
  buffer_load_dwordx4 v3, s[20:23], s34 offen lds
k1_sk7:
  s_add_u32 m0, s32, 16384
  s_mov_b32 s34, s64
  buffer_load_dwordx4 v2, s[20:23], s34 offen lds
  s_add_u32 m0, s32, 0
  s_add_u32 s34, s65, 0
  buffer_load_dwordx4 v1, s[16:19], s34 offen lds
  s_add_u32 m0, s32, 8192
  s_add_u32 s34, s65, 73728
  buffer_load_dwordx4 v1, s[16:19], s34 offen lds
  v_mfma_f32_16x16x32_bf16 v[64:67], v[16:19], v[44:47], v[64:67]
  v_mfma_f32_16x16x32_bf16 v[84:87], v[20:23], v[44:47], v[84:87]
  v_mfma_f32_16x16x32_bf16 v[68:71], v[16:19], v[48:51], v[68:71]
  v_mfma_f32_16x16x32_bf16 v[88:91], v[20:23], v[48:51], v[88:91]
  v_mfma_f32_16x16x32_bf16 v[72:75], v[16:19], v[52:55], v[72:75]
  v_mfma_f32_16x16x32_bf16 v[92:95], v[20:23], v[52:55], v[92:95]
  v_mfma_f32_16x16x32_bf16 v[76:79], v[16:19], v[56:59], v[76:79]
  v_mfma_f32_16x16x32_bf16 v[96:99], v[20:23], v[56:59], v[96:99]
  v_mfma_f32_16x16x32_bf16 v[80:83], v[16:19], v[60:63], v[80:83]
  v_mfma_f32_16x16x32_bf16 v[100:103], v[20:23], v[60:63], v[100:103]
  ds_read_b128 v[16:19], v5 offset:0
  ds_read_b128 v[20:23], v5 offset:2048
  ds_read_b64_tr_b16 v[44:45], v6 offset:7680
  ds_read_b64_tr_b16 v[46:47], v6 offset:7920
  ds_read_b64_tr_b16 v[48:49], v6 offset:7712
  ds_read_b64_tr_b16 v[50:51], v6 offset:7952
  ds_read_b64_tr_b16 v[52:53], v6 offset:7744
  ds_read_b64_tr_b16 v[54:55], v6 offset:7984
  ds_read_b64_tr_b16 v[56:57], v6 offset:7776
  ds_read_b64_tr_b16 v[58:59], v6 offset:8016
  ds_read_b64_tr_b16 v[60:61], v6 offset:7808
  ds_read_b64_tr_b16 v[62:63], v6 offset:8048
  s_add_u32 s64, s62, 6
  s_cmp_ge_u32 s64, 9
  s_cselect_b32 s65, 9, 0
  s_sub_u32 s64, s64, s65
  s_lshl_b32 s65, s64, 7
  s_mul_i32 s64, s64, 221184
  s_cmp_eq_u32 s3, 7
  s_cbranch_scc1 k1_sk8
  s_add_u32 m0, s32, 56320
  s_mov_b32 s34, s64
  buffer_load_dwordx4 v3, s[20:23], s34 offen lds
k1_sk8:
  s_add_u32 m0, s32, 48128
  s_mov_b32 s34, s64
  buffer_load_dwordx4 v2, s[20:23], s34 offen lds
  s_add_u32 m0, s32, 31744
  s_add_u32 s34, s65, 0
  buffer_load_dwordx4 v1, s[16:19], s34 offen lds
  s_add_u32 m0, s32, 39936
  s_add_u32 s34, s65, 73728
  buffer_load_dwordx4 v1, s[16:19], s34 offen lds
  s_mov_b32 m0, 160768
  s_cmp_ge_u32 s3, 3
  s_cbranch_scc1 k1_pf9
  buffer_load_dwordx4 v110, s[48:51], s61 offen lds
k1_pf9:
  s_waitcnt lgkmcnt(12)
  v_mfma_f32_16x16x32_bf16 v[64:67], v[8:11], v[24:27], v[64:67]
  v_mfma_f32_16x16x32_bf16 v[84:87], v[12:15], v[24:27], v[84:87]
  v_mfma_f32_16x16x32_bf16 v[68:71], v[8:11], v[28:31], v[68:71]
  v_mfma_f32_16x16x32_bf16 v[88:91], v[12:15], v[28:31], v[88:91]
  v_mfma_f32_16x16x32_bf16 v[72:75], v[8:11], v[32:35], v[72:75]
  v_mfma_f32_16x16x32_bf16 v[92:95], v[12:15], v[32:35], v[92:95]
  v_mfma_f32_16x16x32_bf16 v[76:79], v[8:11], v[36:39], v[76:79]
  v_mfma_f32_16x16x32_bf16 v[96:99], v[12:15], v[36:39], v[96:99]
  v_mfma_f32_16x16x32_bf16 v[80:83], v[8:11], v[40:43], v[80:83]
  v_mfma_f32_16x16x32_bf16 v[100:103], v[12:15], v[40:43], v[100:103]
  s_waitcnt lgkmcnt(0)
  s_waitcnt vmcnt(9)
  s_barrier
  v_add_u32 v4, 31744, v4
  v_add_u32 v5, 31744, v5
  v_add_u32 v6, 31744, v6
  v_add_u32 v7, 31744, v7
  ds_read_b128 v[8:11], v4 offset:0
  ds_read_b128 v[12:15], v4 offset:2048
  ds_read_b64_tr_b16 v[24:25], v6 offset:0
  ds_read_b64_tr_b16 v[26:27], v6 offset:240
  ds_read_b64_tr_b16 v[28:29], v6 offset:32
  ds_read_b64_tr_b16 v[30:31], v6 offset:272
  ds_read_b64_tr_b16 v[32:33], v6 offset:64
  ds_read_b64_tr_b16 v[34:35], v6 offset:304
  ds_read_b64_tr_b16 v[36:37], v6 offset:96
  ds_read_b64_tr_b16 v[38:39], v6 offset:336
  ds_read_b64_tr_b16 v[40:41], v6 offset:128
  ds_read_b64_tr_b16 v[42:43], v6 offset:368
  s_add_u32 s64, s62, 7
  s_cmp_ge_u32 s64, 9
  s_cselect_b32 s65, 9, 0
  s_sub_u32 s64, s64, s65
  s_lshl_b32 s65, s64, 7
  s_mul_i32 s64, s64, 221184
  s_cmp_eq_u32 s3, 7
  s_cbranch_scc1 k1_sk10
  s_add_u32 m0, s32, 88064
  s_mov_b32 s34, s64
  buffer_load_dwordx4 v3, s[20:23], s34 offen lds
k1_sk10:
  s_add_u32 m0, s32, 79872
  s_mov_b32 s34, s64
  buffer_load_dwordx4 v2, s[20:23], s34 offen lds
  s_add_u32 m0, s32, 63488
  s_add_u32 s34, s65, 0
  buffer_load_dwordx4 v1, s[16:19], s34 offen lds
  s_add_u32 m0, s32, 71680
  s_add_u32 s34, s65, 73728
  buffer_load_dwordx4 v1, s[16:19], s34 offen lds
  v_mfma_f32_16x16x32_bf16 v[64:67], v[16:19], v[44:47], v[64:67]
  v_mfma_f32_16x16x32_bf16 v[84:87], v[20:23], v[44:47], v[84:87]
  v_mfma_f32_16x16x32_bf16 v[68:71], v[16:19], v[48:51], v[68:71]
  v_mfma_f32_16x16x32_bf16 v[88:91], v[20:23], v[48:51], v[88:91]
  v_mfma_f32_16x16x32_bf16 v[72:75], v[16:19], v[52:55], v[72:75]
  v_mfma_f32_16x16x32_bf16 v[92:95], v[20:23], v[52:55], v[92:95]
  v_mfma_f32_16x16x32_bf16 v[76:79], v[16:19], v[56:59], v[76:79]
  v_mfma_f32_16x16x32_bf16 v[96:99], v[20:23], v[56:59], v[96:99]
  v_mfma_f32_16x16x32_bf16 v[80:83], v[16:19], v[60:63], v[80:83]
  v_mfma_f32_16x16x32_bf16 v[100:103], v[20:23], v[60:63], v[100:103]
  ds_read_b128 v[16:19], v5 offset:0
  ds_read_b128 v[20:23], v5 offset:2048
  ds_read_b64_tr_b16 v[44:45], v6 offset:7680
  ds_read_b64_tr_b16 v[46:47], v6 offset:7920
  ds_read_b64_tr_b16 v[48:49], v6 offset:7712
  ds_read_b64_tr_b16 v[50:51], v6 offset:7952
  ds_read_b64_tr_b16 v[52:53], v6 offset:7744
  ds_read_b64_tr_b16 v[54:55], v6 offset:7984
  ds_read_b64_tr_b16 v[56:57], v6 offset:7776
  ds_read_b64_tr_b16 v[58:59], v6 offset:8016
  ds_read_b64_tr_b16 v[60:61], v6 offset:7808
  ds_read_b64_tr_b16 v[62:63], v6 offset:8048
  s_waitcnt lgkmcnt(12)
  v_mfma_f32_16x16x32_bf16 v[64:67], v[8:11], v[24:27], v[64:67]
  v_mfma_f32_16x16x32_bf16 v[84:87], v[12:15], v[24:27], v[84:87]
  v_mfma_f32_16x16x32_bf16 v[68:71], v[8:11], v[28:31], v[68:71]
  v_mfma_f32_16x16x32_bf16 v[88:91], v[12:15], v[28:31], v[88:91]
  v_mfma_f32_16x16x32_bf16 v[72:75], v[8:11], v[32:35], v[72:75]
  v_mfma_f32_16x16x32_bf16 v[92:95], v[12:15], v[32:35], v[92:95]
  v_mfma_f32_16x16x32_bf16 v[76:79], v[8:11], v[36:39], v[76:79]
  v_mfma_f32_16x16x32_bf16 v[96:99], v[12:15], v[36:39], v[96:99]
  v_mfma_f32_16x16x32_bf16 v[80:83], v[8:11], v[40:43], v[80:83]
  v_mfma_f32_16x16x32_bf16 v[100:103], v[12:15], v[40:43], v[100:103]
  s_waitcnt lgkmcnt(0)
  s_waitcnt vmcnt(9)
  s_barrier
  v_add_u32 v4, 31744, v4
  v_add_u32 v5, 31744, v5
  v_add_u32 v6, 31744, v6
  v_add_u32 v7, 31744, v7
  ds_read_b128 v[8:11], v4 offset:0
  ds_read_b128 v[12:15], v4 offset:2048
  ds_read_b64_tr_b16 v[24:25], v6 offset:0
  ds_read_b64_tr_b16 v[26:27], v6 offset:240
  ds_read_b64_tr_b16 v[28:29], v6 offset:32
  ds_read_b64_tr_b16 v[30:31], v6 offset:272
  ds_read_b64_tr_b16 v[32:33], v6 offset:64
  ds_read_b64_tr_b16 v[34:35], v6 offset:304
  ds_read_b64_tr_b16 v[36:37], v6 offset:96
  ds_read_b64_tr_b16 v[38:39], v6 offset:336
  ds_read_b64_tr_b16 v[40:41], v6 offset:128
  ds_read_b64_tr_b16 v[42:43], v6 offset:368
  s_add_u32 s64, s62, 8
  s_cmp_ge_u32 s64, 9
  s_cselect_b32 s65, 9, 0
  s_sub_u32 s64, s64, s65
  s_lshl_b32 s65, s64, 7
  s_mul_i32 s64, s64, 221184
  s_cmp_eq_u32 s3, 7
  s_cbranch_scc1 k1_sk11
  s_add_u32 m0, s32, 119808
  s_mov_b32 s34, s64
  buffer_load_dwordx4 v3, s[20:23], s34 offen lds
k1_sk11:
  s_add_u32 m0, s32, 111616
  s_mov_b32 s34, s64
  buffer_load_dwordx4 v2, s[20:23], s34 offen lds
  s_add_u32 m0, s32, 95232
  s_add_u32 s34, s65, 0
  buffer_load_dwordx4 v1, s[16:19], s34 offen lds
  s_add_u32 m0, s32, 103424
  s_add_u32 s34, s65, 73728
  buffer_load_dwordx4 v1, s[16:19], s34 offen lds
  v_mfma_f32_16x16x32_bf16 v[64:67], v[16:19], v[44:47], v[64:67]
  v_mfma_f32_16x16x32_bf16 v[84:87], v[20:23], v[44:47], v[84:87]
  v_mfma_f32_16x16x32_bf16 v[68:71], v[16:19], v[48:51], v[68:71]
  v_mfma_f32_16x16x32_bf16 v[88:91], v[20:23], v[48:51], v[88:91]
  v_mfma_f32_16x16x32_bf16 v[72:75], v[16:19], v[52:55], v[72:75]
  v_mfma_f32_16x16x32_bf16 v[92:95], v[20:23], v[52:55], v[92:95]
  v_mfma_f32_16x16x32_bf16 v[76:79], v[16:19], v[56:59], v[76:79]
  v_mfma_f32_16x16x32_bf16 v[96:99], v[20:23], v[56:59], v[96:99]
  v_mfma_f32_16x16x32_bf16 v[80:83], v[16:19], v[60:63], v[80:83]
  v_mfma_f32_16x16x32_bf16 v[100:103], v[20:23], v[60:63], v[100:103]
  ds_read_b128 v[16:19], v5 offset:0
  ds_read_b128 v[20:23], v5 offset:2048
  ds_read_b64_tr_b16 v[44:45], v6 offset:7680
  ds_read_b64_tr_b16 v[46:47], v6 offset:7920
  ds_read_b64_tr_b16 v[48:49], v6 offset:7712
  ds_read_b64_tr_b16 v[50:51], v6 offset:7952
  ds_read_b64_tr_b16 v[52:53], v6 offset:7744
  ds_read_b64_tr_b16 v[54:55], v6 offset:7984
  ds_read_b64_tr_b16 v[56:57], v6 offset:7776
  ds_read_b64_tr_b16 v[58:59], v6 offset:8016
  ds_read_b64_tr_b16 v[60:61], v6 offset:7808
  ds_read_b64_tr_b16 v[62:63], v6 offset:8048
  s_waitcnt lgkmcnt(12)
  v_mfma_f32_16x16x32_bf16 v[64:67], v[8:11], v[24:27], v[64:67]
  v_mfma_f32_16x16x32_bf16 v[84:87], v[12:15], v[24:27], v[84:87]
  v_mfma_f32_16x16x32_bf16 v[68:71], v[8:11], v[28:31], v[68:71]
  v_mfma_f32_16x16x32_bf16 v[88:91], v[12:15], v[28:31], v[88:91]
  v_mfma_f32_16x16x32_bf16 v[72:75], v[8:11], v[32:35], v[72:75]
  v_mfma_f32_16x16x32_bf16 v[92:95], v[12:15], v[32:35], v[92:95]
  v_mfma_f32_16x16x32_bf16 v[76:79], v[8:11], v[36:39], v[76:79]
  v_mfma_f32_16x16x32_bf16 v[96:99], v[12:15], v[36:39], v[96:99]
  v_mfma_f32_16x16x32_bf16 v[80:83], v[8:11], v[40:43], v[80:83]
  v_mfma_f32_16x16x32_bf16 v[100:103], v[12:15], v[40:43], v[100:103]
  s_waitcnt lgkmcnt(0)
  s_waitcnt vmcnt(9)
  s_barrier
  v_add_u32 v4, 4294840320, v4
  v_add_u32 v5, 4294840320, v5
  v_add_u32 v6, 4294840320, v6
  v_add_u32 v7, 4294840320, v7
  ds_read_b128 v[8:11], v4 offset:0
  ds_read_b128 v[12:15], v4 offset:2048
  ds_read_b64_tr_b16 v[24:25], v6 offset:0
  ds_read_b64_tr_b16 v[26:27], v6 offset:240
  ds_read_b64_tr_b16 v[28:29], v6 offset:32
  ds_read_b64_tr_b16 v[30:31], v6 offset:272
  ds_read_b64_tr_b16 v[32:33], v6 offset:64
  ds_read_b64_tr_b16 v[34:35], v6 offset:304
  ds_read_b64_tr_b16 v[36:37], v6 offset:96
  ds_read_b64_tr_b16 v[38:39], v6 offset:336
  ds_read_b64_tr_b16 v[40:41], v6 offset:128
  ds_read_b64_tr_b16 v[42:43], v6 offset:368
  v_mfma_f32_16x16x32_bf16 v[64:67], v[16:19], v[44:47], v[64:67]
  v_mfma_f32_16x16x32_bf16 v[84:87], v[20:23], v[44:47], v[84:87]
  v_mfma_f32_16x16x32_bf16 v[68:71], v[16:19], v[48:51], v[68:71]
  v_mfma_f32_16x16x32_bf16 v[88:91], v[20:23], v[48:51], v[88:91]
  v_mfma_f32_16x16x32_bf16 v[72:75], v[16:19], v[52:55], v[72:75]
  v_mfma_f32_16x16x32_bf16 v[92:95], v[20:23], v[52:55], v[92:95]
  v_mfma_f32_16x16x32_bf16 v[76:79], v[16:19], v[56:59], v[76:79]
  v_mfma_f32_16x16x32_bf16 v[96:99], v[20:23], v[56:59], v[96:99]
  v_mfma_f32_16x16x32_bf16 v[80:83], v[16:19], v[60:63], v[80:83]
  v_mfma_f32_16x16x32_bf16 v[100:103], v[20:23], v[60:63], v[100:103]
  ds_read_b128 v[16:19], v5 offset:0
  ds_read_b128 v[20:23], v5 offset:2048
  ds_read_b64_tr_b16 v[44:45], v6 offset:7680
  ds_read_b64_tr_b16 v[46:47], v6 offset:7920
  ds_read_b64_tr_b16 v[48:49], v6 offset:7712
  ds_read_b64_tr_b16 v[50:51], v6 offset:7952
  ds_read_b64_tr_b16 v[52:53], v6 offset:7744
  ds_read_b64_tr_b16 v[54:55], v6 offset:7984
  ds_read_b64_tr_b16 v[56:57], v6 offset:7776
  ds_read_b64_tr_b16 v[58:59], v6 offset:8016
  ds_read_b64_tr_b16 v[60:61], v6 offset:7808
  ds_read_b64_tr_b16 v[62:63], v6 offset:8048
  s_mov_b32 m0, 160768
  s_nop 0
  buffer_load_dword v105, s[24:27], s72 offen lds
  s_waitcnt lgkmcnt(12)
  v_mfma_f32_16x16x32_bf16 v[64:67], v[8:11], v[24:27], v[64:67]
  v_mfma_f32_16x16x32_bf16 v[84:87], v[12:15], v[24:27], v[84:87]
  v_mfma_f32_16x16x32_bf16 v[68:71], v[8:11], v[28:31], v[68:71]
  v_mfma_f32_16x16x32_bf16 v[88:91], v[12:15], v[28:31], v[88:91]
  v_mfma_f32_16x16x32_bf16 v[72:75], v[8:11], v[32:35], v[72:75]
  v_mfma_f32_16x16x32_bf16 v[92:95], v[12:15], v[32:35], v[92:95]
  v_mfma_f32_16x16x32_bf16 v[76:79], v[8:11], v[36:39], v[76:79]
  v_mfma_f32_16x16x32_bf16 v[96:99], v[12:15], v[36:39], v[96:99]
  v_mfma_f32_16x16x32_bf16 v[80:83], v[8:11], v[40:43], v[80:83]
  v_mfma_f32_16x16x32_bf16 v[100:103], v[12:15], v[40:43], v[100:103]
  s_waitcnt lgkmcnt(0)
  s_waitcnt vmcnt(7)
  s_barrier
  v_add_u32 v4, 31744, v4
  v_add_u32 v5, 31744, v5
  v_add_u32 v6, 31744, v6
  v_add_u32 v7, 31744, v7
  ds_read_b128 v[8:11], v4 offset:0
  ds_read_b128 v[12:15], v4 offset:2048
  ds_read_b64_tr_b16 v[24:25], v6 offset:0
  ds_read_b64_tr_b16 v[26:27], v6 offset:240
  ds_read_b64_tr_b16 v[28:29], v6 offset:32
  ds_read_b64_tr_b16 v[30:31], v6 offset:272
  ds_read_b64_tr_b16 v[32:33], v6 offset:64
  ds_read_b64_tr_b16 v[34:35], v6 offset:304
  ds_read_b64_tr_b16 v[36:37], v6 offset:96
  ds_read_b64_tr_b16 v[38:39], v6 offset:336
  ds_read_b64_tr_b16 v[40:41], v6 offset:128
  ds_read_b64_tr_b16 v[42:43], v6 offset:368
  v_mfma_f32_16x16x32_bf16 v[64:67], v[16:19], v[44:47], v[64:67]
  v_mfma_f32_16x16x32_bf16 v[84:87], v[20:23], v[44:47], v[84:87]
  v_mfma_f32_16x16x32_bf16 v[68:71], v[16:19], v[48:51], v[68:71]
  v_mfma_f32_16x16x32_bf16 v[88:91], v[20:23], v[48:51], v[88:91]
  v_mfma_f32_16x16x32_bf16 v[72:75], v[16:19], v[52:55], v[72:75]
  v_mfma_f32_16x16x32_bf16 v[92:95], v[20:23], v[52:55], v[92:95]
  v_mfma_f32_16x16x32_bf16 v[76:79], v[16:19], v[56:59], v[76:79]
  v_mfma_f32_16x16x32_bf16 v[96:99], v[20:23], v[56:59], v[96:99]
  v_mfma_f32_16x16x32_bf16 v[80:83], v[16:19], v[60:63], v[80:83]
  v_mfma_f32_16x16x32_bf16 v[100:103], v[20:23], v[60:63], v[100:103]
  ds_read_b128 v[16:19], v5 offset:0
  ds_read_b128 v[20:23], v5 offset:2048
  ds_read_b64_tr_b16 v[44:45], v6 offset:7680
  ds_read_b64_tr_b16 v[46:47], v6 offset:7920
  ds_read_b64_tr_b16 v[48:49], v6 offset:7712
  ds_read_b64_tr_b16 v[50:51], v6 offset:7952
  ds_read_b64_tr_b16 v[52:53], v6 offset:7744
  ds_read_b64_tr_b16 v[54:55], v6 offset:7984
  ds_read_b64_tr_b16 v[56:57], v6 offset:7776
  ds_read_b64_tr_b16 v[58:59], v6 offset:8016
  ds_read_b64_tr_b16 v[60:61], v6 offset:7808
  ds_read_b64_tr_b16 v[62:63], v6 offset:8048
  s_waitcnt lgkmcnt(12)
  v_mfma_f32_16x16x32_bf16 v[64:67], v[8:11], v[24:27], v[64:67]
  v_mfma_f32_16x16x32_bf16 v[84:87], v[12:15], v[24:27], v[84:87]
  v_mfma_f32_16x16x32_bf16 v[68:71], v[8:11], v[28:31], v[68:71]
  v_mfma_f32_16x16x32_bf16 v[88:91], v[12:15], v[28:31], v[88:91]
  v_mfma_f32_16x16x32_bf16 v[72:75], v[8:11], v[32:35], v[72:75]
  v_mfma_f32_16x16x32_bf16 v[92:95], v[12:15], v[32:35], v[92:95]
  v_mfma_f32_16x16x32_bf16 v[76:79], v[8:11], v[36:39], v[76:79]
  v_mfma_f32_16x16x32_bf16 v[96:99], v[12:15], v[36:39], v[96:99]
  v_mfma_f32_16x16x32_bf16 v[80:83], v[8:11], v[40:43], v[80:83]
  v_mfma_f32_16x16x32_bf16 v[100:103], v[12:15], v[40:43], v[100:103]
  s_waitcnt lgkmcnt(0)
  s_waitcnt vmcnt(4)
  s_barrier
  v_add_u32 v4, 31744, v4
  v_add_u32 v5, 31744, v5
  v_add_u32 v6, 31744, v6
  v_add_u32 v7, 31744, v7
  ds_read_b128 v[8:11], v4 offset:0
  ds_read_b128 v[12:15], v4 offset:2048
  ds_read_b64_tr_b16 v[24:25], v6 offset:0
  ds_read_b64_tr_b16 v[26:27], v6 offset:240
  ds_read_b64_tr_b16 v[28:29], v6 offset:32
  ds_read_b64_tr_b16 v[30:31], v6 offset:272
  ds_read_b64_tr_b16 v[32:33], v6 offset:64
  ds_read_b64_tr_b16 v[34:35], v6 offset:304
  ds_read_b64_tr_b16 v[36:37], v6 offset:96
  ds_read_b64_tr_b16 v[38:39], v6 offset:336
  ds_read_b64_tr_b16 v[40:41], v6 offset:128
  ds_read_b64_tr_b16 v[42:43], v6 offset:368
  v_mfma_f32_16x16x32_bf16 v[64:67], v[16:19], v[44:47], v[64:67]
  v_mfma_f32_16x16x32_bf16 v[84:87], v[20:23], v[44:47], v[84:87]
  v_mfma_f32_16x16x32_bf16 v[68:71], v[16:19], v[48:51], v[68:71]
  v_mfma_f32_16x16x32_bf16 v[88:91], v[20:23], v[48:51], v[88:91]
  v_mfma_f32_16x16x32_bf16 v[72:75], v[16:19], v[52:55], v[72:75]
  v_mfma_f32_16x16x32_bf16 v[92:95], v[20:23], v[52:55], v[92:95]
  v_mfma_f32_16x16x32_bf16 v[76:79], v[16:19], v[56:59], v[76:79]
  v_mfma_f32_16x16x32_bf16 v[96:99], v[20:23], v[56:59], v[96:99]
  v_mfma_f32_16x16x32_bf16 v[80:83], v[16:19], v[60:63], v[80:83]
  v_mfma_f32_16x16x32_bf16 v[100:103], v[20:23], v[60:63], v[100:103]
  ds_read_b128 v[16:19], v5 offset:0
  ds_read_b128 v[20:23], v5 offset:2048
  ds_read_b64_tr_b16 v[44:45], v6 offset:7680
  ds_read_b64_tr_b16 v[46:47], v6 offset:7920
  ds_read_b64_tr_b16 v[48:49], v6 offset:7712
  ds_read_b64_tr_b16 v[50:51], v6 offset:7952
  ds_read_b64_tr_b16 v[52:53], v6 offset:7744
  ds_read_b64_tr_b16 v[54:55], v6 offset:7984
  ds_read_b64_tr_b16 v[56:57], v6 offset:7776
  ds_read_b64_tr_b16 v[58:59], v6 offset:8016
  ds_read_b64_tr_b16 v[60:61], v6 offset:7808
  ds_read_b64_tr_b16 v[62:63], v6 offset:8048
  s_waitcnt lgkmcnt(12)
  v_mfma_f32_16x16x32_bf16 v[64:67], v[8:11], v[24:27], v[64:67]
  v_mfma_f32_16x16x32_bf16 v[84:87], v[12:15], v[24:27], v[84:87]
  v_mfma_f32_16x16x32_bf16 v[68:71], v[8:11], v[28:31], v[68:71]
  v_mfma_f32_16x16x32_bf16 v[88:91], v[12:15], v[28:31], v[88:91]
  v_mfma_f32_16x16x32_bf16 v[72:75], v[8:11], v[32:35], v[72:75]
  v_mfma_f32_16x16x32_bf16 v[92:95], v[12:15], v[32:35], v[92:95]
  v_mfma_f32_16x16x32_bf16 v[76:79], v[8:11], v[36:39], v[76:79]
  v_mfma_f32_16x16x32_bf16 v[96:99], v[12:15], v[36:39], v[96:99]
  v_mfma_f32_16x16x32_bf16 v[80:83], v[8:11], v[40:43], v[80:83]
  v_mfma_f32_16x16x32_bf16 v[100:103], v[12:15], v[40:43], v[100:103]
  s_waitcnt lgkmcnt(0)
  s_waitcnt vmcnt(1)
  s_barrier
  v_add_u32 v4, 31744, v4
  v_add_u32 v5, 31744, v5
  v_add_u32 v6, 31744, v6
  v_add_u32 v7, 31744, v7
  ds_read_b128 v[8:11], v4 offset:0
  ds_read_b128 v[12:15], v4 offset:2048
  ds_read_b64_tr_b16 v[24:25], v6 offset:0
  ds_read_b64_tr_b16 v[26:27], v6 offset:240
  ds_read_b64_tr_b16 v[28:29], v6 offset:32
  ds_read_b64_tr_b16 v[30:31], v6 offset:272
  ds_read_b64_tr_b16 v[32:33], v6 offset:64
  ds_read_b64_tr_b16 v[34:35], v6 offset:304
  ds_read_b64_tr_b16 v[36:37], v6 offset:96
  ds_read_b64_tr_b16 v[38:39], v6 offset:336
  ds_read_b64_tr_b16 v[40:41], v6 offset:128
  ds_read_b64_tr_b16 v[42:43], v6 offset:368
  v_mfma_f32_16x16x32_bf16 v[64:67], v[16:19], v[44:47], v[64:67]
  v_mfma_f32_16x16x32_bf16 v[84:87], v[20:23], v[44:47], v[84:87]
  v_mfma_f32_16x16x32_bf16 v[68:71], v[16:19], v[48:51], v[68:71]
  v_mfma_f32_16x16x32_bf16 v[88:91], v[20:23], v[48:51], v[88:91]
  v_mfma_f32_16x16x32_bf16 v[72:75], v[16:19], v[52:55], v[72:75]
  v_mfma_f32_16x16x32_bf16 v[92:95], v[20:23], v[52:55], v[92:95]
  v_mfma_f32_16x16x32_bf16 v[76:79], v[16:19], v[56:59], v[76:79]
  v_mfma_f32_16x16x32_bf16 v[96:99], v[20:23], v[56:59], v[96:99]
  v_mfma_f32_16x16x32_bf16 v[80:83], v[16:19], v[60:63], v[80:83]
  v_mfma_f32_16x16x32_bf16 v[100:103], v[20:23], v[60:63], v[100:103]
  ds_read_b128 v[16:19], v5 offset:0
  ds_read_b128 v[20:23], v5 offset:2048
  ds_read_b64_tr_b16 v[44:45], v6 offset:7680
  ds_read_b64_tr_b16 v[46:47], v6 offset:7920
  ds_read_b64_tr_b16 v[48:49], v6 offset:7712
  ds_read_b64_tr_b16 v[50:51], v6 offset:7952
  ds_read_b64_tr_b16 v[52:53], v6 offset:7744
  ds_read_b64_tr_b16 v[54:55], v6 offset:7984
  ds_read_b64_tr_b16 v[56:57], v6 offset:7776
  ds_read_b64_tr_b16 v[58:59], v6 offset:8016
  ds_read_b64_tr_b16 v[60:61], v6 offset:7808
  ds_read_b64_tr_b16 v[62:63], v6 offset:8048
  s_waitcnt lgkmcnt(12)
  v_mfma_f32_16x16x32_bf16 v[64:67], v[8:11], v[24:27], v[64:67]
  v_mfma_f32_16x16x32_bf16 v[84:87], v[12:15], v[24:27], v[84:87]
  v_mfma_f32_16x16x32_bf16 v[68:71], v[8:11], v[28:31], v[68:71]
  v_mfma_f32_16x16x32_bf16 v[88:91], v[12:15], v[28:31], v[88:91]
  v_mfma_f32_16x16x32_bf16 v[72:75], v[8:11], v[32:35], v[72:75]
  v_mfma_f32_16x16x32_bf16 v[92:95], v[12:15], v[32:35], v[92:95]
  v_mfma_f32_16x16x32_bf16 v[76:79], v[8:11], v[36:39], v[76:79]
  v_mfma_f32_16x16x32_bf16 v[96:99], v[12:15], v[36:39], v[96:99]
  v_mfma_f32_16x16x32_bf16 v[80:83], v[8:11], v[40:43], v[80:83]
  v_mfma_f32_16x16x32_bf16 v[100:103], v[12:15], v[40:43], v[100:103]
  s_waitcnt lgkmcnt(0)
  v_mfma_f32_16x16x32_bf16 v[64:67], v[16:19], v[44:47], v[64:67]
  v_mfma_f32_16x16x32_bf16 v[84:87], v[20:23], v[44:47], v[84:87]
  v_mfma_f32_16x16x32_bf16 v[68:71], v[16:19], v[48:51], v[68:71]
  v_mfma_f32_16x16x32_bf16 v[88:91], v[20:23], v[48:51], v[88:91]
  v_mfma_f32_16x16x32_bf16 v[72:75], v[16:19], v[52:55], v[72:75]
  v_mfma_f32_16x16x32_bf16 v[92:95], v[20:23], v[52:55], v[92:95]
  v_mfma_f32_16x16x32_bf16 v[76:79], v[16:19], v[56:59], v[76:79]
  v_mfma_f32_16x16x32_bf16 v[96:99], v[20:23], v[56:59], v[96:99]
  v_mfma_f32_16x16x32_bf16 v[80:83], v[16:19], v[60:63], v[80:83]
  v_mfma_f32_16x16x32_bf16 v[100:103], v[20:23], v[60:63], v[100:103]
  s_barrier
  v_and_b32 v16, 15, v0
  v_lshrrev_b32 v17, 4, v0
  s_lshl_b32 s34, s14, 7
  s_add_u32 s34, s34, 158720
  v_lshl_add_u32 v18, v17, 4, s34
  ds_read_b128 v[112:115], v18 offset:0
  ds_read_b128 v[120:123], v18 offset:512
  ds_read_b128 v[116:119], v18 offset:64
  ds_read_b128 v[124:127], v18 offset:576
  v_lshlrev_b32 v19, 2, v16
  v_add_u32 v19, 159744, v19
  ds_read_b32 v128, v19 offset:0
  ds_read_b32 v129, v19 offset:64
  ds_read_b32 v130, v19 offset:128
  ds_read_b32 v131, v19 offset:192
  ds_read_b32 v132, v19 offset:256
  s_waitcnt lgkmcnt(0)
  v_fmac_f32 v64, v112, v128
  v_mul_f32 v64, v64, v120
  v_fmac_f32 v65, v113, v128
  v_mul_f32 v65, v65, v121
  v_fmac_f32 v66, v114, v128
  v_mul_f32 v66, v66, v122
  v_fmac_f32 v67, v115, v128
  v_mul_f32 v67, v67, v123
  v_mul_f32 v8, 0x3fb8aa3b, v64
  v_mul_f32 v9, 0x3fb8aa3b, v65
  v_mul_f32 v10, 0x3fb8aa3b, v66
  v_mul_f32 v11, 0x3fb8aa3b, v67
  v_exp_f32 v8, v8
  v_exp_f32 v9, v9
  v_exp_f32 v10, v10
  v_exp_f32 v11, v11
  v_cmp_lt_f32 s[40:41], 0, v64
  v_cmp_lt_f32 s[42:43], 0, v65
  v_cmp_lt_f32 s[44:45], 0, v66
  v_cmp_lt_f32 s[46:47], 0, v67
  v_add_f32 v64, 1.0, v64
  v_add_f32 v65, 1.0, v65
  v_add_f32 v66, 1.0, v66
  v_add_f32 v67, 1.0, v67
  v_cndmask_b32_e64 v64, v8, v64, s[40:41]
  v_cndmask_b32_e64 v65, v9, v65, s[42:43]
  v_cndmask_b32_e64 v66, v10, v66, s[44:45]
  v_cndmask_b32_e64 v67, v11, v67, s[46:47]
  v_add_f32 v64, 0x358637bd, v64
  v_add_f32 v65, 0x358637bd, v65
  v_add_f32 v66, 0x358637bd, v66
  v_add_f32 v67, 0x358637bd, v67
  v_cvt_pk_bf16_f32 v136, v64, v65
  v_cvt_pk_bf16_f32 v137, v66, v67
  v_fmac_f32 v84, v116, v128
  v_mul_f32 v84, v84, v124
  v_fmac_f32 v85, v117, v128
  v_mul_f32 v85, v85, v125
  v_fmac_f32 v86, v118, v128
  v_mul_f32 v86, v86, v126
  v_fmac_f32 v87, v119, v128
  v_mul_f32 v87, v87, v127
  v_mul_f32 v8, 0x3fb8aa3b, v84
  v_mul_f32 v9, 0x3fb8aa3b, v85
  v_mul_f32 v10, 0x3fb8aa3b, v86
  v_mul_f32 v11, 0x3fb8aa3b, v87
  v_exp_f32 v8, v8
  v_exp_f32 v9, v9
  v_exp_f32 v10, v10
  v_exp_f32 v11, v11
  v_cmp_lt_f32 s[40:41], 0, v84
  v_cmp_lt_f32 s[42:43], 0, v85
  v_cmp_lt_f32 s[44:45], 0, v86
  v_cmp_lt_f32 s[46:47], 0, v87
  v_add_f32 v84, 1.0, v84
  v_add_f32 v85, 1.0, v85
  v_add_f32 v86, 1.0, v86
  v_add_f32 v87, 1.0, v87
  v_cndmask_b32_e64 v84, v8, v84, s[40:41]
  v_cndmask_b32_e64 v85, v9, v85, s[42:43]
  v_cndmask_b32_e64 v86, v10, v86, s[44:45]
  v_cndmask_b32_e64 v87, v11, v87, s[46:47]
  v_add_f32 v84, 0x358637bd, v84
  v_add_f32 v85, 0x358637bd, v85
  v_add_f32 v86, 0x358637bd, v86
  v_add_f32 v87, 0x358637bd, v87
  v_cvt_pk_bf16_f32 v138, v84, v85
  v_cvt_pk_bf16_f32 v139, v86, v87
  v_fmac_f32 v68, v112, v129
  v_mul_f32 v68, v68, v120
  v_fmac_f32 v69, v113, v129
  v_mul_f32 v69, v69, v121
  v_fmac_f32 v70, v114, v129
  v_mul_f32 v70, v70, v122
  v_fmac_f32 v71, v115, v129
  v_mul_f32 v71, v71, v123
  v_mul_f32 v8, 0x3fb8aa3b, v68
  v_mul_f32 v9, 0x3fb8aa3b, v69
  v_mul_f32 v10, 0x3fb8aa3b, v70
  v_mul_f32 v11, 0x3fb8aa3b, v71
  v_exp_f32 v8, v8
  v_exp_f32 v9, v9
  v_exp_f32 v10, v10
  v_exp_f32 v11, v11
  v_cmp_lt_f32 s[40:41], 0, v68
  v_cmp_lt_f32 s[42:43], 0, v69
  v_cmp_lt_f32 s[44:45], 0, v70
  v_cmp_lt_f32 s[46:47], 0, v71
  v_add_f32 v68, 1.0, v68
  v_add_f32 v69, 1.0, v69
  v_add_f32 v70, 1.0, v70
  v_add_f32 v71, 1.0, v71
  v_cndmask_b32_e64 v68, v8, v68, s[40:41]
  v_cndmask_b32_e64 v69, v9, v69, s[42:43]
  v_cndmask_b32_e64 v70, v10, v70, s[44:45]
  v_cndmask_b32_e64 v71, v11, v71, s[46:47]
  v_add_f32 v68, 0x358637bd, v68
  v_add_f32 v69, 0x358637bd, v69
  v_add_f32 v70, 0x358637bd, v70
  v_add_f32 v71, 0x358637bd, v71
  v_cvt_pk_bf16_f32 v140, v68, v69
  v_cvt_pk_bf16_f32 v141, v70, v71
  v_fmac_f32 v88, v116, v129
  v_mul_f32 v88, v88, v124
  v_fmac_f32 v89, v117, v129
  v_mul_f32 v89, v89, v125
  v_fmac_f32 v90, v118, v129
  v_mul_f32 v90, v90, v126
  v_fmac_f32 v91, v119, v129
  v_mul_f32 v91, v91, v127
  v_mul_f32 v8, 0x3fb8aa3b, v88
  v_mul_f32 v9, 0x3fb8aa3b, v89
  v_mul_f32 v10, 0x3fb8aa3b, v90
  v_mul_f32 v11, 0x3fb8aa3b, v91
  v_exp_f32 v8, v8
  v_exp_f32 v9, v9
  v_exp_f32 v10, v10
  v_exp_f32 v11, v11
  v_cmp_lt_f32 s[40:41], 0, v88
  v_cmp_lt_f32 s[42:43], 0, v89
  v_cmp_lt_f32 s[44:45], 0, v90
  v_cmp_lt_f32 s[46:47], 0, v91
  v_add_f32 v88, 1.0, v88
  v_add_f32 v89, 1.0, v89
  v_add_f32 v90, 1.0, v90
  v_add_f32 v91, 1.0, v91
  v_cndmask_b32_e64 v88, v8, v88, s[40:41]
  v_cndmask_b32_e64 v89, v9, v89, s[42:43]
  v_cndmask_b32_e64 v90, v10, v90, s[44:45]
  v_cndmask_b32_e64 v91, v11, v91, s[46:47]
  v_add_f32 v88, 0x358637bd, v88
  v_add_f32 v89, 0x358637bd, v89
  v_add_f32 v90, 0x358637bd, v90
  v_add_f32 v91, 0x358637bd, v91
  v_cvt_pk_bf16_f32 v142, v88, v89
  v_cvt_pk_bf16_f32 v143, v90, v91
  v_fmac_f32 v72, v112, v130
  v_mul_f32 v72, v72, v120
  v_fmac_f32 v73, v113, v130
  v_mul_f32 v73, v73, v121
  v_fmac_f32 v74, v114, v130
  v_mul_f32 v74, v74, v122
  v_fmac_f32 v75, v115, v130
  v_mul_f32 v75, v75, v123
  v_cvt_pk_bf16_f32 v148, v72, v73
  v_cvt_pk_bf16_f32 v149, v74, v75
  v_mul_f32 v8, 0x3fb8aa3b, v72
  v_mul_f32 v9, 0x3fb8aa3b, v73
  v_mul_f32 v10, 0x3fb8aa3b, v74
  v_mul_f32 v11, 0x3fb8aa3b, v75
  v_exp_f32 v8, v8
  v_exp_f32 v9, v9
  v_exp_f32 v10, v10
  v_exp_f32 v11, v11
  v_cmp_lt_f32 s[40:41], 0, v72
  v_cmp_lt_f32 s[42:43], 0, v73
  v_cmp_lt_f32 s[44:45], 0, v74
  v_cmp_lt_f32 s[46:47], 0, v75
  v_add_f32 v72, 1.0, v72
  v_add_f32 v73, 1.0, v73
  v_add_f32 v74, 1.0, v74
  v_add_f32 v75, 1.0, v75
  v_cndmask_b32_e64 v72, v8, v72, s[40:41]
  v_cndmask_b32_e64 v73, v9, v73, s[42:43]
  v_cndmask_b32_e64 v74, v10, v74, s[44:45]
  v_cndmask_b32_e64 v75, v11, v75, s[46:47]
  v_add_f32 v72, 0x358637bd, v72
  v_add_f32 v73, 0x358637bd, v73
  v_add_f32 v74, 0x358637bd, v74
  v_add_f32 v75, 0x358637bd, v75
  v_cvt_pk_bf16_f32 v144, v72, v73
  v_cvt_pk_bf16_f32 v145, v74, v75
  v_fmac_f32 v92, v116, v130
  v_mul_f32 v92, v92, v124
  v_fmac_f32 v93, v117, v130
  v_mul_f32 v93, v93, v125
  v_fmac_f32 v94, v118, v130
  v_mul_f32 v94, v94, v126
  v_fmac_f32 v95, v119, v130
  v_mul_f32 v95, v95, v127
  v_cvt_pk_bf16_f32 v150, v92, v93
  v_cvt_pk_bf16_f32 v151, v94, v95
  v_mul_f32 v8, 0x3fb8aa3b, v92
  v_mul_f32 v9, 0x3fb8aa3b, v93
  v_mul_f32 v10, 0x3fb8aa3b, v94
  v_mul_f32 v11, 0x3fb8aa3b, v95
  v_exp_f32 v8, v8
  v_exp_f32 v9, v9
  v_exp_f32 v10, v10
  v_exp_f32 v11, v11
  v_cmp_lt_f32 s[40:41], 0, v92
  v_cmp_lt_f32 s[42:43], 0, v93
  v_cmp_lt_f32 s[44:45], 0, v94
  v_cmp_lt_f32 s[46:47], 0, v95
  v_add_f32 v92, 1.0, v92
  v_add_f32 v93, 1.0, v93
  v_add_f32 v94, 1.0, v94
  v_add_f32 v95, 1.0, v95
  v_cndmask_b32_e64 v92, v8, v92, s[40:41]
  v_cndmask_b32_e64 v93, v9, v93, s[42:43]
  v_cndmask_b32_e64 v94, v10, v94, s[44:45]
  v_cndmask_b32_e64 v95, v11, v95, s[46:47]
  v_add_f32 v92, 0x358637bd, v92
  v_add_f32 v93, 0x358637bd, v93
  v_add_f32 v94, 0x358637bd, v94
  v_add_f32 v95, 0x358637bd, v95
  v_cvt_pk_bf16_f32 v146, v92, v93
  v_cvt_pk_bf16_f32 v147, v94, v95
  v_fmac_f32 v76, v112, v131
  v_mul_f32 v76, v76, v120
  v_fmac_f32 v77, v113, v131
  v_mul_f32 v77, v77, v121
  v_fmac_f32 v78, v114, v131
  v_mul_f32 v78, v78, v122
  v_fmac_f32 v79, v115, v131
  v_mul_f32 v79, v79, v123
  v_cvt_pk_bf16_f32 v152, v76, v77
  v_cvt_pk_bf16_f32 v153, v78, v79
  v_fmac_f32 v96, v116, v131
  v_mul_f32 v96, v96, v124
  v_fmac_f32 v97, v117, v131
  v_mul_f32 v97, v97, v125
  v_fmac_f32 v98, v118, v131
  v_mul_f32 v98, v98, v126
  v_fmac_f32 v99, v119, v131
  v_mul_f32 v99, v99, v127
  v_cvt_pk_bf16_f32 v154, v96, v97
  v_cvt_pk_bf16_f32 v155, v98, v99
  v_fmac_f32 v80, v112, v132
  v_mul_f32 v80, v80, v120
  v_fmac_f32 v81, v113, v132
  v_mul_f32 v81, v81, v121
  v_fmac_f32 v82, v114, v132
  v_mul_f32 v82, v82, v122
  v_fmac_f32 v83, v115, v132
  v_mul_f32 v83, v83, v123
  v_cvt_pk_bf16_f32 v156, v80, v81
  v_cvt_pk_bf16_f32 v157, v82, v83
  v_fmac_f32 v100, v116, v132
  v_mul_f32 v100, v100, v124
  v_fmac_f32 v101, v117, v132
  v_mul_f32 v101, v101, v125
  v_fmac_f32 v102, v118, v132
  v_mul_f32 v102, v102, v126
  v_fmac_f32 v103, v119, v132
  v_mul_f32 v103, v103, v127
  v_cvt_pk_bf16_f32 v158, v100, v101
  v_cvt_pk_bf16_f32 v159, v102, v103
  v_mov_b32 v160, 0x3f803f80
  v_mov_b32 v161, 0x3f803f80
  v_mov_b32 v162, 0x3f803f80
  v_mov_b32 v163, 0x3f803f80
  s_nop 1
  v_mfma_f32_16x16x32_bf16 v[64:67], v[136:139], v[148:151], 0
  v_mfma_f32_16x16x32_bf16 v[68:71], v[136:139], v[152:155], 0
  v_mfma_f32_16x16x32_bf16 v[72:75], v[140:143], v[148:151], 0
  v_mfma_f32_16x16x32_bf16 v[76:79], v[140:143], v[152:155], 0
  v_mfma_f32_16x16x32_bf16 v[80:83], v[140:143], v[156:159], 0
  v_mfma_f32_16x16x32_bf16 v[84:87], v[144:147], v[152:155], 0
  v_mfma_f32_16x16x32_bf16 v[88:91], v[144:147], v[156:159], 0
  v_mfma_f32_16x16x32_bf16 v[92:95], v[136:139], v[160:163], 0
  v_mfma_f32_16x16x32_bf16 v[96:99], v[140:143], v[160:163], 0
  v_mfma_f32_16x16x32_bf16 v[100:103], v[144:147], v[160:163], 0
  s_mul_i32 s34, s14, 12288
  v_lshl_add_u32 v18, v0, 4, s34
  s_nop 7
  ds_write_b128 v18, v[64:67] offset:0
  ds_write_b128 v18, v[68:71] offset:1024
  ds_write_b128 v18, v[72:75] offset:4096
  ds_write_b128 v18, v[76:79] offset:5120
  ds_write_b128 v18, v[80:83] offset:6144
  ds_write_b128 v18, v[84:87] offset:9216
  ds_write_b128 v18, v[88:91] offset:10240
  ds_write_b128 v18, v[92:95] offset:3072
  ds_write_b128 v18, v[96:99] offset:7168
  ds_write_b128 v18, v[100:103] offset:11264
  s_branch k1_join
k1_qmain:
  ds_read_b128 v[8:11], v4 offset:0
  ds_read_b128 v[12:15], v4 offset:2048
  ds_read_b64_tr_b16 v[24:25], v6 offset:160
  ds_read_b64_tr_b16 v[26:27], v6 offset:400
  ds_read_b64_tr_b16 v[28:29], v6 offset:192
  ds_read_b64_tr_b16 v[30:31], v6 offset:432
  ds_read_b64_tr_b16 v[32:33], v6 offset:224
  ds_read_b64_tr_b16 v[34:35], v6 offset:464
  ds_read_b64_tr_b16 v[36:37], v7 offset:0
  ds_read_b64_tr_b16 v[38:39], v7 offset:240
  ds_read_b64_tr_b16 v[40:41], v7 offset:32
  ds_read_b64_tr_b16 v[42:43], v7 offset:272
  ds_read_b128 v[16:19], v5 offset:0
  ds_read_b128 v[20:23], v5 offset:2048
  ds_read_b64_tr_b16 v[44:45], v6 offset:7840
  ds_read_b64_tr_b16 v[46:47], v6 offset:8080
  ds_read_b64_tr_b16 v[48:49], v6 offset:7872
  ds_read_b64_tr_b16 v[50:51], v6 offset:8112
  ds_read_b64_tr_b16 v[52:53], v6 offset:7904
  ds_read_b64_tr_b16 v[54:55], v6 offset:8144
  ds_read_b64_tr_b16 v[56:57], v7 offset:7680
  ds_read_b64_tr_b16 v[58:59], v7 offset:7920
  ds_read_b64_tr_b16 v[60:61], v7 offset:7712
  ds_read_b64_tr_b16 v[62:63], v7 offset:7952
  s_add_u32 s64, s62, 2
  s_cmp_ge_u32 s64, 9
  s_cselect_b32 s65, 9, 0
  s_sub_u32 s64, s64, s65
  s_lshl_b32 s65, s64, 7
  s_mul_i32 s64, s64, 221184
  s_cmp_eq_u32 s3, 7
  s_cbranch_scc1 k1_sk12
  s_add_u32 m0, s32, 88064
  s_mov_b32 s34, s64
  buffer_load_dwordx4 v3, s[20:23], s34 offen lds
k1_sk12:
  s_add_u32 m0, s32, 79872
  s_mov_b32 s34, s64
  buffer_load_dwordx4 v2, s[20:23], s34 offen lds
  s_add_u32 m0, s32, 63488
  s_add_u32 s34, s65, 0
  buffer_load_dwordx4 v1, s[16:19], s34 offen lds
  s_add_u32 m0, s32, 71680
  s_add_u32 s34, s65, 73728
  buffer_load_dwordx4 v1, s[16:19], s34 offen lds
  s_waitcnt lgkmcnt(12)
  v_mfma_f32_16x16x32_bf16 v[64:67], v[24:27], v[8:11], 0
  v_mfma_f32_16x16x32_bf16 v[76:79], v[24:27], v[12:15], 0
  v_mfma_f32_16x16x32_bf16 v[68:71], v[28:31], v[8:11], 0
  v_mfma_f32_16x16x32_bf16 v[80:83], v[28:31], v[12:15], 0
  v_mfma_f32_16x16x32_bf16 v[72:75], v[32:35], v[8:11], 0
  v_mfma_f32_16x16x32_bf16 v[84:87], v[32:35], v[12:15], 0
  v_mfma_f32_16x16x32_bf16 v[164:167], v[188:191], v[8:11], 0
  v_mfma_f32_16x16x32_bf16 v[172:175], v[8:11], v[8:11], 0
  v_mfma_f32_16x16x32_bf16 v[180:183], v[188:191], v[36:39], 0
  v_mfma_f32_16x16x32_bf16 v[168:171], v[188:191], v[12:15], 0
  v_mfma_f32_16x16x32_bf16 v[176:179], v[12:15], v[12:15], 0
  v_mfma_f32_16x16x32_bf16 v[184:187], v[188:191], v[40:43], 0
  s_waitcnt lgkmcnt(0)
  s_waitcnt vmcnt(3)
  s_barrier
  v_add_u32 v4, 31744, v4
  v_add_u32 v5, 31744, v5
  v_add_u32 v6, 31744, v6
  v_add_u32 v7, 31744, v7
  ds_read_b128 v[8:11], v4 offset:0
  ds_read_b128 v[12:15], v4 offset:2048
  ds_read_b64_tr_b16 v[24:25], v6 offset:160
  ds_read_b64_tr_b16 v[26:27], v6 offset:400
  ds_read_b64_tr_b16 v[28:29], v6 offset:192
  ds_read_b64_tr_b16 v[30:31], v6 offset:432
  ds_read_b64_tr_b16 v[32:33], v6 offset:224
  ds_read_b64_tr_b16 v[34:35], v6 offset:464
  ds_read_b64_tr_b16 v[36:37], v7 offset:0
  ds_read_b64_tr_b16 v[38:39], v7 offset:240
  ds_read_b64_tr_b16 v[40:41], v7 offset:32
  ds_read_b64_tr_b16 v[42:43], v7 offset:272
  s_add_u32 s64, s62, 3
  s_cmp_ge_u32 s64, 9
  s_cselect_b32 s65, 9, 0
  s_sub_u32 s64, s64, s65
  s_lshl_b32 s65, s64, 7
  s_mul_i32 s64, s64, 221184
  s_cmp_eq_u32 s3, 7
  s_cbranch_scc1 k1_sk13
  s_add_u32 m0, s32, 119808
  s_mov_b32 s34, s64
  buffer_load_dwordx4 v3, s[20:23], s34 offen lds
k1_sk13:
  s_add_u32 m0, s32, 111616
  s_mov_b32 s34, s64
  buffer_load_dwordx4 v2, s[20:23], s34 offen lds
  s_add_u32 m0, s32, 95232
  s_add_u32 s34, s65, 0
  buffer_load_dwordx4 v1, s[16:19], s34 offen lds
  s_add_u32 m0, s32, 103424
  s_add_u32 s34, s65, 73728
  buffer_load_dwordx4 v1, s[16:19], s34 offen lds
  v_mfma_f32_16x16x32_bf16 v[64:67], v[44:47], v[16:19], v[64:67]
  v_mfma_f32_16x16x32_bf16 v[76:79], v[44:47], v[20:23], v[76:79]
  v_mfma_f32_16x16x32_bf16 v[68:71], v[48:51], v[16:19], v[68:71]
  v_mfma_f32_16x16x32_bf16 v[80:83], v[48:51], v[20:23], v[80:83]
  v_mfma_f32_16x16x32_bf16 v[72:75], v[52:55], v[16:19], v[72:75]
  v_mfma_f32_16x16x32_bf16 v[84:87], v[52:55], v[20:23], v[84:87]
  v_mfma_f32_16x16x32_bf16 v[164:167], v[188:191], v[16:19], v[164:167]
  v_mfma_f32_16x16x32_bf16 v[172:175], v[16:19], v[16:19], v[172:175]
  v_mfma_f32_16x16x32_bf16 v[180:183], v[188:191], v[56:59], v[180:183]
  v_mfma_f32_16x16x32_bf16 v[168:171], v[188:191], v[20:23], v[168:171]
  v_mfma_f32_16x16x32_bf16 v[176:179], v[20:23], v[20:23], v[176:179]
  v_mfma_f32_16x16x32_bf16 v[184:187], v[188:191], v[60:63], v[184:187]
  ds_read_b128 v[16:19], v5 offset:0
  ds_read_b128 v[20:23], v5 offset:2048
  ds_read_b64_tr_b16 v[44:45], v6 offset:7840
  ds_read_b64_tr_b16 v[46:47], v6 offset:8080
  ds_read_b64_tr_b16 v[48:49], v6 offset:7872
  ds_read_b64_tr_b16 v[50:51], v6 offset:8112
  ds_read_b64_tr_b16 v[52:53], v6 offset:7904
  ds_read_b64_tr_b16 v[54:55], v6 offset:8144
  ds_read_b64_tr_b16 v[56:57], v7 offset:7680
  ds_read_b64_tr_b16 v[58:59], v7 offset:7920
  ds_read_b64_tr_b16 v[60:61], v7 offset:7712
  ds_read_b64_tr_b16 v[62:63], v7 offset:7952
  s_add_u32 s64, s62, 4
  s_cmp_ge_u32 s64, 9
  s_cselect_b32 s65, 9, 0
  s_sub_u32 s64, s64, s65
  s_lshl_b32 s65, s64, 7
  s_mul_i32 s64, s64, 221184
  s_cmp_eq_u32 s3, 7
  s_cbranch_scc1 k1_sk14
  s_add_u32 m0, s32, 151552
  s_mov_b32 s34, s64
  buffer_load_dwordx4 v3, s[20:23], s34 offen lds
k1_sk14:
  s_add_u32 m0, s32, 143360
  s_mov_b32 s34, s64
  buffer_load_dwordx4 v2, s[20:23], s34 offen lds
  s_add_u32 m0, s32, 126976
  s_add_u32 s34, s65, 0
  buffer_load_dwordx4 v1, s[16:19], s34 offen lds
  s_add_u32 m0, s32, 135168
  s_add_u32 s34, s65, 73728
  buffer_load_dwordx4 v1, s[16:19], s34 offen lds
  s_waitcnt lgkmcnt(12)
  v_mfma_f32_16x16x32_bf16 v[64:67], v[24:27], v[8:11], v[64:67]
  v_mfma_f32_16x16x32_bf16 v[76:79], v[24:27], v[12:15], v[76:79]
  v_mfma_f32_16x16x32_bf16 v[68:71], v[28:31], v[8:11], v[68:71]
  v_mfma_f32_16x16x32_bf16 v[80:83], v[28:31], v[12:15], v[80:83]
  v_mfma_f32_16x16x32_bf16 v[72:75], v[32:35], v[8:11], v[72:75]
  v_mfma_f32_16x16x32_bf16 v[84:87], v[32:35], v[12:15], v[84:87]
  v_mfma_f32_16x16x32_bf16 v[164:167], v[188:191], v[8:11], v[164:167]
  v_mfma_f32_16x16x32_bf16 v[172:175], v[8:11], v[8:11], v[172:175]
  v_mfma_f32_16x16x32_bf16 v[180:183], v[188:191], v[36:39], v[180:183]
  v_mfma_f32_16x16x32_bf16 v[168:171], v[188:191], v[12:15], v[168:171]
  v_mfma_f32_16x16x32_bf16 v[176:179], v[12:15], v[12:15], v[176:179]
  v_mfma_f32_16x16x32_bf16 v[184:187], v[188:191], v[40:43], v[184:187]
  s_waitcnt lgkmcnt(0)
  s_waitcnt vmcnt(6)
  s_barrier
  v_add_u32 v4, 31744, v4
  v_add_u32 v5, 31744, v5
  v_add_u32 v6, 31744, v6
  v_add_u32 v7, 31744, v7
  ds_read_b128 v[8:11], v4 offset:0
  ds_read_b128 v[12:15], v4 offset:2048
  ds_read_b64_tr_b16 v[24:25], v6 offset:160
  ds_read_b64_tr_b16 v[26:27], v6 offset:400
  ds_read_b64_tr_b16 v[28:29], v6 offset:192
  ds_read_b64_tr_b16 v[30:31], v6 offset:432
  ds_read_b64_tr_b16 v[32:33], v6 offset:224
  ds_read_b64_tr_b16 v[34:35], v6 offset:464
  ds_read_b64_tr_b16 v[36:37], v7 offset:0
  ds_read_b64_tr_b16 v[38:39], v7 offset:240
  ds_read_b64_tr_b16 v[40:41], v7 offset:32
  ds_read_b64_tr_b16 v[42:43], v7 offset:272
  s_add_u32 s64, s62, 5
  s_cmp_ge_u32 s64, 9
  s_cselect_b32 s65, 9, 0
  s_sub_u32 s64, s64, s65
  s_lshl_b32 s65, s64, 7
  s_mul_i32 s64, s64, 221184
  s_cmp_eq_u32 s3, 7
  s_cbranch_scc1 k1_sk15
  s_add_u32 m0, s32, 24576
  s_mov_b32 s34, s64
  buffer_load_dwordx4 v3, s[20:23], s34 offen lds
k1_sk15:
  s_add_u32 m0, s32, 16384
  s_mov_b32 s34, s64
  buffer_load_dwordx4 v2, s[20:23], s34 offen lds
  s_add_u32 m0, s32, 0
  s_add_u32 s34, s65, 0
  buffer_load_dwordx4 v1, s[16:19], s34 offen lds
  s_add_u32 m0, s32, 8192
  s_add_u32 s34, s65, 73728
  buffer_load_dwordx4 v1, s[16:19], s34 offen lds
  v_mfma_f32_16x16x32_bf16 v[64:67], v[44:47], v[16:19], v[64:67]
  v_mfma_f32_16x16x32_bf16 v[76:79], v[44:47], v[20:23], v[76:79]
  v_mfma_f32_16x16x32_bf16 v[68:71], v[48:51], v[16:19], v[68:71]
  v_mfma_f32_16x16x32_bf16 v[80:83], v[48:51], v[20:23], v[80:83]
  v_mfma_f32_16x16x32_bf16 v[72:75], v[52:55], v[16:19], v[72:75]
  v_mfma_f32_16x16x32_bf16 v[84:87], v[52:55], v[20:23], v[84:87]
  v_mfma_f32_16x16x32_bf16 v[164:167], v[188:191], v[16:19], v[164:167]
  v_mfma_f32_16x16x32_bf16 v[172:175], v[16:19], v[16:19], v[172:175]
  v_mfma_f32_16x16x32_bf16 v[180:183], v[188:191], v[56:59], v[180:183]
  v_mfma_f32_16x16x32_bf16 v[168:171], v[188:191], v[20:23], v[168:171]
  v_mfma_f32_16x16x32_bf16 v[176:179], v[20:23], v[20:23], v[176:179]
  v_mfma_f32_16x16x32_bf16 v[184:187], v[188:191], v[60:63], v[184:187]
  ds_read_b128 v[16:19], v5 offset:0
  ds_read_b128 v[20:23], v5 offset:2048
  ds_read_b64_tr_b16 v[44:45], v6 offset:7840
  ds_read_b64_tr_b16 v[46:47], v6 offset:8080
  ds_read_b64_tr_b16 v[48:49], v6 offset:7872
  ds_read_b64_tr_b16 v[50:51], v6 offset:8112
  ds_read_b64_tr_b16 v[52:53], v6 offset:7904
  ds_read_b64_tr_b16 v[54:55], v6 offset:8144
  ds_read_b64_tr_b16 v[56:57], v7 offset:7680
  ds_read_b64_tr_b16 v[58:59], v7 offset:7920
  ds_read_b64_tr_b16 v[60:61], v7 offset:7712
  ds_read_b64_tr_b16 v[62:63], v7 offset:7952
  s_add_u32 s64, s62, 6
  s_cmp_ge_u32 s64, 9
  s_cselect_b32 s65, 9, 0
  s_sub_u32 s64, s64, s65
  s_lshl_b32 s65, s64, 7
  s_mul_i32 s64, s64, 221184
  s_cmp_eq_u32 s3, 7
  s_cbranch_scc1 k1_sk16
  s_add_u32 m0, s32, 56320
  s_mov_b32 s34, s64
  buffer_load_dwordx4 v3, s[20:23], s34 offen lds
k1_sk16:
  s_add_u32 m0, s32, 48128
  s_mov_b32 s34, s64
  buffer_load_dwordx4 v2, s[20:23], s34 offen lds
  s_add_u32 m0, s32, 31744
  s_add_u32 s34, s65, 0
  buffer_load_dwordx4 v1, s[16:19], s34 offen lds
  s_add_u32 m0, s32, 39936
  s_add_u32 s34, s65, 73728
  buffer_load_dwordx4 v1, s[16:19], s34 offen lds
  s_mov_b32 m0, 160768
  s_cmp_ge_u32 s3, 3
  s_cbranch_scc1 k1_pf17
  buffer_load_dwordx4 v110, s[48:51], s61 offen lds
k1_pf17:
  s_waitcnt lgkmcnt(12)
  v_mfma_f32_16x16x32_bf16 v[64:67], v[24:27], v[8:11], v[64:67]
  v_mfma_f32_16x16x32_bf16 v[76:79], v[24:27], v[12:15], v[76:79]
  v_mfma_f32_16x16x32_bf16 v[68:71], v[28:31], v[8:11], v[68:71]
  v_mfma_f32_16x16x32_bf16 v[80:83], v[28:31], v[12:15], v[80:83]
  v_mfma_f32_16x16x32_bf16 v[72:75], v[32:35], v[8:11], v[72:75]
  v_mfma_f32_16x16x32_bf16 v[84:87], v[32:35], v[12:15], v[84:87]
  v_mfma_f32_16x16x32_bf16 v[164:167], v[188:191], v[8:11], v[164:167]
  v_mfma_f32_16x16x32_bf16 v[172:175], v[8:11], v[8:11], v[172:175]
  v_mfma_f32_16x16x32_bf16 v[180:183], v[188:191], v[36:39], v[180:183]
  v_mfma_f32_16x16x32_bf16 v[168:171], v[188:191], v[12:15], v[168:171]
  v_mfma_f32_16x16x32_bf16 v[176:179], v[12:15], v[12:15], v[176:179]
  v_mfma_f32_16x16x32_bf16 v[184:187], v[188:191], v[40:43], v[184:187]
  s_waitcnt lgkmcnt(0)
  s_waitcnt vmcnt(9)
  s_barrier
  v_add_u32 v4, 31744, v4
  v_add_u32 v5, 31744, v5
  v_add_u32 v6, 31744, v6
  v_add_u32 v7, 31744, v7
  ds_read_b128 v[8:11], v4 offset:0
  ds_read_b128 v[12:15], v4 offset:2048
  ds_read_b64_tr_b16 v[24:25], v6 offset:160
  ds_read_b64_tr_b16 v[26:27], v6 offset:400
  ds_read_b64_tr_b16 v[28:29], v6 offset:192
  ds_read_b64_tr_b16 v[30:31], v6 offset:432
  ds_read_b64_tr_b16 v[32:33], v6 offset:224
  ds_read_b64_tr_b16 v[34:35], v6 offset:464
  ds_read_b64_tr_b16 v[36:37], v7 offset:0
  ds_read_b64_tr_b16 v[38:39], v7 offset:240
  ds_read_b64_tr_b16 v[40:41], v7 offset:32
  ds_read_b64_tr_b16 v[42:43], v7 offset:272
  s_add_u32 s64, s62, 7
  s_cmp_ge_u32 s64, 9
  s_cselect_b32 s65, 9, 0
  s_sub_u32 s64, s64, s65
  s_lshl_b32 s65, s64, 7
  s_mul_i32 s64, s64, 221184
  s_cmp_eq_u32 s3, 7
  s_cbranch_scc1 k1_sk18
  s_add_u32 m0, s32, 88064
  s_mov_b32 s34, s64
  buffer_load_dwordx4 v3, s[20:23], s34 offen lds
k1_sk18:
  s_add_u32 m0, s32, 79872
  s_mov_b32 s34, s64
  buffer_load_dwordx4 v2, s[20:23], s34 offen lds
  s_add_u32 m0, s32, 63488
  s_add_u32 s34, s65, 0
  buffer_load_dwordx4 v1, s[16:19], s34 offen lds
  s_add_u32 m0, s32, 71680
  s_add_u32 s34, s65, 73728
  buffer_load_dwordx4 v1, s[16:19], s34 offen lds
  v_mfma_f32_16x16x32_bf16 v[64:67], v[44:47], v[16:19], v[64:67]
  v_mfma_f32_16x16x32_bf16 v[76:79], v[44:47], v[20:23], v[76:79]
  v_mfma_f32_16x16x32_bf16 v[68:71], v[48:51], v[16:19], v[68:71]
  v_mfma_f32_16x16x32_bf16 v[80:83], v[48:51], v[20:23], v[80:83]
  v_mfma_f32_16x16x32_bf16 v[72:75], v[52:55], v[16:19], v[72:75]
  v_mfma_f32_16x16x32_bf16 v[84:87], v[52:55], v[20:23], v[84:87]
  v_mfma_f32_16x16x32_bf16 v[164:167], v[188:191], v[16:19], v[164:167]
  v_mfma_f32_16x16x32_bf16 v[172:175], v[16:19], v[16:19], v[172:175]
  v_mfma_f32_16x16x32_bf16 v[180:183], v[188:191], v[56:59], v[180:183]
  v_mfma_f32_16x16x32_bf16 v[168:171], v[188:191], v[20:23], v[168:171]
  v_mfma_f32_16x16x32_bf16 v[176:179], v[20:23], v[20:23], v[176:179]
  v_mfma_f32_16x16x32_bf16 v[184:187], v[188:191], v[60:63], v[184:187]
  ds_read_b128 v[16:19], v5 offset:0
  ds_read_b128 v[20:23], v5 offset:2048
  ds_read_b64_tr_b16 v[44:45], v6 offset:7840
  ds_read_b64_tr_b16 v[46:47], v6 offset:8080
  ds_read_b64_tr_b16 v[48:49], v6 offset:7872
  ds_read_b64_tr_b16 v[50:51], v6 offset:8112
  ds_read_b64_tr_b16 v[52:53], v6 offset:7904
  ds_read_b64_tr_b16 v[54:55], v6 offset:8144
  ds_read_b64_tr_b16 v[56:57], v7 offset:7680
  ds_read_b64_tr_b16 v[58:59], v7 offset:7920
  ds_read_b64_tr_b16 v[60:61], v7 offset:7712
  ds_read_b64_tr_b16 v[62:63], v7 offset:7952
  s_waitcnt lgkmcnt(12)
  v_mfma_f32_16x16x32_bf16 v[64:67], v[24:27], v[8:11], v[64:67]
  v_mfma_f32_16x16x32_bf16 v[76:79], v[24:27], v[12:15], v[76:79]
  v_mfma_f32_16x16x32_bf16 v[68:71], v[28:31], v[8:11], v[68:71]
  v_mfma_f32_16x16x32_bf16 v[80:83], v[28:31], v[12:15], v[80:83]
  v_mfma_f32_16x16x32_bf16 v[72:75], v[32:35], v[8:11], v[72:75]
  v_mfma_f32_16x16x32_bf16 v[84:87], v[32:35], v[12:15], v[84:87]
  v_mfma_f32_16x16x32_bf16 v[164:167], v[188:191], v[8:11], v[164:167]
  v_mfma_f32_16x16x32_bf16 v[172:175], v[8:11], v[8:11], v[172:175]
  v_mfma_f32_16x16x32_bf16 v[180:183], v[188:191], v[36:39], v[180:183]
  v_mfma_f32_16x16x32_bf16 v[168:171], v[188:191], v[12:15], v[168:171]
  v_mfma_f32_16x16x32_bf16 v[176:179], v[12:15], v[12:15], v[176:179]
  v_mfma_f32_16x16x32_bf16 v[184:187], v[188:191], v[40:43], v[184:187]
  s_waitcnt lgkmcnt(0)
  s_waitcnt vmcnt(9)
  s_barrier
  v_add_u32 v4, 31744, v4
  v_add_u32 v5, 31744, v5
  v_add_u32 v6, 31744, v6
  v_add_u32 v7, 31744, v7
  ds_read_b128 v[8:11], v4 offset:0
  ds_read_b128 v[12:15], v4 offset:2048
  ds_read_b64_tr_b16 v[24:25], v6 offset:160
  ds_read_b64_tr_b16 v[26:27], v6 offset:400
  ds_read_b64_tr_b16 v[28:29], v6 offset:192
  ds_read_b64_tr_b16 v[30:31], v6 offset:432
  ds_read_b64_tr_b16 v[32:33], v6 offset:224
  ds_read_b64_tr_b16 v[34:35], v6 offset:464
  ds_read_b64_tr_b16 v[36:37], v7 offset:0
  ds_read_b64_tr_b16 v[38:39], v7 offset:240
  ds_read_b64_tr_b16 v[40:41], v7 offset:32
  ds_read_b64_tr_b16 v[42:43], v7 offset:272
  s_add_u32 s64, s62, 8
  s_cmp_ge_u32 s64, 9
  s_cselect_b32 s65, 9, 0
  s_sub_u32 s64, s64, s65
  s_lshl_b32 s65, s64, 7
  s_mul_i32 s64, s64, 221184
  s_cmp_eq_u32 s3, 7
  s_cbranch_scc1 k1_sk19
  s_add_u32 m0, s32, 119808
  s_mov_b32 s34, s64
  buffer_load_dwordx4 v3, s[20:23], s34 offen lds
k1_sk19:
  s_add_u32 m0, s32, 111616
  s_mov_b32 s34, s64
  buffer_load_dwordx4 v2, s[20:23], s34 offen lds
  s_add_u32 m0, s32, 95232
  s_add_u32 s34, s65, 0
  buffer_load_dwordx4 v1, s[16:19], s34 offen lds
  s_add_u32 m0, s32, 103424
  s_add_u32 s34, s65, 73728
  buffer_load_dwordx4 v1, s[16:19], s34 offen lds
  v_mfma_f32_16x16x32_bf16 v[64:67], v[44:47], v[16:19], v[64:67]
  v_mfma_f32_16x16x32_bf16 v[76:79], v[44:47], v[20:23], v[76:79]
  v_mfma_f32_16x16x32_bf16 v[68:71], v[48:51], v[16:19], v[68:71]
  v_mfma_f32_16x16x32_bf16 v[80:83], v[48:51], v[20:23], v[80:83]
  v_mfma_f32_16x16x32_bf16 v[72:75], v[52:55], v[16:19], v[72:75]
  v_mfma_f32_16x16x32_bf16 v[84:87], v[52:55], v[20:23], v[84:87]
  v_mfma_f32_16x16x32_bf16 v[164:167], v[188:191], v[16:19], v[164:167]
  v_mfma_f32_16x16x32_bf16 v[172:175], v[16:19], v[16:19], v[172:175]
  v_mfma_f32_16x16x32_bf16 v[180:183], v[188:191], v[56:59], v[180:183]
  v_mfma_f32_16x16x32_bf16 v[168:171], v[188:191], v[20:23], v[168:171]
  v_mfma_f32_16x16x32_bf16 v[176:179], v[20:23], v[20:23], v[176:179]
  v_mfma_f32_16x16x32_bf16 v[184:187], v[188:191], v[60:63], v[184:187]
  ds_read_b128 v[16:19], v5 offset:0
  ds_read_b128 v[20:23], v5 offset:2048
  ds_read_b64_tr_b16 v[44:45], v6 offset:7840
  ds_read_b64_tr_b16 v[46:47], v6 offset:8080
  ds_read_b64_tr_b16 v[48:49], v6 offset:7872
  ds_read_b64_tr_b16 v[50:51], v6 offset:8112
  ds_read_b64_tr_b16 v[52:53], v6 offset:7904
  ds_read_b64_tr_b16 v[54:55], v6 offset:8144
  ds_read_b64_tr_b16 v[56:57], v7 offset:7680
  ds_read_b64_tr_b16 v[58:59], v7 offset:7920
  ds_read_b64_tr_b16 v[60:61], v7 offset:7712
  ds_read_b64_tr_b16 v[62:63], v7 offset:7952
  s_waitcnt lgkmcnt(12)
  v_mfma_f32_16x16x32_bf16 v[64:67], v[24:27], v[8:11], v[64:67]
  v_mfma_f32_16x16x32_bf16 v[76:79], v[24:27], v[12:15], v[76:79]
  v_mfma_f32_16x16x32_bf16 v[68:71], v[28:31], v[8:11], v[68:71]
  v_mfma_f32_16x16x32_bf16 v[80:83], v[28:31], v[12:15], v[80:83]
  v_mfma_f32_16x16x32_bf16 v[72:75], v[32:35], v[8:11], v[72:75]
  v_mfma_f32_16x16x32_bf16 v[84:87], v[32:35], v[12:15], v[84:87]
  v_mfma_f32_16x16x32_bf16 v[164:167], v[188:191], v[8:11], v[164:167]
  v_mfma_f32_16x16x32_bf16 v[172:175], v[8:11], v[8:11], v[172:175]
  v_mfma_f32_16x16x32_bf16 v[180:183], v[188:191], v[36:39], v[180:183]
  v_mfma_f32_16x16x32_bf16 v[168:171], v[188:191], v[12:15], v[168:171]
  v_mfma_f32_16x16x32_bf16 v[176:179], v[12:15], v[12:15], v[176:179]
  v_mfma_f32_16x16x32_bf16 v[184:187], v[188:191], v[40:43], v[184:187]
  s_waitcnt lgkmcnt(0)
  s_waitcnt vmcnt(9)
  s_barrier
  v_add_u32 v4, 4294840320, v4
  v_add_u32 v5, 4294840320, v5
  v_add_u32 v6, 4294840320, v6
  v_add_u32 v7, 4294840320, v7
  ds_read_b128 v[8:11], v4 offset:0
  ds_read_b128 v[12:15], v4 offset:2048
  ds_read_b64_tr_b16 v[24:25], v6 offset:160
  ds_read_b64_tr_b16 v[26:27], v6 offset:400
  ds_read_b64_tr_b16 v[28:29], v6 offset:192
  ds_read_b64_tr_b16 v[30:31], v6 offset:432
  ds_read_b64_tr_b16 v[32:33], v6 offset:224
  ds_read_b64_tr_b16 v[34:35], v6 offset:464
  ds_read_b64_tr_b16 v[36:37], v7 offset:0
  ds_read_b64_tr_b16 v[38:39], v7 offset:240
  ds_read_b64_tr_b16 v[40:41], v7 offset:32
  ds_read_b64_tr_b16 v[42:43], v7 offset:272
  v_mfma_f32_16x16x32_bf16 v[64:67], v[44:47], v[16:19], v[64:67]
  v_mfma_f32_16x16x32_bf16 v[76:79], v[44:47], v[20:23], v[76:79]
  v_mfma_f32_16x16x32_bf16 v[68:71], v[48:51], v[16:19], v[68:71]
  v_mfma_f32_16x16x32_bf16 v[80:83], v[48:51], v[20:23], v[80:83]
  v_mfma_f32_16x16x32_bf16 v[72:75], v[52:55], v[16:19], v[72:75]
  v_mfma_f32_16x16x32_bf16 v[84:87], v[52:55], v[20:23], v[84:87]
  v_mfma_f32_16x16x32_bf16 v[164:167], v[188:191], v[16:19], v[164:167]
  v_mfma_f32_16x16x32_bf16 v[172:175], v[16:19], v[16:19], v[172:175]
  v_mfma_f32_16x16x32_bf16 v[180:183], v[188:191], v[56:59], v[180:183]
  v_mfma_f32_16x16x32_bf16 v[168:171], v[188:191], v[20:23], v[168:171]
  v_mfma_f32_16x16x32_bf16 v[176:179], v[20:23], v[20:23], v[176:179]
  v_mfma_f32_16x16x32_bf16 v[184:187], v[188:191], v[60:63], v[184:187]
  ds_read_b128 v[16:19], v5 offset:0
  ds_read_b128 v[20:23], v5 offset:2048
  ds_read_b64_tr_b16 v[44:45], v6 offset:7840
  ds_read_b64_tr_b16 v[46:47], v6 offset:8080
  ds_read_b64_tr_b16 v[48:49], v6 offset:7872
  ds_read_b64_tr_b16 v[50:51], v6 offset:8112
  ds_read_b64_tr_b16 v[52:53], v6 offset:7904
  ds_read_b64_tr_b16 v[54:55], v6 offset:8144
  ds_read_b64_tr_b16 v[56:57], v7 offset:7680
  ds_read_b64_tr_b16 v[58:59], v7 offset:7920
  ds_read_b64_tr_b16 v[60:61], v7 offset:7712
  ds_read_b64_tr_b16 v[62:63], v7 offset:7952
  s_mov_b32 m0, 160768
  s_nop 0
  buffer_load_dword v105, s[24:27], s72 offen lds
  s_waitcnt lgkmcnt(12)
  v_mfma_f32_16x16x32_bf16 v[64:67], v[24:27], v[8:11], v[64:67]
  v_mfma_f32_16x16x32_bf16 v[76:79], v[24:27], v[12:15], v[76:79]
  v_mfma_f32_16x16x32_bf16 v[68:71], v[28:31], v[8:11], v[68:71]
  v_mfma_f32_16x16x32_bf16 v[80:83], v[28:31], v[12:15], v[80:83]
  v_mfma_f32_16x16x32_bf16 v[72:75], v[32:35], v[8:11], v[72:75]
  v_mfma_f32_16x16x32_bf16 v[84:87], v[32:35], v[12:15], v[84:87]
  v_mfma_f32_16x16x32_bf16 v[164:167], v[188:191], v[8:11], v[164:167]
  v_mfma_f32_16x16x32_bf16 v[172:175], v[8:11], v[8:11], v[172:175]
  v_mfma_f32_16x16x32_bf16 v[180:183], v[188:191], v[36:39], v[180:183]
  v_mfma_f32_16x16x32_bf16 v[168:171], v[188:191], v[12:15], v[168:171]
  v_mfma_f32_16x16x32_bf16 v[176:179], v[12:15], v[12:15], v[176:179]
  v_mfma_f32_16x16x32_bf16 v[184:187], v[188:191], v[40:43], v[184:187]
  s_waitcnt lgkmcnt(0)
  s_waitcnt vmcnt(7)
  s_barrier
  v_add_u32 v4, 31744, v4
  v_add_u32 v5, 31744, v5
  v_add_u32 v6, 31744, v6
  v_add_u32 v7, 31744, v7
  ds_read_b128 v[8:11], v4 offset:0
  ds_read_b128 v[12:15], v4 offset:2048
  ds_read_b64_tr_b16 v[24:25], v6 offset:160
  ds_read_b64_tr_b16 v[26:27], v6 offset:400
  ds_read_b64_tr_b16 v[28:29], v6 offset:192
  ds_read_b64_tr_b16 v[30:31], v6 offset:432
  ds_read_b64_tr_b16 v[32:33], v6 offset:224
  ds_read_b64_tr_b16 v[34:35], v6 offset:464
  ds_read_b64_tr_b16 v[36:37], v7 offset:0
  ds_read_b64_tr_b16 v[38:39], v7 offset:240
  ds_read_b64_tr_b16 v[40:41], v7 offset:32
  ds_read_b64_tr_b16 v[42:43], v7 offset:272
  v_mfma_f32_16x16x32_bf16 v[64:67], v[44:47], v[16:19], v[64:67]
  v_mfma_f32_16x16x32_bf16 v[76:79], v[44:47], v[20:23], v[76:79]
  v_mfma_f32_16x16x32_bf16 v[68:71], v[48:51], v[16:19], v[68:71]
  v_mfma_f32_16x16x32_bf16 v[80:83], v[48:51], v[20:23], v[80:83]
  v_mfma_f32_16x16x32_bf16 v[72:75], v[52:55], v[16:19], v[72:75]
  v_mfma_f32_16x16x32_bf16 v[84:87], v[52:55], v[20:23], v[84:87]
  v_mfma_f32_16x16x32_bf16 v[164:167], v[188:191], v[16:19], v[164:167]
  v_mfma_f32_16x16x32_bf16 v[172:175], v[16:19], v[16:19], v[172:175]
  v_mfma_f32_16x16x32_bf16 v[180:183], v[188:191], v[56:59], v[180:183]
  v_mfma_f32_16x16x32_bf16 v[168:171], v[188:191], v[20:23], v[168:171]
  v_mfma_f32_16x16x32_bf16 v[176:179], v[20:23], v[20:23], v[176:179]
  v_mfma_f32_16x16x32_bf16 v[184:187], v[188:191], v[60:63], v[184:187]
  ds_read_b128 v[16:19], v5 offset:0
  ds_read_b128 v[20:23], v5 offset:2048
  ds_read_b64_tr_b16 v[44:45], v6 offset:7840
  ds_read_b64_tr_b16 v[46:47], v6 offset:8080
  ds_read_b64_tr_b16 v[48:49], v6 offset:7872
  ds_read_b64_tr_b16 v[50:51], v6 offset:8112
  ds_read_b64_tr_b16 v[52:53], v6 offset:7904
  ds_read_b64_tr_b16 v[54:55], v6 offset:8144
  ds_read_b64_tr_b16 v[56:57], v7 offset:7680
  ds_read_b64_tr_b16 v[58:59], v7 offset:7920
  ds_read_b64_tr_b16 v[60:61], v7 offset:7712
  ds_read_b64_tr_b16 v[62:63], v7 offset:7952
  s_waitcnt lgkmcnt(12)
  v_mfma_f32_16x16x32_bf16 v[64:67], v[24:27], v[8:11], v[64:67]
  v_mfma_f32_16x16x32_bf16 v[76:79], v[24:27], v[12:15], v[76:79]
  v_mfma_f32_16x16x32_bf16 v[68:71], v[28:31], v[8:11], v[68:71]
  v_mfma_f32_16x16x32_bf16 v[80:83], v[28:31], v[12:15], v[80:83]
  v_mfma_f32_16x16x32_bf16 v[72:75], v[32:35], v[8:11], v[72:75]
  v_mfma_f32_16x16x32_bf16 v[84:87], v[32:35], v[12:15], v[84:87]
  v_mfma_f32_16x16x32_bf16 v[164:167], v[188:191], v[8:11], v[164:167]
  v_mfma_f32_16x16x32_bf16 v[172:175], v[8:11], v[8:11], v[172:175]
  v_mfma_f32_16x16x32_bf16 v[180:183], v[188:191], v[36:39], v[180:183]
  v_mfma_f32_16x16x32_bf16 v[168:171], v[188:191], v[12:15], v[168:171]
  v_mfma_f32_16x16x32_bf16 v[176:179], v[12:15], v[12:15], v[176:179]
  v_mfma_f32_16x16x32_bf16 v[184:187], v[188:191], v[40:43], v[184:187]
  s_waitcnt lgkmcnt(0)
  s_waitcnt vmcnt(4)
  s_barrier
  v_add_u32 v4, 31744, v4
  v_add_u32 v5, 31744, v5
  v_add_u32 v6, 31744, v6
  v_add_u32 v7, 31744, v7
  ds_read_b128 v[8:11], v4 offset:0
  ds_read_b128 v[12:15], v4 offset:2048
  ds_read_b64_tr_b16 v[24:25], v6 offset:160
  ds_read_b64_tr_b16 v[26:27], v6 offset:400
  ds_read_b64_tr_b16 v[28:29], v6 offset:192
  ds_read_b64_tr_b16 v[30:31], v6 offset:432
  ds_read_b64_tr_b16 v[32:33], v6 offset:224
  ds_read_b64_tr_b16 v[34:35], v6 offset:464
  ds_read_b64_tr_b16 v[36:37], v7 offset:0
  ds_read_b64_tr_b16 v[38:39], v7 offset:240
  ds_read_b64_tr_b16 v[40:41], v7 offset:32
  ds_read_b64_tr_b16 v[42:43], v7 offset:272
  v_mfma_f32_16x16x32_bf16 v[64:67], v[44:47], v[16:19], v[64:67]
  v_mfma_f32_16x16x32_bf16 v[76:79], v[44:47], v[20:23], v[76:79]
  v_mfma_f32_16x16x32_bf16 v[68:71], v[48:51], v[16:19], v[68:71]
  v_mfma_f32_16x16x32_bf16 v[80:83], v[48:51], v[20:23], v[80:83]
  v_mfma_f32_16x16x32_bf16 v[72:75], v[52:55], v[16:19], v[72:75]
  v_mfma_f32_16x16x32_bf16 v[84:87], v[52:55], v[20:23], v[84:87]
  v_mfma_f32_16x16x32_bf16 v[164:167], v[188:191], v[16:19], v[164:167]
  v_mfma_f32_16x16x32_bf16 v[172:175], v[16:19], v[16:19], v[172:175]
  v_mfma_f32_16x16x32_bf16 v[180:183], v[188:191], v[56:59], v[180:183]
  v_mfma_f32_16x16x32_bf16 v[168:171], v[188:191], v[20:23], v[168:171]
  v_mfma_f32_16x16x32_bf16 v[176:179], v[20:23], v[20:23], v[176:179]
  v_mfma_f32_16x16x32_bf16 v[184:187], v[188:191], v[60:63], v[184:187]
  ds_read_b128 v[16:19], v5 offset:0
  ds_read_b128 v[20:23], v5 offset:2048
  ds_read_b64_tr_b16 v[44:45], v6 offset:7840
  ds_read_b64_tr_b16 v[46:47], v6 offset:8080
  ds_read_b64_tr_b16 v[48:49], v6 offset:7872
  ds_read_b64_tr_b16 v[50:51], v6 offset:8112
  ds_read_b64_tr_b16 v[52:53], v6 offset:7904
  ds_read_b64_tr_b16 v[54:55], v6 offset:8144
  ds_read_b64_tr_b16 v[56:57], v7 offset:7680
  ds_read_b64_tr_b16 v[58:59], v7 offset:7920
  ds_read_b64_tr_b16 v[60:61], v7 offset:7712
  ds_read_b64_tr_b16 v[62:63], v7 offset:7952
  s_waitcnt lgkmcnt(12)
  v_mfma_f32_16x16x32_bf16 v[64:67], v[24:27], v[8:11], v[64:67]
  v_mfma_f32_16x16x32_bf16 v[76:79], v[24:27], v[12:15], v[76:79]
  v_mfma_f32_16x16x32_bf16 v[68:71], v[28:31], v[8:11], v[68:71]
  v_mfma_f32_16x16x32_bf16 v[80:83], v[28:31], v[12:15], v[80:83]
  v_mfma_f32_16x16x32_bf16 v[72:75], v[32:35], v[8:11], v[72:75]
  v_mfma_f32_16x16x32_bf16 v[84:87], v[32:35], v[12:15], v[84:87]
  v_mfma_f32_16x16x32_bf16 v[164:167], v[188:191], v[8:11], v[164:167]
  v_mfma_f32_16x16x32_bf16 v[172:175], v[8:11], v[8:11], v[172:175]
  v_mfma_f32_16x16x32_bf16 v[180:183], v[188:191], v[36:39], v[180:183]
  v_mfma_f32_16x16x32_bf16 v[168:171], v[188:191], v[12:15], v[168:171]
  v_mfma_f32_16x16x32_bf16 v[176:179], v[12:15], v[12:15], v[176:179]
  v_mfma_f32_16x16x32_bf16 v[184:187], v[188:191], v[40:43], v[184:187]
  s_waitcnt lgkmcnt(0)
  s_waitcnt vmcnt(1)
  s_barrier
  v_add_u32 v4, 31744, v4
  v_add_u32 v5, 31744, v5
  v_add_u32 v6, 31744, v6
  v_add_u32 v7, 31744, v7
  ds_read_b128 v[8:11], v4 offset:0
  ds_read_b128 v[12:15], v4 offset:2048
  ds_read_b64_tr_b16 v[24:25], v6 offset:160
  ds_read_b64_tr_b16 v[26:27], v6 offset:400
  ds_read_b64_tr_b16 v[28:29], v6 offset:192
  ds_read_b64_tr_b16 v[30:31], v6 offset:432
  ds_read_b64_tr_b16 v[32:33], v6 offset:224
  ds_read_b64_tr_b16 v[34:35], v6 offset:464
  ds_read_b64_tr_b16 v[36:37], v7 offset:0
  ds_read_b64_tr_b16 v[38:39], v7 offset:240
  ds_read_b64_tr_b16 v[40:41], v7 offset:32
  ds_read_b64_tr_b16 v[42:43], v7 offset:272
  v_mfma_f32_16x16x32_bf16 v[64:67], v[44:47], v[16:19], v[64:67]
  v_mfma_f32_16x16x32_bf16 v[76:79], v[44:47], v[20:23], v[76:79]
  v_mfma_f32_16x16x32_bf16 v[68:71], v[48:51], v[16:19], v[68:71]
  v_mfma_f32_16x16x32_bf16 v[80:83], v[48:51], v[20:23], v[80:83]
  v_mfma_f32_16x16x32_bf16 v[72:75], v[52:55], v[16:19], v[72:75]
  v_mfma_f32_16x16x32_bf16 v[84:87], v[52:55], v[20:23], v[84:87]
  v_mfma_f32_16x16x32_bf16 v[164:167], v[188:191], v[16:19], v[164:167]
  v_mfma_f32_16x16x32_bf16 v[172:175], v[16:19], v[16:19], v[172:175]
  v_mfma_f32_16x16x32_bf16 v[180:183], v[188:191], v[56:59], v[180:183]
  v_mfma_f32_16x16x32_bf16 v[168:171], v[188:191], v[20:23], v[168:171]
  v_mfma_f32_16x16x32_bf16 v[176:179], v[20:23], v[20:23], v[176:179]
  v_mfma_f32_16x16x32_bf16 v[184:187], v[188:191], v[60:63], v[184:187]
  ds_read_b128 v[16:19], v5 offset:0
  ds_read_b128 v[20:23], v5 offset:2048
  ds_read_b64_tr_b16 v[44:45], v6 offset:7840
  ds_read_b64_tr_b16 v[46:47], v6 offset:8080
  ds_read_b64_tr_b16 v[48:49], v6 offset:7872
  ds_read_b64_tr_b16 v[50:51], v6 offset:8112
  ds_read_b64_tr_b16 v[52:53], v6 offset:7904
  ds_read_b64_tr_b16 v[54:55], v6 offset:8144
  ds_read_b64_tr_b16 v[56:57], v7 offset:7680
  ds_read_b64_tr_b16 v[58:59], v7 offset:7920
  ds_read_b64_tr_b16 v[60:61], v7 offset:7712
  ds_read_b64_tr_b16 v[62:63], v7 offset:7952
  s_waitcnt lgkmcnt(12)
  v_mfma_f32_16x16x32_bf16 v[64:67], v[24:27], v[8:11], v[64:67]
  v_mfma_f32_16x16x32_bf16 v[76:79], v[24:27], v[12:15], v[76:79]
  v_mfma_f32_16x16x32_bf16 v[68:71], v[28:31], v[8:11], v[68:71]
  v_mfma_f32_16x16x32_bf16 v[80:83], v[28:31], v[12:15], v[80:83]
  v_mfma_f32_16x16x32_bf16 v[72:75], v[32:35], v[8:11], v[72:75]
  v_mfma_f32_16x16x32_bf16 v[84:87], v[32:35], v[12:15], v[84:87]
  v_mfma_f32_16x16x32_bf16 v[164:167], v[188:191], v[8:11], v[164:167]
  v_mfma_f32_16x16x32_bf16 v[172:175], v[8:11], v[8:11], v[172:175]
  v_mfma_f32_16x16x32_bf16 v[180:183], v[188:191], v[36:39], v[180:183]
  v_mfma_f32_16x16x32_bf16 v[168:171], v[188:191], v[12:15], v[168:171]
  v_mfma_f32_16x16x32_bf16 v[176:179], v[12:15], v[12:15], v[176:179]
  v_mfma_f32_16x16x32_bf16 v[184:187], v[188:191], v[40:43], v[184:187]
  s_waitcnt lgkmcnt(0)
  v_mfma_f32_16x16x32_bf16 v[64:67], v[44:47], v[16:19], v[64:67]
  v_mfma_f32_16x16x32_bf16 v[76:79], v[44:47], v[20:23], v[76:79]
  v_mfma_f32_16x16x32_bf16 v[68:71], v[48:51], v[16:19], v[68:71]
  v_mfma_f32_16x16x32_bf16 v[80:83], v[48:51], v[20:23], v[80:83]
  v_mfma_f32_16x16x32_bf16 v[72:75], v[52:55], v[16:19], v[72:75]
  v_mfma_f32_16x16x32_bf16 v[84:87], v[52:55], v[20:23], v[84:87]
  v_mfma_f32_16x16x32_bf16 v[164:167], v[188:191], v[16:19], v[164:167]
  v_mfma_f32_16x16x32_bf16 v[172:175], v[16:19], v[16:19], v[172:175]
  v_mfma_f32_16x16x32_bf16 v[180:183], v[188:191], v[56:59], v[180:183]
  v_mfma_f32_16x16x32_bf16 v[168:171], v[188:191], v[20:23], v[168:171]
  v_mfma_f32_16x16x32_bf16 v[176:179], v[20:23], v[20:23], v[176:179]
  v_mfma_f32_16x16x32_bf16 v[184:187], v[188:191], v[60:63], v[184:187]
  v_and_b32 v10, 15, v0
  v_lshrrev_b32 v11, 2, v10
  v_lshl_add_u32 v11, v11, 4, v10
  v_lshlrev_b32 v11, 2, v11
  v_and_b32 v10, 3, v0
  v_cmp_eq_u32 s[40:41], 1, v10
  v_cmp_eq_u32 s[42:43], 2, v10
  v_cmp_eq_u32 s[44:45], 3, v10
  s_nop 4
  v_cndmask_b32_e64 v172, v172, v173, s[40:41]
  v_cndmask_b32_e64 v172, v172, v174, s[42:43]
  v_cndmask_b32_e64 v172, v172, v175, s[44:45]
  ds_bpermute_b32 v102, v11, v172
  v_mov_b32 v100, v164
  v_mov_b32 v104, v180
  v_cndmask_b32_e64 v176, v176, v177, s[40:41]
  v_cndmask_b32_e64 v176, v176, v178, s[42:43]
  v_cndmask_b32_e64 v176, v176, v179, s[44:45]
  ds_bpermute_b32 v103, v11, v176
  v_mov_b32 v101, v168
  v_mov_b32 v105, v184
  s_waitcnt lgkmcnt(0)
  v_and_b32 v16, 15, v0
  v_lshrrev_b32 v17, 4, v0
  s_lshl_b32 s34, s14, 7
  s_add_u32 s34, s34, 158720
  v_lshl_add_u32 v18, v16, 2, s34
  v_mov_b32 v19, 0x3ae38e39
  v_mul_f32 v100, v19, v100
  v_mul_f32 v102, v19, v102
  v_fma_f32 v102, -v100, v100, v102
  v_max_f32 v102, 0, v102
  v_add_f32 v102, 0x3727c5ac, v102
  v_rsq_f32 v102, v102
  v_sub_f32 v100, 0, v100
  ds_write_b32 v18, v100 offset:0
  ds_write_b32 v18, v102 offset:512
  ds_write_b32 v18, v104 offset:1024
  v_mul_f32 v101, v19, v101
  v_mul_f32 v103, v19, v103
  v_fma_f32 v103, -v101, v101, v103
  v_max_f32 v103, 0, v103
  v_add_f32 v103, 0x3727c5ac, v103
  v_rsq_f32 v103, v103
  v_sub_f32 v101, 0, v101
  ds_write_b32 v18, v101 offset:64
  ds_write_b32 v18, v103 offset:576
  ds_write_b32 v18, v105 offset:1088
  s_waitcnt lgkmcnt(0)
  s_barrier
  v_lshlrev_b32 v19, 4, v17
  v_add_u32 v19, 160064, v19
  ds_read_b128 v[112:115], v19 offset:0
  ds_read_b128 v[116:119], v19 offset:64
  ds_read_b128 v[120:123], v19 offset:128
  s_add_u32 s24, s10, 0x2c00000
  s_addc_u32 s25, s11, 0
  s_mov_b32 s26, 0x300000
  s_mov_b32 s27, 0x00020000
  s_lshl_b32 s34, s13, 3
  s_lshl_b32 s35, s14, 1
  s_add_u32 s34, s34, s35
  s_lshl_b32 s34, s34, 4
  s_add_u32 s34, s34, s12
  s_mul_i32 s34, s34, 1536
  v_lshlrev_b32 v20, 4, v0
  v_lshlrev_b32 v21, 3, v0
  v_cmp_gt_u32 vcc, 16, v0
  s_waitcnt lgkmcnt(0)
  v_fmac_f32 v64, v100, v112
  v_mul_f32 v64, v64, v102
  v_fmac_f32 v65, v100, v113
  v_mul_f32 v65, v65, v102
  v_fmac_f32 v66, v100, v114
  v_mul_f32 v66, v66, v102
  v_fmac_f32 v67, v100, v115
  v_mul_f32 v67, v67, v102
  v_mul_f32 v8, 0x3fb8aa3b, v64
  v_mul_f32 v9, 0x3fb8aa3b, v65
  v_mul_f32 v10, 0x3fb8aa3b, v66
  v_mul_f32 v11, 0x3fb8aa3b, v67
  v_exp_f32 v8, v8
  v_exp_f32 v9, v9
  v_exp_f32 v10, v10
  v_exp_f32 v11, v11
  v_cmp_lt_f32 s[40:41], 0, v64
  v_cmp_lt_f32 s[42:43], 0, v65
  v_cmp_lt_f32 s[44:45], 0, v66
  v_cmp_lt_f32 s[46:47], 0, v67
  v_add_f32 v64, 1.0, v64
  v_add_f32 v65, 1.0, v65
  v_add_f32 v66, 1.0, v66
  v_add_f32 v67, 1.0, v67
  v_cndmask_b32_e64 v64, v8, v64, s[40:41]
  v_cndmask_b32_e64 v65, v9, v65, s[42:43]
  v_cndmask_b32_e64 v66, v10, v66, s[44:45]
  v_cndmask_b32_e64 v67, v11, v67, s[46:47]
  v_add_f32 v64, 0x358637bd, v64
  v_add_f32 v65, 0x358637bd, v65
  v_add_f32 v66, 0x358637bd, v66
  v_add_f32 v67, 0x358637bd, v67
  v_cvt_pk_bf16_f32 v128, v64, v65
  v_cvt_pk_bf16_f32 v129, v66, v67
  v_fmac_f32 v68, v100, v116
  v_mul_f32 v68, v68, v102
  v_fmac_f32 v69, v100, v117
  v_mul_f32 v69, v69, v102
  v_fmac_f32 v70, v100, v118
  v_mul_f32 v70, v70, v102
  v_fmac_f32 v71, v100, v119
  v_mul_f32 v71, v71, v102
  v_mul_f32 v8, 0x3fb8aa3b, v68
  v_mul_f32 v9, 0x3fb8aa3b, v69
  v_mul_f32 v10, 0x3fb8aa3b, v70
  v_mul_f32 v11, 0x3fb8aa3b, v71
  v_exp_f32 v8, v8
  v_exp_f32 v9, v9
  v_exp_f32 v10, v10
  v_exp_f32 v11, v11
  v_cmp_lt_f32 s[40:41], 0, v68
  v_cmp_lt_f32 s[42:43], 0, v69
  v_cmp_lt_f32 s[44:45], 0, v70
  v_cmp_lt_f32 s[46:47], 0, v71
  v_add_f32 v68, 1.0, v68
  v_add_f32 v69, 1.0, v69
  v_add_f32 v70, 1.0, v70
  v_add_f32 v71, 1.0, v71
  v_cndmask_b32_e64 v68, v8, v68, s[40:41]
  v_cndmask_b32_e64 v69, v9, v69, s[42:43]
  v_cndmask_b32_e64 v70, v10, v70, s[44:45]
  v_cndmask_b32_e64 v71, v11, v71, s[46:47]
  v_add_f32 v68, 0x358637bd, v68
  v_add_f32 v69, 0x358637bd, v69
  v_add_f32 v70, 0x358637bd, v70
  v_add_f32 v71, 0x358637bd, v71
  v_cvt_pk_bf16_f32 v130, v68, v69
  v_cvt_pk_bf16_f32 v131, v70, v71
  v_fmac_f32 v72, v100, v120
  v_mul_f32 v72, v72, v102
  v_fmac_f32 v73, v100, v121
  v_mul_f32 v73, v73, v102
  v_fmac_f32 v74, v100, v122
  v_mul_f32 v74, v74, v102
  v_fmac_f32 v75, v100, v123
  v_mul_f32 v75, v75, v102
  v_mul_f32 v8, 0x3fb8aa3b, v72
  v_mul_f32 v9, 0x3fb8aa3b, v73
  v_mul_f32 v10, 0x3fb8aa3b, v74
  v_mul_f32 v11, 0x3fb8aa3b, v75
  v_exp_f32 v8, v8
  v_exp_f32 v9, v9
  v_exp_f32 v10, v10
  v_exp_f32 v11, v11
  v_cmp_lt_f32 s[40:41], 0, v72
  v_cmp_lt_f32 s[42:43], 0, v73
  v_cmp_lt_f32 s[44:45], 0, v74
  v_cmp_lt_f32 s[46:47], 0, v75
  v_add_f32 v72, 1.0, v72
  v_add_f32 v73, 1.0, v73
  v_add_f32 v74, 1.0, v74
  v_add_f32 v75, 1.0, v75
  v_cndmask_b32_e64 v72, v8, v72, s[40:41]
  v_cndmask_b32_e64 v73, v9, v73, s[42:43]
  v_cndmask_b32_e64 v74, v10, v74, s[44:45]
  v_cndmask_b32_e64 v75, v11, v75, s[46:47]
  v_add_f32 v72, 0x358637bd, v72
  v_add_f32 v73, 0x358637bd, v73
  v_add_f32 v74, 0x358637bd, v74
  v_add_f32 v75, 0x358637bd, v75
  v_cvt_pk_bf16_f32 v132, v72, v73
  v_cvt_pk_bf16_f32 v133, v74, v75
  v_cndmask_b32 v132, 0, v132, vcc
  v_cndmask_b32 v133, 0, v133, vcc
  s_add_u32 s35, s34, 0
  buffer_store_dwordx4 v[128:131], v20, s[24:27], s35 offen
  buffer_store_dwordx2 v[132:133], v21, s[24:27], s35 offen offset:1024
  v_fmac_f32 v76, v101, v112
  v_mul_f32 v76, v76, v103
  v_fmac_f32 v77, v101, v113
  v_mul_f32 v77, v77, v103
  v_fmac_f32 v78, v101, v114
  v_mul_f32 v78, v78, v103
  v_fmac_f32 v79, v101, v115
  v_mul_f32 v79, v79, v103
  v_mul_f32 v8, 0x3fb8aa3b, v76
  v_mul_f32 v9, 0x3fb8aa3b, v77
  v_mul_f32 v10, 0x3fb8aa3b, v78
  v_mul_f32 v11, 0x3fb8aa3b, v79
  v_exp_f32 v8, v8
  v_exp_f32 v9, v9
  v_exp_f32 v10, v10
  v_exp_f32 v11, v11
  v_cmp_lt_f32 s[40:41], 0, v76
  v_cmp_lt_f32 s[42:43], 0, v77
  v_cmp_lt_f32 s[44:45], 0, v78
  v_cmp_lt_f32 s[46:47], 0, v79
  v_add_f32 v76, 1.0, v76
  v_add_f32 v77, 1.0, v77
  v_add_f32 v78, 1.0, v78
  v_add_f32 v79, 1.0, v79
  v_cndmask_b32_e64 v76, v8, v76, s[40:41]
  v_cndmask_b32_e64 v77, v9, v77, s[42:43]
  v_cndmask_b32_e64 v78, v10, v78, s[44:45]
  v_cndmask_b32_e64 v79, v11, v79, s[46:47]
  v_add_f32 v76, 0x358637bd, v76
  v_add_f32 v77, 0x358637bd, v77
  v_add_f32 v78, 0x358637bd, v78
  v_add_f32 v79, 0x358637bd, v79
  v_cvt_pk_bf16_f32 v136, v76, v77
  v_cvt_pk_bf16_f32 v137, v78, v79
  v_fmac_f32 v80, v101, v116
  v_mul_f32 v80, v80, v103
  v_fmac_f32 v81, v101, v117
  v_mul_f32 v81, v81, v103
  v_fmac_f32 v82, v101, v118
  v_mul_f32 v82, v82, v103
  v_fmac_f32 v83, v101, v119
  v_mul_f32 v83, v83, v103
  v_mul_f32 v8, 0x3fb8aa3b, v80
  v_mul_f32 v9, 0x3fb8aa3b, v81
  v_mul_f32 v10, 0x3fb8aa3b, v82
  v_mul_f32 v11, 0x3fb8aa3b, v83
  v_exp_f32 v8, v8
  v_exp_f32 v9, v9
  v_exp_f32 v10, v10
  v_exp_f32 v11, v11
  v_cmp_lt_f32 s[40:41], 0, v80
  v_cmp_lt_f32 s[42:43], 0, v81
  v_cmp_lt_f32 s[44:45], 0, v82
  v_cmp_lt_f32 s[46:47], 0, v83
  v_add_f32 v80, 1.0, v80
  v_add_f32 v81, 1.0, v81
  v_add_f32 v82, 1.0, v82
  v_add_f32 v83, 1.0, v83
  v_cndmask_b32_e64 v80, v8, v80, s[40:41]
  v_cndmask_b32_e64 v81, v9, v81, s[42:43]
  v_cndmask_b32_e64 v82, v10, v82, s[44:45]
  v_cndmask_b32_e64 v83, v11, v83, s[46:47]
  v_add_f32 v80, 0x358637bd, v80
  v_add_f32 v81, 0x358637bd, v81
  v_add_f32 v82, 0x358637bd, v82
  v_add_f32 v83, 0x358637bd, v83
  v_cvt_pk_bf16_f32 v138, v80, v81
  v_cvt_pk_bf16_f32 v139, v82, v83
  v_fmac_f32 v84, v101, v120
  v_mul_f32 v84, v84, v103
  v_fmac_f32 v85, v101, v121
  v_mul_f32 v85, v85, v103
  v_fmac_f32 v86, v101, v122
  v_mul_f32 v86, v86, v103
  v_fmac_f32 v87, v101, v123
  v_mul_f32 v87, v87, v103
  v_mul_f32 v8, 0x3fb8aa3b, v84
  v_mul_f32 v9, 0x3fb8aa3b, v85
  v_mul_f32 v10, 0x3fb8aa3b, v86
  v_mul_f32 v11, 0x3fb8aa3b, v87
  v_exp_f32 v8, v8
  v_exp_f32 v9, v9
  v_exp_f32 v10, v10
  v_exp_f32 v11, v11
  v_cmp_lt_f32 s[40:41], 0, v84
  v_cmp_lt_f32 s[42:43], 0, v85
  v_cmp_lt_f32 s[44:45], 0, v86
  v_cmp_lt_f32 s[46:47], 0, v87
  v_add_f32 v84, 1.0, v84
  v_add_f32 v85, 1.0, v85
  v_add_f32 v86, 1.0, v86
  v_add_f32 v87, 1.0, v87
  v_cndmask_b32_e64 v84, v8, v84, s[40:41]
  v_cndmask_b32_e64 v85, v9, v85, s[42:43]
  v_cndmask_b32_e64 v86, v10, v86, s[44:45]
  v_cndmask_b32_e64 v87, v11, v87, s[46:47]
  v_add_f32 v84, 0x358637bd, v84
  v_add_f32 v85, 0x358637bd, v85
  v_add_f32 v86, 0x358637bd, v86
  v_add_f32 v87, 0x358637bd, v87
  v_cvt_pk_bf16_f32 v140, v84, v85
  v_cvt_pk_bf16_f32 v141, v86, v87
  v_cndmask_b32 v140, 0, v140, vcc
  v_cndmask_b32 v141, 0, v141, vcc
  s_add_u32 s35, s34, 24576
  buffer_store_dwordx4 v[136:139], v20, s[24:27], s35 offen
  buffer_store_dwordx2 v[140:141], v21, s[24:27], s35 offen offset:1024
k1_join:
  s_waitcnt lgkmcnt(0)
  s_barrier
  s_add_u32 s28, s10, 0x490000
  s_addc_u32 s29, s11, 0
  s_mov_b32 s30, 0xb0000
  s_mov_b32 s31, 0x00020000
  s_lshl_b32 s34, s12, 5
  s_add_u32 s34, s34, s13
  s_mul_i32 s34, s34, 1408
  ds_read_b32 v20, v106 offset:0
  ds_read_b32 v21, v106 offset:12288
  ds_read_b32 v22, v106 offset:24576
  ds_read_b32 v23, v106 offset:36864
  ds_read_b32 v24, v107 offset:0
  ds_read_b32 v25, v107 offset:12288
  ds_read_b32 v26, v107 offset:24576
  ds_read_b32 v27, v107 offset:36864
  s_waitcnt lgkmcnt(0)
  v_add_f32 v20, v20, v21
  v_add_f32 v22, v22, v23
  v_add_f32 v20, v20, v22
  buffer_store_dword v20, v108, s[28:31], s34 offen
  v_add_f32 v24, v24, v25
  v_add_f32 v26, v26, v27
  v_add_f32 v24, v24, v26
  buffer_store_dword v24, v109, s[28:31], s34 offen
k1_fin:
k1_end:
  s_endpgm
.globl k2_kernel
.p2align 8
.type k2_kernel,@function
k2_kernel:
  s_cmp_ge_u32 s2, 256
  s_cbranch_scc1 k2_end
  s_load_dwordx2 s[4:5], s[0:1], 16
  s_load_dwordx2 s[6:7], s[0:1], 0
  s_load_dwordx4 s[8:11], s[0:1], 64
  s_load_dwordx4 s[72:75], s[0:1], 32
  v_lshrrev_b32 v1, 6, v0
  v_mov_b32 v4, v0
  s_and_b32 s13, s2, 3
  v_readfirstlane_b32 s3, v1
  v_and_b32 v0, 63, v0
  s_bfe_u32 s14, s2, 0x10002
  s_lshl_b32 s14, s14, 5
  s_lshr_b32 s12, s2, 3
  s_add_u32 s14, s14, s12
  v_lshlrev_b32 v1, 4, v0
  v_lshlrev_b32 v2, 3, v0
  s_waitcnt lgkmcnt(0)
  s_add_u32 s24, s10, 0x540000
  s_addc_u32 s25, s11, 0
  s_mov_b32 s26, 0x10000
  s_mov_b32 s27, 0x00020000
  s_cmp_ge_u32 s2, 32
  s_cbranch_scc1 k2_noprod
  s_add_u32 s56, s10, 0x490000
  s_addc_u32 s57, s11, 0
  s_mov_b32 s58, 0xb0000
  s_mov_b32 s59, 0x00020000
  s_lshl_b32 s34, s2, 4
  s_lshl_b32 s35, s3, 2
  s_add_u32 s34, s34, s35
  s_mul_i32 s34, s34, 1408
  s_add_u32 s35, s34, 0
  buffer_load_dwordx4 v[32:35], v1, s[56:59], s35 offen
  buffer_load_dwordx4 v[36:39], v1, s[56:59], s35 offen offset:1024
  s_add_u32 s35, s34, 1408
  buffer_load_dwordx4 v[40:43], v1, s[56:59], s35 offen
  buffer_load_dwordx4 v[44:47], v1, s[56:59], s35 offen offset:1024
  s_add_u32 s35, s34, 2816
  buffer_load_dwordx4 v[48:51], v1, s[56:59], s35 offen
  buffer_load_dwordx4 v[52:55], v1, s[56:59], s35 offen offset:1024
  s_add_u32 s35, s34, 4224
  buffer_load_dwordx4 v[56:59], v1, s[56:59], s35 offen
  buffer_load_dwordx4 v[60:63], v1, s[56:59], s35 offen offset:1024
  s_lshl_b32 s34, s3, 11
  s_add_u32 s34, s34, 147456
  v_add_u32 v8, s34, v1
  v_and_b32 v9, 15, v0
  v_lshrrev_b32 v10, 4, v0
  s_and_b32 s36, s2, 3
  s_and_b32 s37, s2, 1
  v_and_b32 v11, 3, v9
  v_lshrrev_b32 v12, 2, v9
  v_add_u32 v13, 16, v11
  v_cmp_eq_u32 s[40:41], s36, v12
  v_cmp_gt_u32 s[42:43], 2, v11
  s_and_b64 s[40:41], s[40:41], s[42:43]
  v_cmp_eq_u32 s[42:43], 2, v11
  s_or_b64 s[40:41], s[40:41], s[42:43]
  s_lshl_b32 s37, s37, 1
  v_lshlrev_b32 v14, 2, v10
  v_subrev_u32 v14, s37, v14
  v_mov_b32 v16, 351
  v_add_u32 v15, 0, v14
  v_cmp_gt_u32 vcc, 18, v15
  v_mul_u32_u24 v15, 19, v15
  v_add_u32 v17, v15, v9
  v_add_u32 v15, v15, v13
  v_cndmask_b32 v17, v16, v17, vcc
  s_and_b64 vcc, vcc, s[40:41]
  v_lshlrev_b32 v64, 2, v17
  s_nop 0
  v_cndmask_b32 v15, v16, v15, vcc
  v_lshlrev_b32 v72, 2, v15
  v_add_u32 v15, 1, v14
  v_cmp_gt_u32 vcc, 18, v15
  v_mul_u32_u24 v15, 19, v15
  v_add_u32 v17, v15, v9
  v_add_u32 v15, v15, v13
  v_cndmask_b32 v17, v16, v17, vcc
  s_and_b64 vcc, vcc, s[40:41]
  v_lshlrev_b32 v65, 2, v17
  s_nop 0
  v_cndmask_b32 v15, v16, v15, vcc
  v_lshlrev_b32 v73, 2, v15
  v_add_u32 v15, 2, v14
  v_cmp_gt_u32 vcc, 18, v15
  v_mul_u32_u24 v15, 19, v15
  v_add_u32 v17, v15, v9
  v_add_u32 v15, v15, v13
  v_cndmask_b32 v17, v16, v17, vcc
  s_and_b64 vcc, vcc, s[40:41]
  v_lshlrev_b32 v66, 2, v17
  s_nop 0
  v_cndmask_b32 v15, v16, v15, vcc
  v_lshlrev_b32 v74, 2, v15
  v_add_u32 v15, 3, v14
  v_cmp_gt_u32 vcc, 18, v15
  v_mul_u32_u24 v15, 19, v15
  v_add_u32 v17, v15, v9
  v_add_u32 v15, v15, v13
  v_cndmask_b32 v17, v16, v17, vcc
  s_and_b64 vcc, vcc, s[40:41]
  v_lshlrev_b32 v67, 2, v17
  s_nop 0
  v_cndmask_b32 v15, v16, v15, vcc
  v_lshlrev_b32 v75, 2, v15
  v_add_u32 v15, 16, v14
  v_cmp_gt_u32 vcc, 18, v15
  v_mul_u32_u24 v15, 19, v15
  v_add_u32 v17, v15, v9
  v_add_u32 v15, v15, v13
  v_cndmask_b32 v17, v16, v17, vcc
  s_and_b64 vcc, vcc, s[40:41]
  v_lshlrev_b32 v68, 2, v17
  s_nop 0
  v_cndmask_b32 v15, v16, v15, vcc
  v_lshlrev_b32 v76, 2, v15
  v_add_u32 v15, 17, v14
  v_cmp_gt_u32 vcc, 18, v15
  v_mul_u32_u24 v15, 19, v15
  v_add_u32 v17, v15, v9
  v_add_u32 v15, v15, v13
  v_cndmask_b32 v17, v16, v17, vcc
  s_and_b64 vcc, vcc, s[40:41]
  v_lshlrev_b32 v69, 2, v17
  s_nop 0
  v_cndmask_b32 v15, v16, v15, vcc
  v_lshlrev_b32 v77, 2, v15
  v_add_u32 v15, 18, v14
  v_cmp_gt_u32 vcc, 18, v15
  v_mul_u32_u24 v15, 19, v15
  v_add_u32 v17, v15, v9
  v_add_u32 v15, v15, v13
  v_cndmask_b32 v17, v16, v17, vcc
  s_and_b64 vcc, vcc, s[40:41]
  v_lshlrev_b32 v70, 2, v17
  s_nop 0
  v_cndmask_b32 v15, v16, v15, vcc
  v_lshlrev_b32 v78, 2, v15
  v_add_u32 v15, 19, v14
  v_cmp_gt_u32 vcc, 18, v15
  v_mul_u32_u24 v15, 19, v15
  v_add_u32 v17, v15, v9
  v_add_u32 v15, v15, v13
  v_cndmask_b32 v17, v16, v17, vcc
  s_and_b64 vcc, vcc, s[40:41]
  v_lshlrev_b32 v71, 2, v17
  s_nop 0
  v_cndmask_b32 v15, v16, v15, vcc
  v_lshlrev_b32 v79, 2, v15
  s_waitcnt vmcnt(0)
  v_add_f32 v32, v32, v40
  v_add_f32 v48, v48, v56
  v_add_f32 v32, v32, v48
  v_add_f32 v33, v33, v41
  v_add_f32 v49, v49, v57
  v_add_f32 v33, v33, v49
  v_add_f32 v34, v34, v42
  v_add_f32 v50, v50, v58
  v_add_f32 v34, v34, v50
  v_add_f32 v35, v35, v43
  v_add_f32 v51, v51, v59
  v_add_f32 v35, v35, v51
  v_add_f32 v36, v36, v44
  v_add_f32 v52, v52, v60
  v_add_f32 v36, v36, v52
  v_add_f32 v37, v37, v45
  v_add_f32 v53, v53, v61
  v_add_f32 v37, v37, v53
  v_add_f32 v38, v38, v46
  v_add_f32 v54, v54, v62
  v_add_f32 v38, v38, v54
  v_add_f32 v39, v39, v47
  v_add_f32 v55, v55, v63
  v_add_f32 v39, v39, v55
  ds_write_b128 v8, v[32:35]
  ds_write_b128 v8, v[36:39] offset:1024
  s_waitcnt lgkmcnt(0)
  s_barrier
  s_cmp_lg_u32 s3, 0
  s_cbranch_scc1 k2_prod2
  v_add_u32 v64, 147456, v64
  v_add_u32 v65, 147456, v65
  v_add_u32 v66, 147456, v66
  v_add_u32 v67, 147456, v67
  v_add_u32 v68, 147456, v68
  v_add_u32 v69, 147456, v69
  v_add_u32 v70, 147456, v70
  v_add_u32 v71, 147456, v71
  v_add_u32 v72, 147456, v72
  v_add_u32 v73, 147456, v73
  v_add_u32 v74, 147456, v74
  v_add_u32 v75, 147456, v75
  v_add_u32 v76, 147456, v76
  v_add_u32 v77, 147456, v77
  v_add_u32 v78, 147456, v78
  v_add_u32 v79, 147456, v79
  ds_read_b32 v80, v64 offset:0
  ds_read_b32 v81, v64 offset:2048
  ds_read_b32 v82, v64 offset:4096
  ds_read_b32 v83, v64 offset:6144
  ds_read_b32 v84, v65 offset:0
  ds_read_b32 v85, v65 offset:2048
  ds_read_b32 v86, v65 offset:4096
  ds_read_b32 v87, v65 offset:6144
  ds_read_b32 v88, v66 offset:0
  ds_read_b32 v89, v66 offset:2048
  ds_read_b32 v90, v66 offset:4096
  ds_read_b32 v91, v66 offset:6144
  ds_read_b32 v92, v67 offset:0
  ds_read_b32 v93, v67 offset:2048
  ds_read_b32 v94, v67 offset:4096
  ds_read_b32 v95, v67 offset:6144
  ds_read_b32 v96, v68 offset:0
  ds_read_b32 v97, v68 offset:2048
  ds_read_b32 v98, v68 offset:4096
  ds_read_b32 v99, v68 offset:6144
  ds_read_b32 v100, v69 offset:0
  ds_read_b32 v101, v69 offset:2048
  ds_read_b32 v102, v69 offset:4096
  ds_read_b32 v103, v69 offset:6144
  ds_read_b32 v104, v70 offset:0
  ds_read_b32 v105, v70 offset:2048
  ds_read_b32 v106, v70 offset:4096
  ds_read_b32 v107, v70 offset:6144
  ds_read_b32 v108, v71 offset:0
  ds_read_b32 v109, v71 offset:2048
  ds_read_b32 v110, v71 offset:4096
  ds_read_b32 v111, v71 offset:6144
  ds_read_b32 v112, v72 offset:0
  ds_read_b32 v113, v72 offset:2048
  ds_read_b32 v114, v72 offset:4096
  ds_read_b32 v115, v72 offset:6144
  ds_read_b32 v116, v73 offset:0
  ds_read_b32 v117, v73 offset:2048
  ds_read_b32 v118, v73 offset:4096
  ds_read_b32 v119, v73 offset:6144
  ds_read_b32 v120, v74 offset:0
  ds_read_b32 v121, v74 offset:2048
  ds_read_b32 v122, v74 offset:4096
  ds_read_b32 v123, v74 offset:6144
  ds_read_b32 v124, v75 offset:0
  ds_read_b32 v125, v75 offset:2048
  ds_read_b32 v126, v75 offset:4096
  ds_read_b32 v127, v75 offset:6144
  ds_read_b32 v128, v76 offset:0
  ds_read_b32 v129, v76 offset:2048
  ds_read_b32 v130, v76 offset:4096
  ds_read_b32 v131, v76 offset:6144
  ds_read_b32 v132, v77 offset:0
  ds_read_b32 v133, v77 offset:2048
  ds_read_b32 v134, v77 offset:4096
  ds_read_b32 v135, v77 offset:6144
  ds_read_b32 v136, v78 offset:0
  ds_read_b32 v137, v78 offset:2048
  ds_read_b32 v138, v78 offset:4096
  ds_read_b32 v139, v78 offset:6144
  ds_read_b32 v140, v79 offset:0
  ds_read_b32 v141, v79 offset:2048
  ds_read_b32 v142, v79 offset:4096
  ds_read_b32 v143, v79 offset:6144
  v_mov_b32 v16, 148860
  s_waitcnt lgkmcnt(0)
  v_add_f32 v80, v80, v81
  v_add_f32 v82, v82, v83
  v_cmp_eq_u32 vcc, v16, v64
  v_add_f32 v80, v80, v82
  s_nop 0
  v_cndmask_b32_e64 v80, v80, 0, vcc
  v_add_f32 v84, v84, v85
  v_add_f32 v86, v86, v87
  v_cmp_eq_u32 vcc, v16, v65
  v_add_f32 v84, v84, v86
  s_nop 0
  v_cndmask_b32_e64 v84, v84, 0, vcc
  v_add_f32 v88, v88, v89
  v_add_f32 v90, v90, v91
  v_cmp_eq_u32 vcc, v16, v66
  v_add_f32 v88, v88, v90
  s_nop 0
  v_cndmask_b32_e64 v88, v88, 0, vcc
  v_add_f32 v92, v92, v93
  v_add_f32 v94, v94, v95
  v_cmp_eq_u32 vcc, v16, v67
  v_add_f32 v92, v92, v94
  s_nop 0
  v_cndmask_b32_e64 v92, v92, 0, vcc
  v_add_f32 v96, v96, v97
  v_add_f32 v98, v98, v99
  v_cmp_eq_u32 vcc, v16, v68
  v_add_f32 v96, v96, v98
  s_nop 0
  v_cndmask_b32_e64 v96, v96, 0, vcc
  v_add_f32 v100, v100, v101
  v_add_f32 v102, v102, v103
  v_cmp_eq_u32 vcc, v16, v69
  v_add_f32 v100, v100, v102
  s_nop 0
  v_cndmask_b32_e64 v100, v100, 0, vcc
  v_add_f32 v104, v104, v105
  v_add_f32 v106, v106, v107
  v_cmp_eq_u32 vcc, v16, v70
  v_add_f32 v104, v104, v106
  s_nop 0
  v_cndmask_b32_e64 v104, v104, 0, vcc
  v_add_f32 v108, v108, v109
  v_add_f32 v110, v110, v111
  v_cmp_eq_u32 vcc, v16, v71
  v_add_f32 v108, v108, v110
  s_nop 0
  v_cndmask_b32_e64 v108, v108, 0, vcc
  v_add_f32 v112, v112, v113
  v_add_f32 v114, v114, v115
  v_cmp_eq_u32 vcc, v16, v72
  v_add_f32 v112, v112, v114
  s_nop 0
  v_cndmask_b32_e64 v112, v112, 0, vcc
  v_add_f32 v116, v116, v117
  v_add_f32 v118, v118, v119
  v_cmp_eq_u32 vcc, v16, v73
  v_add_f32 v116, v116, v118
  s_nop 0
  v_cndmask_b32_e64 v116, v116, 0, vcc
  v_add_f32 v120, v120, v121
  v_add_f32 v122, v122, v123
  v_cmp_eq_u32 vcc, v16, v74
  v_add_f32 v120, v120, v122
  s_nop 0
  v_cndmask_b32_e64 v120, v120, 0, vcc
  v_add_f32 v124, v124, v125
  v_add_f32 v126, v126, v127
  v_cmp_eq_u32 vcc, v16, v75
  v_add_f32 v124, v124, v126
  s_nop 0
  v_cndmask_b32_e64 v124, v124, 0, vcc
  v_add_f32 v128, v128, v129
  v_add_f32 v130, v130, v131
  v_cmp_eq_u32 vcc, v16, v76
  v_add_f32 v128, v128, v130
  s_nop 0
  v_cndmask_b32_e64 v128, v128, 0, vcc
  v_add_f32 v132, v132, v133
  v_add_f32 v134, v134, v135
  v_cmp_eq_u32 vcc, v16, v77
  v_add_f32 v132, v132, v134
  s_nop 0
  v_cndmask_b32_e64 v132, v132, 0, vcc
  v_add_f32 v136, v136, v137
  v_add_f32 v138, v138, v139
  v_cmp_eq_u32 vcc, v16, v78
  v_add_f32 v136, v136, v138
  s_nop 0
  v_cndmask_b32_e64 v136, v136, 0, vcc
  v_add_f32 v140, v140, v141
  v_add_f32 v142, v142, v143
  v_cmp_eq_u32 vcc, v16, v79
  v_add_f32 v140, v140, v142
  s_nop 0
  v_cndmask_b32_e64 v140, v140, 0, vcc
  v_cvt_pk_bf16_f32 v32, v80, v84
  v_cvt_pk_bf16_f32 v33, v88, v92
  v_cvt_pk_bf16_f32 v34, v96, v100
  v_cvt_pk_bf16_f32 v35, v104, v108
  v_cvt_pk_bf16_f32 v36, v112, v116
  v_cvt_pk_bf16_f32 v37, v120, v124
  v_cvt_pk_bf16_f32 v38, v128, v132
  v_cvt_pk_bf16_f32 v39, v136, v140
  v_mov_b32 v16, 0xfffffffe
  v_min_u32 v32, v16, v32
  v_min_u32 v33, v16, v33
  v_min_u32 v34, v16, v34
  v_min_u32 v35, v16, v35
  v_min_u32 v36, v16, v36
  v_min_u32 v37, v16, v37
  v_min_u32 v38, v16, v38
  v_min_u32 v39, v16, v39
  s_lshl_b32 s34, s2, 11
  buffer_store_dwordx4 v[32:35], v1, s[24:27], s34 offen sc1
  buffer_store_dwordx4 v[36:39], v1, s[24:27], s34 offen offset:1024 sc1
  s_nop 1
k2_prod2:
k2_noprod:
  s_add_u32 s20, s10, 0x2c00000
  s_addc_u32 s21, s11, 0
  s_mov_b32 s22, 0x300000
  s_mov_b32 s23, 0x00020000
  s_mov_b32 s16, s4
  s_mov_b32 s17, s5
  s_mov_b32 s18, 0xa2000
  s_mov_b32 s19, 0x00020000
  s_mul_i32 s37, s3, 165888
  s_mul_i32 s38, s13, 288
  s_add_u32 s37, s37, s38
  s_mul_i32 s32, s3, 36864
  v_add_u32 v20, 0, v0
  v_mul_u32_u24 v21, 3641, v20
  v_lshrrev_b32 v21, 16, v21
  v_mul_u32_u24 v22, 18, v21
  v_sub_u32 v22, v20, v22
  v_lshrrev_b32 v23, 4, v21
  v_lshl_add_u32 v21, v23, 1, v21
  v_mul_u32_u24 v21, 1152, v21
  v_lshl_add_u32 v8, v22, 4, v21
  v_add_u32 v20, 64, v0
  v_mul_u32_u24 v21, 3641, v20
  v_lshrrev_b32 v21, 16, v21
  v_mul_u32_u24 v22, 18, v21
  v_sub_u32 v22, v20, v22
  v_lshrrev_b32 v23, 4, v21
  v_lshl_add_u32 v21, v23, 1, v21
  v_mul_u32_u24 v21, 1152, v21
  v_lshl_add_u32 v9, v22, 4, v21
  v_add_u32 v20, 128, v0
  v_mul_u32_u24 v21, 3641, v20
  v_lshrrev_b32 v21, 16, v21
  v_mul_u32_u24 v22, 18, v21
  v_sub_u32 v22, v20, v22
  v_lshrrev_b32 v23, 4, v21
  v_lshl_add_u32 v21, v23, 1, v21
  v_mul_u32_u24 v21, 1152, v21
  v_lshl_add_u32 v10, v22, 4, v21
  v_add_u32 v20, 192, v0
  v_mul_u32_u24 v21, 3641, v20
  v_lshrrev_b32 v21, 16, v21
  v_mul_u32_u24 v22, 18, v21
  v_sub_u32 v22, v20, v22
  v_lshrrev_b32 v23, 4, v21
  v_lshl_add_u32 v21, v23, 1, v21
  v_mul_u32_u24 v21, 1152, v21
  v_lshl_add_u32 v11, v22, 4, v21
  v_add_u32 v20, 256, v0
  v_mul_u32_u24 v21, 3641, v20
  v_lshrrev_b32 v21, 16, v21
  v_mul_u32_u24 v22, 18, v21
  v_sub_u32 v22, v20, v22
  v_lshrrev_b32 v23, 4, v21
  v_lshl_add_u32 v21, v23, 1, v21
  v_mul_u32_u24 v21, 1152, v21
  v_lshl_add_u32 v12, v22, 4, v21
  v_add_u32 v20, 320, v0
  v_mul_u32_u24 v21, 3641, v20
  v_lshrrev_b32 v21, 16, v21
  v_mul_u32_u24 v22, 18, v21
  v_sub_u32 v22, v20, v22
  v_lshrrev_b32 v23, 4, v21
  v_lshl_add_u32 v21, v23, 1, v21
  v_mul_u32_u24 v21, 1152, v21
  v_lshl_add_u32 v13, v22, 4, v21
  v_add_u32 v20, 384, v0
  v_mul_u32_u24 v21, 3641, v20
  v_lshrrev_b32 v21, 16, v21
  v_mul_u32_u24 v22, 18, v21
  v_sub_u32 v22, v20, v22
  v_lshrrev_b32 v23, 4, v21
  v_lshl_add_u32 v21, v23, 1, v21
  v_mul_u32_u24 v21, 1152, v21
  v_lshl_add_u32 v14, v22, 4, v21
  v_add_u32 v20, 448, v0
  v_mul_u32_u24 v21, 3641, v20
  v_lshrrev_b32 v21, 16, v21
  v_mul_u32_u24 v22, 18, v21
  v_sub_u32 v22, v20, v22
  v_lshrrev_b32 v23, 4, v21
  v_lshl_add_u32 v21, v23, 1, v21
  v_mul_u32_u24 v21, 1152, v21
  v_lshl_add_u32 v15, v22, 4, v21
  v_add_u32 v20, 512, v0
  v_mul_u32_u24 v21, 3641, v20
  v_lshrrev_b32 v21, 16, v21
  v_mul_u32_u24 v22, 18, v21
  v_sub_u32 v22, v20, v22
  v_lshrrev_b32 v23, 4, v21
  v_lshl_add_u32 v21, v23, 1, v21
  v_mul_u32_u24 v21, 1152, v21
  v_lshl_add_u32 v16, v22, 4, v21
  s_lshl_b32 s34, s14, 5
  s_lshl_b32 s35, s3, 2
  s_add_u32 s34, s34, s35
  s_mul_i32 s39, s34, 1536
  s_add_u32 s35, s39, 0
  buffer_load_dwordx4 v[32:35], v1, s[20:23], s35 offen
  buffer_load_dwordx2 v[36:37], v2, s[20:23], s35 offen offset:1024
  s_add_u32 s35, s39, 24576
  buffer_load_dwordx4 v[38:41], v1, s[20:23], s35 offen
  buffer_load_dwordx2 v[42:43], v2, s[20:23], s35 offen offset:1024
  s_add_u32 s35, s39, 1536
  buffer_load_dwordx4 v[44:47], v1, s[20:23], s35 offen
  buffer_load_dwordx2 v[48:49], v2, s[20:23], s35 offen offset:1024
  s_add_u32 s35, s39, 26112
  buffer_load_dwordx4 v[50:53], v1, s[20:23], s35 offen
  buffer_load_dwordx2 v[54:55], v2, s[20:23], s35 offen offset:1024
  s_add_u32 s35, s39, 3072
  buffer_load_dwordx4 v[56:59], v1, s[20:23], s35 offen
  buffer_load_dwordx2 v[60:61], v2, s[20:23], s35 offen offset:1024
  s_add_u32 s35, s39, 27648
  buffer_load_dwordx4 v[62:65], v1, s[20:23], s35 offen
  buffer_load_dwordx2 v[66:67], v2, s[20:23], s35 offen offset:1024
  s_add_u32 s35, s39, 4608
  buffer_load_dwordx4 v[68:71], v1, s[20:23], s35 offen
  buffer_load_dwordx2 v[72:73], v2, s[20:23], s35 offen offset:1024
  s_add_u32 s35, s39, 29184
  buffer_load_dwordx4 v[74:77], v1, s[20:23], s35 offen
  buffer_load_dwordx2 v[78:79], v2, s[20:23], s35 offen offset:1024
  s_add_u32 m0, s32, 0
  s_add_u32 s34, s37, 0
  buffer_load_dwordx4 v8, s[16:19], s34 offen lds
  s_add_u32 m0, s32, 1024
  s_add_u32 s34, s37, 0
  buffer_load_dwordx4 v9, s[16:19], s34 offen lds
  s_add_u32 m0, s32, 2048
  s_add_u32 s34, s37, 0
  buffer_load_dwordx4 v10, s[16:19], s34 offen lds
  s_add_u32 m0, s32, 3072
  s_add_u32 s34, s37, 0
  buffer_load_dwordx4 v11, s[16:19], s34 offen lds
  s_add_u32 m0, s32, 4096
  s_add_u32 s34, s37, 0
  buffer_load_dwordx4 v12, s[16:19], s34 offen lds
  s_add_u32 m0, s32, 5120
  s_add_u32 s34, s37, 0
  buffer_load_dwordx4 v13, s[16:19], s34 offen lds
  s_add_u32 m0, s32, 6144
  s_add_u32 s34, s37, 0
  buffer_load_dwordx4 v14, s[16:19], s34 offen lds
  s_add_u32 m0, s32, 7168
  s_add_u32 s34, s37, 0
  buffer_load_dwordx4 v15, s[16:19], s34 offen lds
  s_add_u32 m0, s32, 8192
  s_add_u32 s34, s37, 0
  buffer_load_dwordx4 v16, s[16:19], s34 offen lds
  s_add_u32 m0, s32, 9216
  s_add_u32 s34, s37, 41472
  buffer_load_dwordx4 v8, s[16:19], s34 offen lds
  s_add_u32 m0, s32, 10240
  s_add_u32 s34, s37, 41472
  buffer_load_dwordx4 v9, s[16:19], s34 offen lds
  s_add_u32 m0, s32, 11264
  s_add_u32 s34, s37, 41472
  buffer_load_dwordx4 v10, s[16:19], s34 offen lds
  s_add_u32 m0, s32, 12288
  s_add_u32 s34, s37, 41472
  buffer_load_dwordx4 v11, s[16:19], s34 offen lds
  s_add_u32 m0, s32, 13312
  s_add_u32 s34, s37, 41472
  buffer_load_dwordx4 v12, s[16:19], s34 offen lds
  s_add_u32 m0, s32, 14336
  s_add_u32 s34, s37, 41472
  buffer_load_dwordx4 v13, s[16:19], s34 offen lds
  s_add_u32 m0, s32, 15360
  s_add_u32 s34, s37, 41472
  buffer_load_dwordx4 v14, s[16:19], s34 offen lds
  s_add_u32 m0, s32, 16384
  s_add_u32 s34, s37, 41472
  buffer_load_dwordx4 v15, s[16:19], s34 offen lds
  s_add_u32 m0, s32, 17408
  s_add_u32 s34, s37, 41472
  buffer_load_dwordx4 v16, s[16:19], s34 offen lds
  s_mov_b32 s28, s6
  s_mov_b32 s29, s7
  s_mov_b32 s30, 0x240000
  s_mov_b32 s31, 0x00020000
  v_and_b32 v20, 15, v0
  s_lshl_b32 s34, s14, 5
  s_and_b32 s35, s3, 1
  s_lshl_b32 s35, s35, 4
  s_add_u32 s34, s34, s35
  v_add_u32 v20, s34, v20
  v_mul_u32_u24 v20, 1152, v20
  v_lshrrev_b32 v21, 4, v0
  v_lshl_add_u32 v20, v21, 3, v20
  v_add_u32 v5, s38, v20
  v_lshrrev_b32 v20, 2, v0
  v_mul_u32_u24 v20, 288, v20
  v_and_b32 v21, 3, v0
  v_lshl_add_u32 v20, v21, 3, v20
  v_add_u32 v3, s32, v20
  v_add_u32 v20, 0, v0
  v_mul_u32_u24 v21, 3641, v20
  v_lshrrev_b32 v21, 16, v21
  v_mul_u32_u24 v22, 18, v21
  v_sub_u32 v22, v20, v22
  v_bfe_u32 v23, v21, 2, 2
  v_bfe_u32 v24, v21, 1, 1
  v_lshl_add_u32 v23, v24, 2, v23
  v_mul_u32_u24 v23, 18, v23
  v_and_b32 v24, 1, v21
  v_add3_u32 v23, v23, v24, 16
  v_mul_u32_u24 v23, 1152, v23
  v_lshl_add_u32 v25, v22, 4, v23
  v_add_u32 v20, 64, v0
  v_mul_u32_u24 v21, 3641, v20
  v_lshrrev_b32 v21, 16, v21
  v_mul_u32_u24 v22, 18, v21
  v_sub_u32 v22, v20, v22
  v_bfe_u32 v23, v21, 2, 2
  v_bfe_u32 v24, v21, 1, 1
  v_lshl_add_u32 v23, v24, 2, v23
  v_mul_u32_u24 v23, 18, v23
  v_and_b32 v24, 1, v21
  v_add3_u32 v23, v23, v24, 16
  v_mul_u32_u24 v23, 1152, v23
  v_lshl_add_u32 v26, v22, 4, v23
  v_add_u32 v20, 128, v0
  v_mul_u32_u24 v21, 3641, v20
  v_lshrrev_b32 v21, 16, v21
  v_mul_u32_u24 v22, 18, v21
  v_sub_u32 v22, v20, v22
  v_bfe_u32 v23, v21, 2, 2
  v_bfe_u32 v24, v21, 1, 1
  v_lshl_add_u32 v23, v24, 2, v23
  v_mul_u32_u24 v23, 18, v23
  v_and_b32 v24, 1, v21
  v_add3_u32 v23, v23, v24, 16
  v_mul_u32_u24 v23, 1152, v23
  v_lshl_add_u32 v27, v22, 4, v23
  v_add_u32 v20, 192, v0
  v_mul_u32_u24 v21, 3641, v20
  v_lshrrev_b32 v21, 16, v21
  v_mul_u32_u24 v22, 18, v21
  v_sub_u32 v22, v20, v22
  v_bfe_u32 v23, v21, 2, 2
  v_bfe_u32 v24, v21, 1, 1
  v_lshl_add_u32 v23, v24, 2, v23
  v_mul_u32_u24 v23, 18, v23
  v_and_b32 v24, 1, v21
  v_add3_u32 v23, v23, v24, 16
  v_mul_u32_u24 v23, 1152, v23
  v_lshl_add_u32 v28, v22, 4, v23
  v_add_u32 v20, 256, v0
  v_mul_u32_u24 v21, 3641, v20
  v_lshrrev_b32 v21, 16, v21
  v_mul_u32_u24 v22, 18, v21
  v_sub_u32 v22, v20, v22
  v_bfe_u32 v23, v21, 2, 2
  v_bfe_u32 v24, v21, 1, 1
  v_lshl_add_u32 v23, v24, 2, v23
  v_mul_u32_u24 v23, 18, v23
  v_and_b32 v24, 1, v21
  v_add3_u32 v23, v23, v24, 16
  v_mul_u32_u24 v23, 1152, v23
  v_lshl_add_u32 v29, v22, 4, v23
  v_mov_b32 v160, 0
  v_mov_b32 v161, 0
  v_mov_b32 v162, 0
  v_mov_b32 v163, 0
  v_mov_b32 v180, 0
  v_mov_b32 v181, 0
  v_mov_b32 v182, 0
  v_mov_b32 v183, 0
  v_mov_b32 v31, 0x358637bd
  s_waitcnt vmcnt(9)
  ds_read_b64_tr_b16 a[168:169], v3 offset:0
  ds_read_b64_tr_b16 a[170:171], v3 offset:4608
  ds_read_b64_tr_b16 a[172:173], v3 offset:32
  ds_read_b64_tr_b16 a[174:175], v3 offset:4640
  ds_read_b64_tr_b16 a[176:177], v3 offset:64
  ds_read_b64_tr_b16 a[178:179], v3 offset:4672
  ds_read_b64_tr_b16 a[180:181], v3 offset:96
  ds_read_b64_tr_b16 a[182:183], v3 offset:4704
  ds_read_b64_tr_b16 a[184:185], v3 offset:128
  ds_read_b64_tr_b16 a[186:187], v3 offset:4736
  ds_read_b64_tr_b16 a[188:189], v3 offset:160
  ds_read_b64_tr_b16 a[190:191], v3 offset:4768
  ds_read_b64_tr_b16 a[192:193], v3 offset:192
  ds_read_b64_tr_b16 a[194:195], v3 offset:4800
  ds_read_b64_tr_b16 a[196:197], v3 offset:224
  ds_read_b64_tr_b16 a[198:199], v3 offset:4832
  ds_read_b64_tr_b16 a[200:201], v3 offset:256
  ds_read_b64_tr_b16 a[202:203], v3 offset:4864
  s_waitcnt lgkmcnt(0)
  s_add_u32 m0, s32, 0
  s_nop 0
  buffer_load_dwordx4 v25, s[16:19], s37 offen lds
  s_add_u32 m0, s32, 1024
  s_nop 0
  buffer_load_dwordx4 v26, s[16:19], s37 offen lds
  s_add_u32 m0, s32, 2048
  s_nop 0
  buffer_load_dwordx4 v27, s[16:19], s37 offen lds
  s_add_u32 m0, s32, 3072
  s_nop 0
  buffer_load_dwordx4 v28, s[16:19], s37 offen lds
  s_add_u32 m0, s32, 4096
  s_nop 0
  buffer_load_dwordx4 v29, s[16:19], s37 offen lds
  s_lshl_b32 s36, s3, 14
  s_mov_b32 s33, 0
k2_poll1:
  s_add_u32 s35, s36, 0
  buffer_load_dwordx4 v[80:83], v1, s[24:27], s35 offen sc1
  s_add_u32 s35, s36, 1024
  buffer_load_dwordx4 v[84:87], v1, s[24:27], s35 offen sc1
  s_add_u32 s35, s36, 2048
  buffer_load_dwordx4 v[88:91], v1, s[24:27], s35 offen sc1
  s_add_u32 s35, s36, 3072
  buffer_load_dwordx4 v[92:95], v1, s[24:27], s35 offen sc1
  s_add_u32 s35, s36, 4096
  buffer_load_dwordx4 v[96:99], v1, s[24:27], s35 offen sc1
  s_add_u32 s35, s36, 5120
  buffer_load_dwordx4 v[100:103], v1, s[24:27], s35 offen sc1
  s_add_u32 s35, s36, 6144
  buffer_load_dwordx4 v[104:107], v1, s[24:27], s35 offen sc1
  s_add_u32 s35, s36, 7168
  buffer_load_dwordx4 v[108:111], v1, s[24:27], s35 offen sc1
  s_add_u32 s35, s36, 8192
  buffer_load_dwordx4 v[112:115], v1, s[24:27], s35 offen sc1
  s_add_u32 s35, s36, 9216
  buffer_load_dwordx4 v[116:119], v1, s[24:27], s35 offen sc1
  s_add_u32 s35, s36, 10240
  buffer_load_dwordx4 v[120:123], v1, s[24:27], s35 offen sc1
  s_add_u32 s35, s36, 11264
  buffer_load_dwordx4 v[124:127], v1, s[24:27], s35 offen sc1
  s_add_u32 s35, s36, 12288
  buffer_load_dwordx4 v[128:131], v1, s[24:27], s35 offen sc1
  s_add_u32 s35, s36, 13312
  buffer_load_dwordx4 v[132:135], v1, s[24:27], s35 offen sc1
  s_add_u32 s35, s36, 14336
  buffer_load_dwordx4 v[136:139], v1, s[24:27], s35 offen sc1
  s_add_u32 s35, s36, 15360
  buffer_load_dwordx4 v[140:143], v1, s[24:27], s35 offen sc1
  s_waitcnt vmcnt(0)
  v_max_u32 v20, v80, v81
  v_max3_u32 v20, v20, v82, v83
  v_max3_u32 v20, v20, v84, v85
  v_max3_u32 v20, v20, v86, v87
  v_max3_u32 v20, v20, v88, v89
  v_max3_u32 v20, v20, v90, v91
  v_max3_u32 v20, v20, v92, v93
  v_max3_u32 v20, v20, v94, v95
  v_max3_u32 v20, v20, v96, v97
  v_max3_u32 v20, v20, v98, v99
  v_max3_u32 v20, v20, v100, v101
  v_max3_u32 v20, v20, v102, v103
  v_max3_u32 v20, v20, v104, v105
  v_max3_u32 v20, v20, v106, v107
  v_max3_u32 v20, v20, v108, v109
  v_max3_u32 v20, v20, v110, v111
  v_max3_u32 v20, v20, v112, v113
  v_max3_u32 v20, v20, v114, v115
  v_max3_u32 v20, v20, v116, v117
  v_max3_u32 v20, v20, v118, v119
  v_max3_u32 v20, v20, v120, v121
  v_max3_u32 v20, v20, v122, v123
  v_max3_u32 v20, v20, v124, v125
  v_max3_u32 v20, v20, v126, v127
  v_max3_u32 v20, v20, v128, v129
  v_max3_u32 v20, v20, v130, v131
  v_max3_u32 v20, v20, v132, v133
  v_max3_u32 v20, v20, v134, v135
  v_max3_u32 v20, v20, v136, v137
  v_max3_u32 v20, v20, v138, v139
  v_max3_u32 v20, v20, v140, v141
  v_max3_u32 v20, v20, v142, v143
  v_cmp_eq_u32 vcc, -1, v20
  s_cbranch_vccz k2_done2
  s_sleep 8
  s_add_u32 s33, s33, 1
  s_cmp_lt_u32 s33, 0x8000
  s_cbranch_scc1 k2_poll1
k2_done2:
  s_add_u32 m0, s32, 18432
  s_add_u32 s34, s37, 82944
  buffer_load_dwordx4 v8, s[16:19], s34 offen lds
  s_add_u32 m0, s32, 19456
  s_add_u32 s34, s37, 82944
  buffer_load_dwordx4 v9, s[16:19], s34 offen lds
  s_add_u32 m0, s32, 20480
  s_add_u32 s34, s37, 82944
  buffer_load_dwordx4 v10, s[16:19], s34 offen lds
  s_add_u32 m0, s32, 21504
  s_add_u32 s34, s37, 82944
  buffer_load_dwordx4 v11, s[16:19], s34 offen lds
  s_add_u32 m0, s32, 22528
  s_add_u32 s34, s37, 82944
  buffer_load_dwordx4 v12, s[16:19], s34 offen lds
  s_add_u32 m0, s32, 23552
  s_add_u32 s34, s37, 82944
  buffer_load_dwordx4 v13, s[16:19], s34 offen lds
  s_add_u32 m0, s32, 24576
  s_add_u32 s34, s37, 82944
  buffer_load_dwordx4 v14, s[16:19], s34 offen lds
  s_add_u32 m0, s32, 25600
  s_add_u32 s34, s37, 82944
  buffer_load_dwordx4 v15, s[16:19], s34 offen lds
  s_add_u32 m0, s32, 26624
  s_add_u32 s34, s37, 82944
  buffer_load_dwordx4 v16, s[16:19], s34 offen lds
  s_add_u32 m0, s32, 27648
  s_add_u32 s34, s37, 124416
  buffer_load_dwordx4 v8, s[16:19], s34 offen lds
  s_add_u32 m0, s32, 28672
  s_add_u32 s34, s37, 124416
  buffer_load_dwordx4 v9, s[16:19], s34 offen lds
  s_add_u32 m0, s32, 29696
  s_add_u32 s34, s37, 124416
  buffer_load_dwordx4 v10, s[16:19], s34 offen lds
  s_add_u32 m0, s32, 30720
  s_add_u32 s34, s37, 124416
  buffer_load_dwordx4 v11, s[16:19], s34 offen lds
  s_add_u32 m0, s32, 31744
  s_add_u32 s34, s37, 124416
  buffer_load_dwordx4 v12, s[16:19], s34 offen lds
  s_add_u32 m0, s32, 32768
  s_add_u32 s34, s37, 124416
  buffer_load_dwordx4 v13, s[16:19], s34 offen lds
  s_add_u32 m0, s32, 33792
  s_add_u32 s34, s37, 124416
  buffer_load_dwordx4 v14, s[16:19], s34 offen lds
  s_add_u32 m0, s32, 34816
  s_add_u32 s34, s37, 124416
  buffer_load_dwordx4 v15, s[16:19], s34 offen lds
  s_add_u32 m0, s32, 35840
  s_add_u32 s34, s37, 124416
  buffer_load_dwordx4 v16, s[16:19], s34 offen lds
  v_mfma_f32_16x16x32_bf16 v[184:187], v[80:83], v[32:35], 0
  v_mfma_f32_16x16x32_bf16 v[188:191], v[84:87], v[32:35], 0
  v_mfma_f32_16x16x32_bf16 v[192:195], v[88:91], v[34:37], 0
  v_mfma_f32_16x16x32_bf16 v[196:199], v[92:95], v[34:37], 0
  v_mfma_f32_16x16x32_bf16 v[200:203], v[80:83], v[38:41], 0
  v_mfma_f32_16x16x32_bf16 v[204:207], v[84:87], v[38:41], 0
  v_mfma_f32_16x16x32_bf16 v[208:211], v[88:91], v[40:43], 0
  v_mfma_f32_16x16x32_bf16 v[212:215], v[92:95], v[40:43], 0
  v_mfma_f32_16x16x32_bf16 v[216:219], v[96:99], v[44:47], 0
  v_mfma_f32_16x16x32_bf16 v[220:223], v[100:103], v[44:47], 0
  v_mfma_f32_16x16x32_bf16 v[224:227], v[104:107], v[46:49], 0
  v_mfma_f32_16x16x32_bf16 v[228:231], v[108:111], v[46:49], 0
  v_mfma_f32_16x16x32_bf16 v[232:235], v[96:99], v[50:53], 0
  v_mfma_f32_16x16x32_bf16 v[236:239], v[100:103], v[50:53], 0
  v_mfma_f32_16x16x32_bf16 v[240:243], v[104:107], v[52:55], 0
  v_mfma_f32_16x16x32_bf16 v[244:247], v[108:111], v[52:55], 0
  v_add_f32 v190, v31, v190
  v_rcp_f32 v190, v190
  v_add_f32 v198, v31, v198
  v_rcp_f32 v198, v198
  v_add_f32 v206, v31, v206
  v_rcp_f32 v206, v206
  v_add_f32 v214, v31, v214
  v_rcp_f32 v214, v214
  v_mul_f32 v184, v184, v190
  v_mul_f32 v185, v185, v190
  v_mul_f32 v186, v186, v190
  v_mul_f32 v187, v187, v190
  v_mul_f32 v188, v188, v190
  v_mul_f32 v189, v189, v190
  v_cvt_pk_bf16_f32 v144, v184, v185
  v_cvt_pk_bf16_f32 v145, v186, v187
  v_cvt_pk_bf16_f32 v191, v188, v189
  v_or_b32 v160, v160, v191
  v_mul_f32 v192, v192, v198
  v_mul_f32 v193, v193, v198
  v_mul_f32 v194, v194, v198
  v_mul_f32 v195, v195, v198
  v_mul_f32 v196, v196, v198
  v_mul_f32 v197, v197, v198
  v_cvt_pk_bf16_f32 v146, v192, v193
  v_cvt_pk_bf16_f32 v147, v194, v195
  v_cvt_pk_bf16_f32 v199, v196, v197
  v_or_b32 v160, v160, v199
  v_mul_f32 v200, v200, v206
  v_mul_f32 v201, v201, v206
  v_mul_f32 v202, v202, v206
  v_mul_f32 v203, v203, v206
  v_mul_f32 v204, v204, v206
  v_mul_f32 v205, v205, v206
  v_cvt_pk_bf16_f32 v164, v200, v201
  v_cvt_pk_bf16_f32 v165, v202, v203
  v_cvt_pk_bf16_f32 v207, v204, v205
  v_or_b32 v180, v180, v207
  v_mul_f32 v208, v208, v214
  v_mul_f32 v209, v209, v214
  v_mul_f32 v210, v210, v214
  v_mul_f32 v211, v211, v214
  v_mul_f32 v212, v212, v214
  v_mul_f32 v213, v213, v214
  v_cvt_pk_bf16_f32 v166, v208, v209
  v_cvt_pk_bf16_f32 v167, v210, v211
  v_cvt_pk_bf16_f32 v215, v212, v213
  v_or_b32 v180, v180, v215
  v_mfma_f32_16x16x32_bf16 v[184:187], v[112:115], v[56:59], 0
  v_mfma_f32_16x16x32_bf16 v[188:191], v[116:119], v[56:59], 0
  v_mfma_f32_16x16x32_bf16 v[192:195], v[120:123], v[58:61], 0
  v_mfma_f32_16x16x32_bf16 v[196:199], v[124:127], v[58:61], 0
  v_mfma_f32_16x16x32_bf16 v[200:203], v[112:115], v[62:65], 0
  v_mfma_f32_16x16x32_bf16 v[204:207], v[116:119], v[62:65], 0
  v_mfma_f32_16x16x32_bf16 v[208:211], v[120:123], v[64:67], 0
  v_mfma_f32_16x16x32_bf16 v[212:215], v[124:127], v[64:67], 0
  v_add_f32 v222, v31, v222
  v_rcp_f32 v222, v222
  v_add_f32 v230, v31, v230
  v_rcp_f32 v230, v230
  v_add_f32 v238, v31, v238
  v_rcp_f32 v238, v238
  v_add_f32 v246, v31, v246
  v_rcp_f32 v246, v246
  v_mul_f32 v216, v216, v222
  v_mul_f32 v217, v217, v222
  v_mul_f32 v218, v218, v222
  v_mul_f32 v219, v219, v222
  v_mul_f32 v220, v220, v222
  v_mul_f32 v221, v221, v222
  v_cvt_pk_bf16_f32 v148, v216, v217
  v_cvt_pk_bf16_f32 v149, v218, v219
  v_cvt_pk_bf16_f32 v223, v220, v221
  v_or_b32 v160, v160, v223
  v_mul_f32 v224, v224, v230
  v_mul_f32 v225, v225, v230
  v_mul_f32 v226, v226, v230
  v_mul_f32 v227, v227, v230
  v_mul_f32 v228, v228, v230
  v_mul_f32 v229, v229, v230
  v_cvt_pk_bf16_f32 v150, v224, v225
  v_cvt_pk_bf16_f32 v151, v226, v227
  v_cvt_pk_bf16_f32 v231, v228, v229
  v_or_b32 v160, v160, v231
  v_mul_f32 v232, v232, v238
  v_mul_f32 v233, v233, v238
  v_mul_f32 v234, v234, v238
  v_mul_f32 v235, v235, v238
  v_mul_f32 v236, v236, v238
  v_mul_f32 v237, v237, v238
  v_cvt_pk_bf16_f32 v168, v232, v233
  v_cvt_pk_bf16_f32 v169, v234, v235
  v_cvt_pk_bf16_f32 v239, v236, v237
  v_or_b32 v180, v180, v239
  v_mul_f32 v240, v240, v246
  v_mul_f32 v241, v241, v246
  v_mul_f32 v242, v242, v246
  v_mul_f32 v243, v243, v246
  v_mul_f32 v244, v244, v246
  v_mul_f32 v245, v245, v246
  v_cvt_pk_bf16_f32 v170, v240, v241
  v_cvt_pk_bf16_f32 v171, v242, v243
  v_cvt_pk_bf16_f32 v247, v244, v245
  v_or_b32 v180, v180, v247
  v_mfma_f32_16x16x32_bf16 v[216:219], v[128:131], v[68:71], 0
  v_mfma_f32_16x16x32_bf16 v[220:223], v[132:135], v[68:71], 0
  v_mfma_f32_16x16x32_bf16 v[224:227], v[136:139], v[70:73], 0
  v_mfma_f32_16x16x32_bf16 v[228:231], v[140:143], v[70:73], 0
  v_mfma_f32_16x16x32_bf16 v[232:235], v[128:131], v[74:77], 0
  v_mfma_f32_16x16x32_bf16 v[236:239], v[132:135], v[74:77], 0
  v_mfma_f32_16x16x32_bf16 v[240:243], v[136:139], v[76:79], 0
  v_mfma_f32_16x16x32_bf16 v[244:247], v[140:143], v[76:79], 0
  v_add_f32 v190, v31, v190
  v_rcp_f32 v190, v190
  v_add_f32 v198, v31, v198
  v_rcp_f32 v198, v198
  v_add_f32 v206, v31, v206
  v_rcp_f32 v206, v206
  v_add_f32 v214, v31, v214
  v_rcp_f32 v214, v214
  v_mul_f32 v184, v184, v190
  v_mul_f32 v185, v185, v190
  v_mul_f32 v186, v186, v190
  v_mul_f32 v187, v187, v190
  v_mul_f32 v188, v188, v190
  v_mul_f32 v189, v189, v190
  v_cvt_pk_bf16_f32 v152, v184, v185
  v_cvt_pk_bf16_f32 v153, v186, v187
  v_cvt_pk_bf16_f32 v191, v188, v189
  v_or_b32 v161, v161, v191
  v_mul_f32 v192, v192, v198
  v_mul_f32 v193, v193, v198
  v_mul_f32 v194, v194, v198
  v_mul_f32 v195, v195, v198
  v_mul_f32 v196, v196, v198
  v_mul_f32 v197, v197, v198
  v_cvt_pk_bf16_f32 v154, v192, v193
  v_cvt_pk_bf16_f32 v155, v194, v195
  v_cvt_pk_bf16_f32 v199, v196, v197
  v_or_b32 v161, v161, v199
  v_mul_f32 v200, v200, v206
  v_mul_f32 v201, v201, v206
  v_mul_f32 v202, v202, v206
  v_mul_f32 v203, v203, v206
  v_mul_f32 v204, v204, v206
  v_mul_f32 v205, v205, v206
  v_cvt_pk_bf16_f32 v172, v200, v201
  v_cvt_pk_bf16_f32 v173, v202, v203
  v_cvt_pk_bf16_f32 v207, v204, v205
  v_or_b32 v181, v181, v207
  v_mul_f32 v208, v208, v214
  v_mul_f32 v209, v209, v214
  v_mul_f32 v210, v210, v214
  v_mul_f32 v211, v211, v214
  v_mul_f32 v212, v212, v214
  v_mul_f32 v213, v213, v214
  v_cvt_pk_bf16_f32 v174, v208, v209
  v_cvt_pk_bf16_f32 v175, v210, v211
  v_cvt_pk_bf16_f32 v215, v212, v213
  v_or_b32 v181, v181, v215
  s_nop 7
  s_nop 1
  v_add_f32 v222, v31, v222
  v_rcp_f32 v222, v222
  v_add_f32 v230, v31, v230
  v_rcp_f32 v230, v230
  v_add_f32 v238, v31, v238
  v_rcp_f32 v238, v238
  v_add_f32 v246, v31, v246
  v_rcp_f32 v246, v246
  v_mul_f32 v216, v216, v222
  v_mul_f32 v217, v217, v222
  v_mul_f32 v218, v218, v222
  v_mul_f32 v219, v219, v222
  v_mul_f32 v220, v220, v222
  v_mul_f32 v221, v221, v222
  v_cvt_pk_bf16_f32 v156, v216, v217
  v_cvt_pk_bf16_f32 v157, v218, v219
  v_cvt_pk_bf16_f32 v223, v220, v221
  v_or_b32 v161, v161, v223
  v_mul_f32 v224, v224, v230
  v_mul_f32 v225, v225, v230
  v_mul_f32 v226, v226, v230
  v_mul_f32 v227, v227, v230
  v_mul_f32 v228, v228, v230
  v_mul_f32 v229, v229, v230
  v_cvt_pk_bf16_f32 v158, v224, v225
  v_cvt_pk_bf16_f32 v159, v226, v227
  v_cvt_pk_bf16_f32 v231, v228, v229
  v_or_b32 v161, v161, v231
  v_mul_f32 v232, v232, v238
  v_mul_f32 v233, v233, v238
  v_mul_f32 v234, v234, v238
  v_mul_f32 v235, v235, v238
  v_mul_f32 v236, v236, v238
  v_mul_f32 v237, v237, v238
  v_cvt_pk_bf16_f32 v176, v232, v233
  v_cvt_pk_bf16_f32 v177, v234, v235
  v_cvt_pk_bf16_f32 v239, v236, v237
  v_or_b32 v181, v181, v239
  v_mul_f32 v240, v240, v246
  v_mul_f32 v241, v241, v246
  v_mul_f32 v242, v242, v246
  v_mul_f32 v243, v243, v246
  v_mul_f32 v244, v244, v246
  v_mul_f32 v245, v245, v246
  v_cvt_pk_bf16_f32 v178, v240, v241
  v_cvt_pk_bf16_f32 v179, v242, v243
  v_cvt_pk_bf16_f32 v247, v244, v245
  v_or_b32 v181, v181, v247
  s_waitcnt vmcnt(0)
  s_lshl_b32 s40, s2, 1
  s_add_u32 s40, s40, s3
  s_sub_u32 s40, s40, 2
  s_mov_b32 s41, 0
  s_cmp_lt_u32 s3, 2
  s_cbranch_scc1 k2_nojob3
  s_cmp_ge_u32 s40, 432
  s_cbranch_scc1 k2_nojob3
  s_mov_b32 s41, 1
  s_mul_hi_u32 s42, s40, 0x55555556
  s_mul_i32 s43, s42, 3
  s_sub_u32 s43, s40, s43
  s_cmp_ge_u32 s42, 72
  s_cselect_b32 s68, s74, s72
  s_cselect_b32 s69, s75, s73
  s_mov_b32 s70, 5308416
  s_mov_b32 s71, 0x00020000
  s_cselect_b32 s34, 72, 0
  s_sub_u32 s34, s42, s34
  s_lshl_b32 s34, s34, 7
  s_mul_i32 s35, s43, 1769472
  s_add_u32 s34, s34, s35
  v_lshrrev_b32 v6, 3, v0
  v_mul_u32_u24 v6, 9216, v6
  v_and_b32 v7, 7, v0
  v_lshl_add_u32 v6, v7, 4, v6
  s_add_u32 s35, s34, 0
  buffer_load_dwordx4 a[72:75], v6, s[68:71], s35 offen
  s_add_u32 s35, s34, 73728
  buffer_load_dwordx4 a[76:79], v6, s[68:71], s35 offen
  s_add_u32 s35, s34, 147456
  buffer_load_dwordx4 a[80:83], v6, s[68:71], s35 offen
  s_add_u32 s35, s34, 221184
  buffer_load_dwordx4 a[84:87], v6, s[68:71], s35 offen
  s_add_u32 s35, s34, 294912
  buffer_load_dwordx4 a[88:91], v6, s[68:71], s35 offen
  s_add_u32 s35, s34, 368640
  buffer_load_dwordx4 a[92:95], v6, s[68:71], s35 offen
  s_add_u32 s35, s34, 442368
  buffer_load_dwordx4 a[96:99], v6, s[68:71], s35 offen
  s_add_u32 s35, s34, 516096
  buffer_load_dwordx4 a[100:103], v6, s[68:71], s35 offen
  s_add_u32 s35, s34, 589824
  buffer_load_dwordx4 a[104:107], v6, s[68:71], s35 offen
  s_add_u32 s35, s34, 663552
  buffer_load_dwordx4 a[108:111], v6, s[68:71], s35 offen
  s_add_u32 s35, s34, 737280
  buffer_load_dwordx4 a[112:115], v6, s[68:71], s35 offen
  s_add_u32 s35, s34, 811008
  buffer_load_dwordx4 a[116:119], v6, s[68:71], s35 offen
  s_add_u32 s35, s34, 884736
  buffer_load_dwordx4 a[120:123], v6, s[68:71], s35 offen
  s_add_u32 s35, s34, 958464
  buffer_load_dwordx4 a[124:127], v6, s[68:71], s35 offen
  s_add_u32 s35, s34, 1032192
  buffer_load_dwordx4 a[128:131], v6, s[68:71], s35 offen
  s_add_u32 s35, s34, 1105920
  buffer_load_dwordx4 a[132:135], v6, s[68:71], s35 offen
  s_add_u32 s35, s34, 1179648
  buffer_load_dwordx4 a[136:139], v6, s[68:71], s35 offen
  s_add_u32 s35, s34, 1253376
  buffer_load_dwordx4 a[140:143], v6, s[68:71], s35 offen
  s_add_u32 s35, s34, 1327104
  buffer_load_dwordx4 a[144:147], v6, s[68:71], s35 offen
  s_add_u32 s35, s34, 1400832
  buffer_load_dwordx4 a[148:151], v6, s[68:71], s35 offen
  s_add_u32 s35, s34, 1474560
  buffer_load_dwordx4 a[152:155], v6, s[68:71], s35 offen
  s_add_u32 s35, s34, 1548288
  buffer_load_dwordx4 a[156:159], v6, s[68:71], s35 offen
  s_add_u32 s35, s34, 1622016
  buffer_load_dwordx4 a[160:163], v6, s[68:71], s35 offen
  s_add_u32 s35, s34, 1695744
  buffer_load_dwordx4 a[164:167], v6, s[68:71], s35 offen
k2_nojob3:
  buffer_load_dwordx2 v[32:33], v5, s[28:31], 0 offen offset:0
  buffer_load_dwordx2 v[34:35], v5, s[28:31], 0 offen offset:32
  buffer_load_dwordx2 v[36:37], v5, s[28:31], 0 offen offset:64
  buffer_load_dwordx2 v[38:39], v5, s[28:31], 0 offen offset:96
  buffer_load_dwordx2 v[40:41], v5, s[28:31], 0 offen offset:128
  buffer_load_dwordx2 v[42:43], v5, s[28:31], 0 offen offset:160
  buffer_load_dwordx2 v[44:45], v5, s[28:31], 0 offen offset:192
  buffer_load_dwordx2 v[46:47], v5, s[28:31], 0 offen offset:224
  buffer_load_dwordx2 v[48:49], v5, s[28:31], 0 offen offset:256
  v_mfma_f32_16x16x32_bf16 a[0:3], a[168:171], v[144:147], 0
  v_mfma_f32_16x16x32_bf16 a[36:39], a[168:171], v[164:167], 0
  ds_read_b64_tr_b16 v[220:221], v3 offset:9216
  ds_read_b64_tr_b16 v[222:223], v3 offset:13824
  v_mfma_f32_16x16x32_bf16 a[4:7], a[172:175], v[144:147], 0
  v_mfma_f32_16x16x32_bf16 a[40:43], a[172:175], v[164:167], 0
  ds_read_b64_tr_b16 v[224:225], v3 offset:9248
  ds_read_b64_tr_b16 v[226:227], v3 offset:13856
  v_mfma_f32_16x16x32_bf16 a[8:11], a[176:179], v[144:147], 0
  v_mfma_f32_16x16x32_bf16 a[44:47], a[176:179], v[164:167], 0
  ds_read_b64_tr_b16 v[228:229], v3 offset:9280
  ds_read_b64_tr_b16 v[230:231], v3 offset:13888
  v_mfma_f32_16x16x32_bf16 a[12:15], a[180:183], v[144:147], 0
  v_mfma_f32_16x16x32_bf16 a[48:51], a[180:183], v[164:167], 0
  ds_read_b64_tr_b16 v[232:233], v3 offset:9312
  ds_read_b64_tr_b16 v[234:235], v3 offset:13920
  v_mfma_f32_16x16x32_bf16 a[16:19], a[184:187], v[144:147], 0
  v_mfma_f32_16x16x32_bf16 a[52:55], a[184:187], v[164:167], 0
  ds_read_b64_tr_b16 v[236:237], v3 offset:9344
  ds_read_b64_tr_b16 v[238:239], v3 offset:13952
  v_mfma_f32_16x16x32_bf16 a[20:23], a[188:191], v[144:147], 0
  v_mfma_f32_16x16x32_bf16 a[56:59], a[188:191], v[164:167], 0
  ds_read_b64_tr_b16 v[240:241], v3 offset:9376
  ds_read_b64_tr_b16 v[242:243], v3 offset:13984
  v_mfma_f32_16x16x32_bf16 a[24:27], a[192:195], v[144:147], 0
  v_mfma_f32_16x16x32_bf16 a[60:63], a[192:195], v[164:167], 0
  ds_read_b64_tr_b16 v[244:245], v3 offset:9408
  ds_read_b64_tr_b16 v[246:247], v3 offset:14016
  v_mfma_f32_16x16x32_bf16 a[28:31], a[196:199], v[144:147], 0
  v_mfma_f32_16x16x32_bf16 a[64:67], a[196:199], v[164:167], 0
  ds_read_b64_tr_b16 v[248:249], v3 offset:9440
  ds_read_b64_tr_b16 v[250:251], v3 offset:14048
  v_mfma_f32_16x16x32_bf16 a[32:35], a[200:203], v[144:147], 0
  v_mfma_f32_16x16x32_bf16 a[68:71], a[200:203], v[164:167], 0
  ds_read_b64_tr_b16 v[252:253], v3 offset:9472
  ds_read_b64_tr_b16 v[254:255], v3 offset:14080
  s_waitcnt lgkmcnt(15)
  v_mfma_f32_16x16x32_bf16 a[0:3], v[220:223], v[148:151], a[0:3]
  v_mfma_f32_16x16x32_bf16 a[36:39], v[220:223], v[168:171], a[36:39]
  ds_read_b64_tr_b16 v[184:185], v3 offset:18432
  ds_read_b64_tr_b16 v[186:187], v3 offset:23040
  s_waitcnt lgkmcnt(15)
  v_mfma_f32_16x16x32_bf16 a[4:7], v[224:227], v[148:151], a[4:7]
  v_mfma_f32_16x16x32_bf16 a[40:43], v[224:227], v[168:171], a[40:43]
  ds_read_b64_tr_b16 v[188:189], v3 offset:18464
  ds_read_b64_tr_b16 v[190:191], v3 offset:23072
  s_waitcnt lgkmcnt(15)
  v_mfma_f32_16x16x32_bf16 a[8:11], v[228:231], v[148:151], a[8:11]
  v_mfma_f32_16x16x32_bf16 a[44:47], v[228:231], v[168:171], a[44:47]
  ds_read_b64_tr_b16 v[192:193], v3 offset:18496
  ds_read_b64_tr_b16 v[194:195], v3 offset:23104
  s_waitcnt lgkmcnt(15)
  v_mfma_f32_16x16x32_bf16 a[12:15], v[232:235], v[148:151], a[12:15]
  v_mfma_f32_16x16x32_bf16 a[48:51], v[232:235], v[168:171], a[48:51]
  ds_read_b64_tr_b16 v[196:197], v3 offset:18528
  ds_read_b64_tr_b16 v[198:199], v3 offset:23136
  s_waitcnt lgkmcnt(15)
  v_mfma_f32_16x16x32_bf16 a[16:19], v[236:239], v[148:151], a[16:19]
  v_mfma_f32_16x16x32_bf16 a[52:55], v[236:239], v[168:171], a[52:55]
  ds_read_b64_tr_b16 v[200:201], v3 offset:18560
  ds_read_b64_tr_b16 v[202:203], v3 offset:23168
  s_waitcnt lgkmcnt(15)
  v_mfma_f32_16x16x32_bf16 a[20:23], v[240:243], v[148:151], a[20:23]
  v_mfma_f32_16x16x32_bf16 a[56:59], v[240:243], v[168:171], a[56:59]
  ds_read_b64_tr_b16 v[204:205], v3 offset:18592
  ds_read_b64_tr_b16 v[206:207], v3 offset:23200
  s_waitcnt lgkmcnt(15)
  v_mfma_f32_16x16x32_bf16 a[24:27], v[244:247], v[148:151], a[24:27]
  v_mfma_f32_16x16x32_bf16 a[60:63], v[244:247], v[168:171], a[60:63]
  ds_read_b64_tr_b16 v[208:209], v3 offset:18624
  ds_read_b64_tr_b16 v[210:211], v3 offset:23232
  s_waitcnt lgkmcnt(15)
  v_mfma_f32_16x16x32_bf16 a[28:31], v[248:251], v[148:151], a[28:31]
  v_mfma_f32_16x16x32_bf16 a[64:67], v[248:251], v[168:171], a[64:67]
  ds_read_b64_tr_b16 v[212:213], v3 offset:18656
  ds_read_b64_tr_b16 v[214:215], v3 offset:23264
  s_waitcnt lgkmcnt(15)
  v_mfma_f32_16x16x32_bf16 a[32:35], v[252:255], v[148:151], a[32:35]
  v_mfma_f32_16x16x32_bf16 a[68:71], v[252:255], v[168:171], a[68:71]
  ds_read_b64_tr_b16 v[216:217], v3 offset:18688
  ds_read_b64_tr_b16 v[218:219], v3 offset:23296
  s_waitcnt lgkmcnt(15)
  v_mfma_f32_16x16x32_bf16 a[0:3], v[184:187], v[152:155], a[0:3]
  v_mfma_f32_16x16x32_bf16 a[36:39], v[184:187], v[172:175], a[36:39]
  ds_read_b64_tr_b16 v[220:221], v3 offset:27648
  ds_read_b64_tr_b16 v[222:223], v3 offset:32256
  s_waitcnt lgkmcnt(15)
  v_mfma_f32_16x16x32_bf16 a[4:7], v[188:191], v[152:155], a[4:7]
  v_mfma_f32_16x16x32_bf16 a[40:43], v[188:191], v[172:175], a[40:43]
  ds_read_b64_tr_b16 v[224:225], v3 offset:27680
  ds_read_b64_tr_b16 v[226:227], v3 offset:32288
  s_waitcnt lgkmcnt(15)
  v_mfma_f32_16x16x32_bf16 a[8:11], v[192:195], v[152:155], a[8:11]
  v_mfma_f32_16x16x32_bf16 a[44:47], v[192:195], v[172:175], a[44:47]
  ds_read_b64_tr_b16 v[228:229], v3 offset:27712
  ds_read_b64_tr_b16 v[230:231], v3 offset:32320
  s_waitcnt lgkmcnt(15)
  v_mfma_f32_16x16x32_bf16 a[12:15], v[196:199], v[152:155], a[12:15]
  v_mfma_f32_16x16x32_bf16 a[48:51], v[196:199], v[172:175], a[48:51]
  ds_read_b64_tr_b16 v[232:233], v3 offset:27744
  ds_read_b64_tr_b16 v[234:235], v3 offset:32352
  s_waitcnt lgkmcnt(15)
  v_mfma_f32_16x16x32_bf16 a[16:19], v[200:203], v[152:155], a[16:19]
  v_mfma_f32_16x16x32_bf16 a[52:55], v[200:203], v[172:175], a[52:55]
  ds_read_b64_tr_b16 v[236:237], v3 offset:27776
  ds_read_b64_tr_b16 v[238:239], v3 offset:32384
  s_waitcnt lgkmcnt(15)
  v_mfma_f32_16x16x32_bf16 a[20:23], v[204:207], v[152:155], a[20:23]
  v_mfma_f32_16x16x32_bf16 a[56:59], v[204:207], v[172:175], a[56:59]
  ds_read_b64_tr_b16 v[240:241], v3 offset:27808
  ds_read_b64_tr_b16 v[242:243], v3 offset:32416
  s_waitcnt lgkmcnt(15)
  v_mfma_f32_16x16x32_bf16 a[24:27], v[208:211], v[152:155], a[24:27]
  v_mfma_f32_16x16x32_bf16 a[60:63], v[208:211], v[172:175], a[60:63]
  ds_read_b64_tr_b16 v[244:245], v3 offset:27840
  ds_read_b64_tr_b16 v[246:247], v3 offset:32448
  s_waitcnt lgkmcnt(15)
  v_mfma_f32_16x16x32_bf16 a[28:31], v[212:215], v[152:155], a[28:31]
  v_mfma_f32_16x16x32_bf16 a[64:67], v[212:215], v[172:175], a[64:67]
  ds_read_b64_tr_b16 v[248:249], v3 offset:27872
  ds_read_b64_tr_b16 v[250:251], v3 offset:32480
  s_waitcnt lgkmcnt(15)
  v_mfma_f32_16x16x32_bf16 a[32:35], v[216:219], v[152:155], a[32:35]
  v_mfma_f32_16x16x32_bf16 a[68:71], v[216:219], v[172:175], a[68:71]
  ds_read_b64_tr_b16 v[252:253], v3 offset:27904
  ds_read_b64_tr_b16 v[254:255], v3 offset:32512
  s_waitcnt lgkmcnt(15)
  v_mfma_f32_16x16x32_bf16 a[0:3], v[220:223], v[156:159], a[0:3]
  v_mfma_f32_16x16x32_bf16 a[36:39], v[220:223], v[176:179], a[36:39]
  ds_read_b64_tr_b16 v[184:185], v3 offset:0
  ds_read_b64_tr_b16 v[186:187], v3 offset:0
  s_waitcnt lgkmcnt(15)
  v_mfma_f32_16x16x32_bf16 a[4:7], v[224:227], v[156:159], a[4:7]
  v_mfma_f32_16x16x32_bf16 a[40:43], v[224:227], v[176:179], a[40:43]
  ds_read_b64_tr_b16 v[188:189], v3 offset:32
  ds_read_b64_tr_b16 v[190:191], v3 offset:32
  s_waitcnt lgkmcnt(15)
  v_mfma_f32_16x16x32_bf16 a[8:11], v[228:231], v[156:159], a[8:11]
  v_mfma_f32_16x16x32_bf16 a[44:47], v[228:231], v[176:179], a[44:47]
  ds_read_b64_tr_b16 v[192:193], v3 offset:64
  ds_read_b64_tr_b16 v[194:195], v3 offset:64
  s_waitcnt lgkmcnt(15)
  v_mfma_f32_16x16x32_bf16 a[12:15], v[232:235], v[156:159], a[12:15]
  v_mfma_f32_16x16x32_bf16 a[48:51], v[232:235], v[176:179], a[48:51]
  ds_read_b64_tr_b16 v[196:197], v3 offset:96
  ds_read_b64_tr_b16 v[198:199], v3 offset:96
  s_waitcnt lgkmcnt(15)
  v_mfma_f32_16x16x32_bf16 a[16:19], v[236:239], v[156:159], a[16:19]
  v_mfma_f32_16x16x32_bf16 a[52:55], v[236:239], v[176:179], a[52:55]
  ds_read_b64_tr_b16 v[200:201], v3 offset:128
  ds_read_b64_tr_b16 v[202:203], v3 offset:128
  s_waitcnt lgkmcnt(15)
  v_mfma_f32_16x16x32_bf16 a[20:23], v[240:243], v[156:159], a[20:23]
  v_mfma_f32_16x16x32_bf16 a[56:59], v[240:243], v[176:179], a[56:59]
  ds_read_b64_tr_b16 v[204:205], v3 offset:160
  ds_read_b64_tr_b16 v[206:207], v3 offset:160
  s_waitcnt lgkmcnt(15)
  v_mfma_f32_16x16x32_bf16 a[24:27], v[244:247], v[156:159], a[24:27]
  v_mfma_f32_16x16x32_bf16 a[60:63], v[244:247], v[176:179], a[60:63]
  ds_read_b64_tr_b16 v[208:209], v3 offset:192
  ds_read_b64_tr_b16 v[210:211], v3 offset:192
  s_waitcnt lgkmcnt(15)
  v_mfma_f32_16x16x32_bf16 a[28:31], v[248:251], v[156:159], a[28:31]
  v_mfma_f32_16x16x32_bf16 a[64:67], v[248:251], v[176:179], a[64:67]
  ds_read_b64_tr_b16 v[212:213], v3 offset:224
  ds_read_b64_tr_b16 v[214:215], v3 offset:224
  s_waitcnt lgkmcnt(15)
  v_mfma_f32_16x16x32_bf16 a[32:35], v[252:255], v[156:159], a[32:35]
  v_mfma_f32_16x16x32_bf16 a[68:71], v[252:255], v[176:179], a[68:71]
  ds_read_b64_tr_b16 v[216:217], v3 offset:256
  ds_read_b64_tr_b16 v[218:219], v3 offset:256
  s_waitcnt lgkmcnt(15)
  v_mfma_f32_16x16x32_bf16 a[0:3], v[184:187], v[160:163], a[0:3]
  v_mfma_f32_16x16x32_bf16 a[36:39], v[184:187], v[180:183], a[36:39]
  s_waitcnt lgkmcnt(14)
  v_mfma_f32_16x16x32_bf16 a[4:7], v[188:191], v[160:163], a[4:7]
  v_mfma_f32_16x16x32_bf16 a[40:43], v[188:191], v[180:183], a[40:43]
  s_waitcnt lgkmcnt(12)
  v_mfma_f32_16x16x32_bf16 a[8:11], v[192:195], v[160:163], a[8:11]
  v_mfma_f32_16x16x32_bf16 a[44:47], v[192:195], v[180:183], a[44:47]
  s_waitcnt lgkmcnt(10)
  v_mfma_f32_16x16x32_bf16 a[12:15], v[196:199], v[160:163], a[12:15]
  v_mfma_f32_16x16x32_bf16 a[48:51], v[196:199], v[180:183], a[48:51]
  s_waitcnt lgkmcnt(8)
  v_mfma_f32_16x16x32_bf16 a[16:19], v[200:203], v[160:163], a[16:19]
  v_mfma_f32_16x16x32_bf16 a[52:55], v[200:203], v[180:183], a[52:55]
  s_waitcnt lgkmcnt(6)
  v_mfma_f32_16x16x32_bf16 a[20:23], v[204:207], v[160:163], a[20:23]
  v_mfma_f32_16x16x32_bf16 a[56:59], v[204:207], v[180:183], a[56:59]
  s_waitcnt lgkmcnt(4)
  v_mfma_f32_16x16x32_bf16 a[24:27], v[208:211], v[160:163], a[24:27]
  v_mfma_f32_16x16x32_bf16 a[60:63], v[208:211], v[180:183], a[60:63]
  s_waitcnt lgkmcnt(2)
  v_mfma_f32_16x16x32_bf16 a[28:31], v[212:215], v[160:163], a[28:31]
  v_mfma_f32_16x16x32_bf16 a[64:67], v[212:215], v[180:183], a[64:67]
  s_waitcnt lgkmcnt(0)
  v_mfma_f32_16x16x32_bf16 a[32:35], v[216:219], v[160:163], a[32:35]
  v_mfma_f32_16x16x32_bf16 a[68:71], v[216:219], v[180:183], a[68:71]
  s_nop 7
  s_barrier
  s_mul_i32 s34, s3, 18432
  v_add_u32 v8, s34, v1
  ds_write_b128 v8, a[0:3] offset:0
  ds_write_b128 v8, a[4:7] offset:1024
  ds_write_b128 v8, a[8:11] offset:2048
  ds_write_b128 v8, a[12:15] offset:3072
  ds_write_b128 v8, a[16:19] offset:4096
  ds_write_b128 v8, a[20:23] offset:5120
  ds_write_b128 v8, a[24:27] offset:6144
  ds_write_b128 v8, a[28:31] offset:7168
  ds_write_b128 v8, a[32:35] offset:8192
  ds_write_b128 v8, a[36:39] offset:9216
  ds_write_b128 v8, a[40:43] offset:10240
  ds_write_b128 v8, a[44:47] offset:11264
  ds_write_b128 v8, a[48:51] offset:12288
  ds_write_b128 v8, a[52:55] offset:13312
  ds_write_b128 v8, a[56:59] offset:14336
  ds_write_b128 v8, a[60:63] offset:15360
  ds_write_b128 v8, a[64:67] offset:16384
  ds_write_b128 v8, a[68:71] offset:17408
  s_waitcnt lgkmcnt(0)
  s_barrier
  s_cmp_ge_u32 s3, 2
  s_cbranch_scc1 k2_side4
  s_mul_i32 s34, s3, 9216
  v_add_u32 v8, s34, v1
  ds_read_b128 v[80:83], v8 offset:0
  ds_read_b128 v[84:87], v8 offset:1024
  ds_read_b128 v[88:91], v8 offset:2048
  ds_read_b128 v[92:95], v8 offset:3072
  ds_read_b128 v[96:99], v8 offset:4096
  ds_read_b128 v[100:103], v8 offset:5120
  ds_read_b128 v[104:107], v8 offset:6144
  ds_read_b128 v[108:111], v8 offset:7168
  ds_read_b128 v[112:115], v8 offset:8192
  ds_read_b128 v[116:119], v8 offset:18432
  ds_read_b128 v[120:123], v8 offset:19456
  ds_read_b128 v[124:127], v8 offset:20480
  ds_read_b128 v[128:131], v8 offset:21504
  ds_read_b128 v[132:135], v8 offset:22528
  ds_read_b128 v[136:139], v8 offset:23552
  ds_read_b128 v[140:143], v8 offset:24576
  ds_read_b128 v[144:147], v8 offset:25600
  ds_read_b128 v[148:151], v8 offset:26624
  ds_read_b128 v[152:155], v8 offset:36864
  ds_read_b128 v[156:159], v8 offset:37888
  ds_read_b128 v[160:163], v8 offset:38912
  ds_read_b128 v[164:167], v8 offset:39936
  ds_read_b128 v[168:171], v8 offset:40960
  ds_read_b128 v[172:175], v8 offset:41984
  ds_read_b128 v[176:179], v8 offset:43008
  ds_read_b128 v[180:183], v8 offset:44032
  ds_read_b128 v[184:187], v8 offset:45056
  ds_read_b128 v[188:191], v8 offset:55296
  ds_read_b128 v[192:195], v8 offset:56320
  ds_read_b128 v[196:199], v8 offset:57344
  ds_read_b128 v[200:203], v8 offset:58368
  ds_read_b128 v[204:207], v8 offset:59392
  ds_read_b128 v[208:211], v8 offset:60416
  ds_read_b128 v[212:215], v8 offset:61440
  ds_read_b128 v[216:219], v8 offset:62464
  ds_read_b128 v[220:223], v8 offset:63488
  s_add_u32 s44, s10, 0x240000
  s_addc_u32 s45, s11, 0
  s_mov_b32 s46, 0x240000
  s_mov_b32 s47, 0x00020000
  s_add_u32 s48, s10, 0x480000
  s_addc_u32 s49, s11, 0
  s_mov_b32 s50, 0x10000
  s_mov_b32 s51, 0x00020000
  s_waitcnt lgkmcnt(15)
  v_add_f32 v80, v80, v116
  v_add_f32 v81, v81, v117
  v_add_f32 v82, v82, v118
  v_add_f32 v83, v83, v119
  v_add_f32 v84, v84, v120
  v_add_f32 v85, v85, v121
  v_add_f32 v86, v86, v122
  v_add_f32 v87, v87, v123
  v_add_f32 v88, v88, v124
  v_add_f32 v89, v89, v125
  v_add_f32 v90, v90, v126
  v_add_f32 v91, v91, v127
  v_add_f32 v92, v92, v128
  v_add_f32 v93, v93, v129
  v_add_f32 v94, v94, v130
  v_add_f32 v95, v95, v131
  v_add_f32 v96, v96, v132
  v_add_f32 v97, v97, v133
  v_add_f32 v98, v98, v134
  v_add_f32 v99, v99, v135
  v_add_f32 v100, v100, v136
  v_add_f32 v101, v101, v137
  v_add_f32 v102, v102, v138
  v_add_f32 v103, v103, v139
  v_add_f32 v104, v104, v140
  v_add_f32 v105, v105, v141
  v_add_f32 v106, v106, v142
  v_add_f32 v107, v107, v143
  v_add_f32 v108, v108, v144
  v_add_f32 v109, v109, v145
  v_add_f32 v110, v110, v146
  v_add_f32 v111, v111, v147
  v_add_f32 v112, v112, v148
  v_add_f32 v113, v113, v149
  v_add_f32 v114, v114, v150
  v_add_f32 v115, v115, v151
  s_waitcnt lgkmcnt(0)
  v_add_f32 v152, v152, v188
  v_add_f32 v153, v153, v189
  v_add_f32 v154, v154, v190
  v_add_f32 v155, v155, v191
  v_add_f32 v156, v156, v192
  v_add_f32 v157, v157, v193
  v_add_f32 v158, v158, v194
  v_add_f32 v159, v159, v195
  v_add_f32 v160, v160, v196
  v_add_f32 v161, v161, v197
  v_add_f32 v162, v162, v198
  v_add_f32 v163, v163, v199
  v_add_f32 v164, v164, v200
  v_add_f32 v165, v165, v201
  v_add_f32 v166, v166, v202
  v_add_f32 v167, v167, v203
  v_add_f32 v168, v168, v204
  v_add_f32 v169, v169, v205
  v_add_f32 v170, v170, v206
  v_add_f32 v171, v171, v207
  v_add_f32 v172, v172, v208
  v_add_f32 v173, v173, v209
  v_add_f32 v174, v174, v210
  v_add_f32 v175, v175, v211
  v_add_f32 v176, v176, v212
  v_add_f32 v177, v177, v213
  v_add_f32 v178, v178, v214
  v_add_f32 v179, v179, v215
  v_add_f32 v180, v180, v216
  v_add_f32 v181, v181, v217
  v_add_f32 v182, v182, v218
  v_add_f32 v183, v183, v219
  v_add_f32 v184, v184, v220
  v_add_f32 v185, v185, v221
  v_add_f32 v186, v186, v222
  v_add_f32 v187, v187, v223
  s_waitcnt vmcnt(0)
  v_mov_b32 v9, 0
  v_lshlrev_b32 v12, 16, v32
  v_and_b32 v13, 0xffff0000, v32
  v_lshlrev_b32 v14, 16, v33
  v_and_b32 v15, 0xffff0000, v33
  v_add_f32 v80, v80, v152
  v_add_f32 v80, v80, v12
  v_add_f32 v81, v81, v153
  v_add_f32 v81, v81, v13
  v_add_f32 v82, v82, v154
  v_add_f32 v82, v82, v14
  v_add_f32 v83, v83, v155
  v_add_f32 v83, v83, v15
  v_cvt_pk_bf16_f32 v32, v80, v81
  v_cvt_pk_bf16_f32 v33, v82, v83
  buffer_store_dwordx2 v[32:33], v5, s[44:47], 0 offen offset:0
  v_lshlrev_b32 v80, 16, v32
  v_and_b32 v81, 0xffff0000, v32
  v_lshlrev_b32 v82, 16, v33
  v_and_b32 v83, 0xffff0000, v33
  v_add_f32 v12, v80, v81
  v_add_f32 v13, v82, v83
  v_add_f32 v9, v9, v12
  v_add_f32 v9, v9, v13
  v_lshlrev_b32 v12, 16, v34
  v_and_b32 v13, 0xffff0000, v34
  v_lshlrev_b32 v14, 16, v35
  v_and_b32 v15, 0xffff0000, v35
  v_add_f32 v84, v84, v156
  v_add_f32 v84, v84, v12
  v_add_f32 v85, v85, v157
  v_add_f32 v85, v85, v13
  v_add_f32 v86, v86, v158
  v_add_f32 v86, v86, v14
  v_add_f32 v87, v87, v159
  v_add_f32 v87, v87, v15
  v_cvt_pk_bf16_f32 v34, v84, v85
  v_cvt_pk_bf16_f32 v35, v86, v87
  buffer_store_dwordx2 v[34:35], v5, s[44:47], 0 offen offset:32
  v_lshlrev_b32 v84, 16, v34
  v_and_b32 v85, 0xffff0000, v34
  v_lshlrev_b32 v86, 16, v35
  v_and_b32 v87, 0xffff0000, v35
  v_add_f32 v12, v84, v85
  v_add_f32 v13, v86, v87
  v_add_f32 v9, v9, v12
  v_add_f32 v9, v9, v13
  v_lshlrev_b32 v12, 16, v36
  v_and_b32 v13, 0xffff0000, v36
  v_lshlrev_b32 v14, 16, v37
  v_and_b32 v15, 0xffff0000, v37
  v_add_f32 v88, v88, v160
  v_add_f32 v88, v88, v12
  v_add_f32 v89, v89, v161
  v_add_f32 v89, v89, v13
  v_add_f32 v90, v90, v162
  v_add_f32 v90, v90, v14
  v_add_f32 v91, v91, v163
  v_add_f32 v91, v91, v15
  v_cvt_pk_bf16_f32 v36, v88, v89
  v_cvt_pk_bf16_f32 v37, v90, v91
  buffer_store_dwordx2 v[36:37], v5, s[44:47], 0 offen offset:64
  v_lshlrev_b32 v88, 16, v36
  v_and_b32 v89, 0xffff0000, v36
  v_lshlrev_b32 v90, 16, v37
  v_and_b32 v91, 0xffff0000, v37
  v_add_f32 v12, v88, v89
  v_add_f32 v13, v90, v91
  v_add_f32 v9, v9, v12
  v_add_f32 v9, v9, v13
  v_lshlrev_b32 v12, 16, v38
  v_and_b32 v13, 0xffff0000, v38
  v_lshlrev_b32 v14, 16, v39
  v_and_b32 v15, 0xffff0000, v39
  v_add_f32 v92, v92, v164
  v_add_f32 v92, v92, v12
  v_add_f32 v93, v93, v165
  v_add_f32 v93, v93, v13
  v_add_f32 v94, v94, v166
  v_add_f32 v94, v94, v14
  v_add_f32 v95, v95, v167
  v_add_f32 v95, v95, v15
  v_cvt_pk_bf16_f32 v38, v92, v93
  v_cvt_pk_bf16_f32 v39, v94, v95
  buffer_store_dwordx2 v[38:39], v5, s[44:47], 0 offen offset:96
  v_lshlrev_b32 v92, 16, v38
  v_and_b32 v93, 0xffff0000, v38
  v_lshlrev_b32 v94, 16, v39
  v_and_b32 v95, 0xffff0000, v39
  v_add_f32 v12, v92, v93
  v_add_f32 v13, v94, v95
  v_add_f32 v9, v9, v12
  v_add_f32 v9, v9, v13
  v_lshlrev_b32 v12, 16, v40
  v_and_b32 v13, 0xffff0000, v40
  v_lshlrev_b32 v14, 16, v41
  v_and_b32 v15, 0xffff0000, v41
  v_add_f32 v96, v96, v168
  v_add_f32 v96, v96, v12
  v_add_f32 v97, v97, v169
  v_add_f32 v97, v97, v13
  v_add_f32 v98, v98, v170
  v_add_f32 v98, v98, v14
  v_add_f32 v99, v99, v171
  v_add_f32 v99, v99, v15
  v_cvt_pk_bf16_f32 v40, v96, v97
  v_cvt_pk_bf16_f32 v41, v98, v99
  buffer_store_dwordx2 v[40:41], v5, s[44:47], 0 offen offset:128
  v_lshlrev_b32 v96, 16, v40
  v_and_b32 v97, 0xffff0000, v40
  v_lshlrev_b32 v98, 16, v41
  v_and_b32 v99, 0xffff0000, v41
  v_add_f32 v12, v96, v97
  v_add_f32 v13, v98, v99
  v_add_f32 v9, v9, v12
  v_add_f32 v9, v9, v13
  v_lshlrev_b32 v12, 16, v42
  v_and_b32 v13, 0xffff0000, v42
  v_lshlrev_b32 v14, 16, v43
  v_and_b32 v15, 0xffff0000, v43
  v_add_f32 v100, v100, v172
  v_add_f32 v100, v100, v12
  v_add_f32 v101, v101, v173
  v_add_f32 v101, v101, v13
  v_add_f32 v102, v102, v174
  v_add_f32 v102, v102, v14
  v_add_f32 v103, v103, v175
  v_add_f32 v103, v103, v15
  v_cvt_pk_bf16_f32 v42, v100, v101
  v_cvt_pk_bf16_f32 v43, v102, v103
  buffer_store_dwordx2 v[42:43], v5, s[44:47], 0 offen offset:160
  v_lshlrev_b32 v100, 16, v42
  v_and_b32 v101, 0xffff0000, v42
  v_lshlrev_b32 v102, 16, v43
  v_and_b32 v103, 0xffff0000, v43
  v_add_f32 v12, v100, v101
  v_add_f32 v13, v102, v103
  v_add_f32 v9, v9, v12
  v_add_f32 v9, v9, v13
  v_lshlrev_b32 v12, 16, v44
  v_and_b32 v13, 0xffff0000, v44
  v_lshlrev_b32 v14, 16, v45
  v_and_b32 v15, 0xffff0000, v45
  v_add_f32 v104, v104, v176
  v_add_f32 v104, v104, v12
  v_add_f32 v105, v105, v177
  v_add_f32 v105, v105, v13
  v_add_f32 v106, v106, v178
  v_add_f32 v106, v106, v14
  v_add_f32 v107, v107, v179
  v_add_f32 v107, v107, v15
  v_cvt_pk_bf16_f32 v44, v104, v105
  v_cvt_pk_bf16_f32 v45, v106, v107
  buffer_store_dwordx2 v[44:45], v5, s[44:47], 0 offen offset:192
  v_lshlrev_b32 v104, 16, v44
  v_and_b32 v105, 0xffff0000, v44
  v_lshlrev_b32 v106, 16, v45
  v_and_b32 v107, 0xffff0000, v45
  v_add_f32 v12, v104, v105
  v_add_f32 v13, v106, v107
  v_add_f32 v9, v9, v12
  v_add_f32 v9, v9, v13
  v_lshlrev_b32 v12, 16, v46
  v_and_b32 v13, 0xffff0000, v46
  v_lshlrev_b32 v14, 16, v47
  v_and_b32 v15, 0xffff0000, v47
  v_add_f32 v108, v108, v180
  v_add_f32 v108, v108, v12
  v_add_f32 v109, v109, v181
  v_add_f32 v109, v109, v13
  v_add_f32 v110, v110, v182
  v_add_f32 v110, v110, v14
  v_add_f32 v111, v111, v183
  v_add_f32 v111, v111, v15
  v_cvt_pk_bf16_f32 v46, v108, v109
  v_cvt_pk_bf16_f32 v47, v110, v111
  buffer_store_dwordx2 v[46:47], v5, s[44:47], 0 offen offset:224
  v_lshlrev_b32 v108, 16, v46
  v_and_b32 v109, 0xffff0000, v46
  v_lshlrev_b32 v110, 16, v47
  v_and_b32 v111, 0xffff0000, v47
  v_add_f32 v12, v108, v109
  v_add_f32 v13, v110, v111
  v_add_f32 v9, v9, v12
  v_add_f32 v9, v9, v13
  v_lshlrev_b32 v12, 16, v48
  v_and_b32 v13, 0xffff0000, v48
  v_lshlrev_b32 v14, 16, v49
  v_and_b32 v15, 0xffff0000, v49
  v_add_f32 v112, v112, v184
  v_add_f32 v112, v112, v12
  v_add_f32 v113, v113, v185
  v_add_f32 v113, v113, v13
  v_add_f32 v114, v114, v186
  v_add_f32 v114, v114, v14
  v_add_f32 v115, v115, v187
  v_add_f32 v115, v115, v15
  v_cvt_pk_bf16_f32 v48, v112, v113
  v_cvt_pk_bf16_f32 v49, v114, v115
  buffer_store_dwordx2 v[48:49], v5, s[44:47], 0 offen offset:256
  v_lshlrev_b32 v112, 16, v48
  v_and_b32 v113, 0xffff0000, v48
  v_lshlrev_b32 v114, 16, v49
  v_and_b32 v115, 0xffff0000, v49
  v_add_f32 v12, v112, v113
  v_add_f32 v13, v114, v115
  v_add_f32 v9, v9, v12
  v_add_f32 v9, v9, v13
  v_xor_b32 v10, 16, v0
  v_lshlrev_b32 v10, 2, v10
  v_xor_b32 v11, 32, v0
  v_lshlrev_b32 v11, 2, v11
  ds_bpermute_b32 v12, v10, v9
  s_waitcnt lgkmcnt(0)
  v_add_f32 v9, v9, v12
  ds_bpermute_b32 v12, v11, v9
  s_waitcnt lgkmcnt(0)
  v_add_f32 v9, v9, v12
  v_mul_f32 v16, 0x3be38e39, v9
  v_mov_b32 v17, 0
  v_mov_b32 v18, 0
  v_sub_f32 v80, v80, v16
  v_fmac_f32 v17, v80, v80
  v_sub_f32 v81, v81, v16
  v_fmac_f32 v18, v81, v81
  v_sub_f32 v82, v82, v16
  v_fmac_f32 v17, v82, v82
  v_sub_f32 v83, v83, v16
  v_fmac_f32 v18, v83, v83
  v_sub_f32 v84, v84, v16
  v_fmac_f32 v17, v84, v84
  v_sub_f32 v85, v85, v16
  v_fmac_f32 v18, v85, v85
  v_sub_f32 v86, v86, v16
  v_fmac_f32 v17, v86, v86
  v_sub_f32 v87, v87, v16
  v_fmac_f32 v18, v87, v87
  v_sub_f32 v88, v88, v16
  v_fmac_f32 v17, v88, v88
  v_sub_f32 v89, v89, v16
  v_fmac_f32 v18, v89, v89
  v_sub_f32 v90, v90, v16
  v_fmac_f32 v17, v90, v90
  v_sub_f32 v91, v91, v16
  v_fmac_f32 v18, v91, v91
  v_sub_f32 v92, v92, v16
  v_fmac_f32 v17, v92, v92
  v_sub_f32 v93, v93, v16
  v_fmac_f32 v18, v93, v93
  v_sub_f32 v94, v94, v16
  v_fmac_f32 v17, v94, v94
  v_sub_f32 v95, v95, v16
  v_fmac_f32 v18, v95, v95
  v_sub_f32 v96, v96, v16
  v_fmac_f32 v17, v96, v96
  v_sub_f32 v97, v97, v16
  v_fmac_f32 v18, v97, v97
  v_sub_f32 v98, v98, v16
  v_fmac_f32 v17, v98, v98
  v_sub_f32 v99, v99, v16
  v_fmac_f32 v18, v99, v99
  v_sub_f32 v100, v100, v16
  v_fmac_f32 v17, v100, v100
  v_sub_f32 v101, v101, v16
  v_fmac_f32 v18, v101, v101
  v_sub_f32 v102, v102, v16
  v_fmac_f32 v17, v102, v102
  v_sub_f32 v103, v103, v16
  v_fmac_f32 v18, v103, v103
  v_sub_f32 v104, v104, v16
  v_fmac_f32 v17, v104, v104
  v_sub_f32 v105, v105, v16
  v_fmac_f32 v18, v105, v105
  v_sub_f32 v106, v106, v16
  v_fmac_f32 v17, v106, v106
  v_sub_f32 v107, v107, v16
  v_fmac_f32 v18, v107, v107
  v_sub_f32 v108, v108, v16
  v_fmac_f32 v17, v108, v108
  v_sub_f32 v109, v109, v16
  v_fmac_f32 v18, v109, v109
  v_sub_f32 v110, v110, v16
  v_fmac_f32 v17, v110, v110
  v_sub_f32 v111, v111, v16
  v_fmac_f32 v18, v111, v111
  v_sub_f32 v112, v112, v16
  v_fmac_f32 v17, v112, v112
  v_sub_f32 v113, v113, v16
  v_fmac_f32 v18, v113, v113
  v_sub_f32 v114, v114, v16
  v_fmac_f32 v17, v114, v114
  v_sub_f32 v115, v115, v16
  v_fmac_f32 v18, v115, v115
  v_add_f32 v17, v17, v18
  ds_bpermute_b32 v12, v10, v17
  s_waitcnt lgkmcnt(0)
  v_add_f32 v17, v17, v12
  ds_bpermute_b32 v12, v11, v17
  s_waitcnt lgkmcnt(0)
  v_add_f32 v17, v17, v12
  v_and_b32 v8, 15, v0
  s_lshl_b32 s34, s14, 5
  s_lshl_b32 s35, s3, 4
  s_add_u32 s34, s34, s35
  v_add_u32 v8, s34, v8
  v_lshlrev_b32 v8, 5, v8
  s_lshl_b32 s34, s13, 3
  buffer_store_dwordx2 v[16:17], v8, s[48:51], s34 offen
  s_branch k2_fin
k2_side4:
  s_cmp_eq_u32 s41, 0
  s_cbranch_scc1 k2_fin
  s_waitcnt vmcnt(0)
  v_accvgpr_read_b32 v32, a72
  v_accvgpr_read_b32 v33, a73
  v_accvgpr_read_b32 v34, a74
  v_accvgpr_read_b32 v35, a75
  v_accvgpr_read_b32 v36, a76
  v_accvgpr_read_b32 v37, a77
  v_accvgpr_read_b32 v38, a78
  v_accvgpr_read_b32 v39, a79
  v_accvgpr_read_b32 v40, a80
  v_accvgpr_read_b32 v41, a81
  v_accvgpr_read_b32 v42, a82
  v_accvgpr_read_b32 v43, a83
  v_accvgpr_read_b32 v44, a84
  v_accvgpr_read_b32 v45, a85
  v_accvgpr_read_b32 v46, a86
  v_accvgpr_read_b32 v47, a87
  v_accvgpr_read_b32 v48, a88
  v_accvgpr_read_b32 v49, a89
  v_accvgpr_read_b32 v50, a90
  v_accvgpr_read_b32 v51, a91
  v_accvgpr_read_b32 v52, a92
  v_accvgpr_read_b32 v53, a93
  v_accvgpr_read_b32 v54, a94
  v_accvgpr_read_b32 v55, a95
  v_accvgpr_read_b32 v56, a96
  v_accvgpr_read_b32 v57, a97
  v_accvgpr_read_b32 v58, a98
  v_accvgpr_read_b32 v59, a99
  v_accvgpr_read_b32 v60, a100
  v_accvgpr_read_b32 v61, a101
  v_accvgpr_read_b32 v62, a102
  v_accvgpr_read_b32 v63, a103
  v_accvgpr_read_b32 v64, a104
  v_accvgpr_read_b32 v65, a105
  v_accvgpr_read_b32 v66, a106
  v_accvgpr_read_b32 v67, a107
  v_accvgpr_read_b32 v68, a108
  v_accvgpr_read_b32 v69, a109
  v_accvgpr_read_b32 v70, a110
  v_accvgpr_read_b32 v71, a111
  v_accvgpr_read_b32 v72, a112
  v_accvgpr_read_b32 v73, a113
  v_accvgpr_read_b32 v74, a114
  v_accvgpr_read_b32 v75, a115
  v_accvgpr_read_b32 v76, a116
  v_accvgpr_read_b32 v77, a117
  v_accvgpr_read_b32 v78, a118
  v_accvgpr_read_b32 v79, a119
  v_accvgpr_read_b32 v80, a120
  v_accvgpr_read_b32 v81, a121
  v_accvgpr_read_b32 v82, a122
  v_accvgpr_read_b32 v83, a123
  v_accvgpr_read_b32 v84, a124
  v_accvgpr_read_b32 v85, a125
  v_accvgpr_read_b32 v86, a126
  v_accvgpr_read_b32 v87, a127
  v_accvgpr_read_b32 v88, a128
  v_accvgpr_read_b32 v89, a129
  v_accvgpr_read_b32 v90, a130
  v_accvgpr_read_b32 v91, a131
  v_accvgpr_read_b32 v92, a132
  v_accvgpr_read_b32 v93, a133
  v_accvgpr_read_b32 v94, a134
  v_accvgpr_read_b32 v95, a135
  v_accvgpr_read_b32 v96, a136
  v_accvgpr_read_b32 v97, a137
  v_accvgpr_read_b32 v98, a138
  v_accvgpr_read_b32 v99, a139
  v_accvgpr_read_b32 v100, a140
  v_accvgpr_read_b32 v101, a141
  v_accvgpr_read_b32 v102, a142
  v_accvgpr_read_b32 v103, a143
  v_accvgpr_read_b32 v104, a144
  v_accvgpr_read_b32 v105, a145
  v_accvgpr_read_b32 v106, a146
  v_accvgpr_read_b32 v107, a147
  v_accvgpr_read_b32 v108, a148
  v_accvgpr_read_b32 v109, a149
  v_accvgpr_read_b32 v110, a150
  v_accvgpr_read_b32 v111, a151
  v_accvgpr_read_b32 v112, a152
  v_accvgpr_read_b32 v113, a153
  v_accvgpr_read_b32 v114, a154
  v_accvgpr_read_b32 v115, a155
  v_accvgpr_read_b32 v116, a156
  v_accvgpr_read_b32 v117, a157
  v_accvgpr_read_b32 v118, a158
  v_accvgpr_read_b32 v119, a159
  v_accvgpr_read_b32 v120, a160
  v_accvgpr_read_b32 v121, a161
  v_accvgpr_read_b32 v122, a162
  v_accvgpr_read_b32 v123, a163
  v_accvgpr_read_b32 v124, a164
  v_accvgpr_read_b32 v125, a165
  v_accvgpr_read_b32 v126, a166
  v_accvgpr_read_b32 v127, a167
  v_mov_b32 v16, 0
  v_mov_b32 v17, 0
  v_mov_b32 v18, 0
  v_mov_b32 v19, 0
  v_mov_b32 v20, 0
  v_mov_b32 v21, 0
  v_mov_b32 v22, 0
  v_mov_b32 v23, 0
  v_lshlrev_b32 v9, 16, v32
  v_and_b32 v10, 0xffff0000, v32
  v_add_f32 v16, v16, v9
  v_add_f32 v17, v17, v10
  v_lshlrev_b32 v9, 16, v33
  v_and_b32 v10, 0xffff0000, v33
  v_add_f32 v18, v18, v9
  v_add_f32 v19, v19, v10
  v_lshlrev_b32 v9, 16, v34
  v_and_b32 v10, 0xffff0000, v34
  v_add_f32 v20, v20, v9
  v_add_f32 v21, v21, v10
  v_lshlrev_b32 v9, 16, v35
  v_and_b32 v10, 0xffff0000, v35
  v_add_f32 v22, v22, v9
  v_add_f32 v23, v23, v10
  v_lshlrev_b32 v9, 16, v36
  v_and_b32 v10, 0xffff0000, v36
  v_add_f32 v16, v16, v9
  v_add_f32 v17, v17, v10
  v_lshlrev_b32 v9, 16, v37
  v_and_b32 v10, 0xffff0000, v37
  v_add_f32 v18, v18, v9
  v_add_f32 v19, v19, v10
  v_lshlrev_b32 v9, 16, v38
  v_and_b32 v10, 0xffff0000, v38
  v_add_f32 v20, v20, v9
  v_add_f32 v21, v21, v10
  v_lshlrev_b32 v9, 16, v39
  v_and_b32 v10, 0xffff0000, v39
  v_add_f32 v22, v22, v9
  v_add_f32 v23, v23, v10
  v_lshlrev_b32 v9, 16, v40
  v_and_b32 v10, 0xffff0000, v40
  v_add_f32 v16, v16, v9
  v_add_f32 v17, v17, v10
  v_lshlrev_b32 v9, 16, v41
  v_and_b32 v10, 0xffff0000, v41
  v_add_f32 v18, v18, v9
  v_add_f32 v19, v19, v10
  v_lshlrev_b32 v9, 16, v42
  v_and_b32 v10, 0xffff0000, v42
  v_add_f32 v20, v20, v9
  v_add_f32 v21, v21, v10
  v_lshlrev_b32 v9, 16, v43
  v_and_b32 v10, 0xffff0000, v43
  v_add_f32 v22, v22, v9
  v_add_f32 v23, v23, v10
  v_lshlrev_b32 v9, 16, v44
  v_and_b32 v10, 0xffff0000, v44
  v_add_f32 v16, v16, v9
  v_add_f32 v17, v17, v10
  v_lshlrev_b32 v9, 16, v45
  v_and_b32 v10, 0xffff0000, v45
  v_add_f32 v18, v18, v9
  v_add_f32 v19, v19, v10
  v_lshlrev_b32 v9, 16, v46
  v_and_b32 v10, 0xffff0000, v46
  v_add_f32 v20, v20, v9
  v_add_f32 v21, v21, v10
  v_lshlrev_b32 v9, 16, v47
  v_and_b32 v10, 0xffff0000, v47
  v_add_f32 v22, v22, v9
  v_add_f32 v23, v23, v10
  v_lshlrev_b32 v9, 16, v48
  v_and_b32 v10, 0xffff0000, v48
  v_add_f32 v16, v16, v9
  v_add_f32 v17, v17, v10
  v_lshlrev_b32 v9, 16, v49
  v_and_b32 v10, 0xffff0000, v49
  v_add_f32 v18, v18, v9
  v_add_f32 v19, v19, v10
  v_lshlrev_b32 v9, 16, v50
  v_and_b32 v10, 0xffff0000, v50
  v_add_f32 v20, v20, v9
  v_add_f32 v21, v21, v10
  v_lshlrev_b32 v9, 16, v51
  v_and_b32 v10, 0xffff0000, v51
  v_add_f32 v22, v22, v9
  v_add_f32 v23, v23, v10
  v_lshlrev_b32 v9, 16, v52
  v_and_b32 v10, 0xffff0000, v52
  v_add_f32 v16, v16, v9
  v_add_f32 v17, v17, v10
  v_lshlrev_b32 v9, 16, v53
  v_and_b32 v10, 0xffff0000, v53
  v_add_f32 v18, v18, v9
  v_add_f32 v19, v19, v10
  v_lshlrev_b32 v9, 16, v54
  v_and_b32 v10, 0xffff0000, v54
  v_add_f32 v20, v20, v9
  v_add_f32 v21, v21, v10
  v_lshlrev_b32 v9, 16, v55
  v_and_b32 v10, 0xffff0000, v55
  v_add_f32 v22, v22, v9
  v_add_f32 v23, v23, v10
  v_lshlrev_b32 v9, 16, v56
  v_and_b32 v10, 0xffff0000, v56
  v_add_f32 v16, v16, v9
  v_add_f32 v17, v17, v10
  v_lshlrev_b32 v9, 16, v57
  v_and_b32 v10, 0xffff0000, v57
  v_add_f32 v18, v18, v9
  v_add_f32 v19, v19, v10
  v_lshlrev_b32 v9, 16, v58
  v_and_b32 v10, 0xffff0000, v58
  v_add_f32 v20, v20, v9
  v_add_f32 v21, v21, v10
  v_lshlrev_b32 v9, 16, v59
  v_and_b32 v10, 0xffff0000, v59
  v_add_f32 v22, v22, v9
  v_add_f32 v23, v23, v10
  v_lshlrev_b32 v9, 16, v60
  v_and_b32 v10, 0xffff0000, v60
  v_add_f32 v16, v16, v9
  v_add_f32 v17, v17, v10
  v_lshlrev_b32 v9, 16, v61
  v_and_b32 v10, 0xffff0000, v61
  v_add_f32 v18, v18, v9
  v_add_f32 v19, v19, v10
  v_lshlrev_b32 v9, 16, v62
  v_and_b32 v10, 0xffff0000, v62
  v_add_f32 v20, v20, v9
  v_add_f32 v21, v21, v10
  v_lshlrev_b32 v9, 16, v63
  v_and_b32 v10, 0xffff0000, v63
  v_add_f32 v22, v22, v9
  v_add_f32 v23, v23, v10
  v_lshlrev_b32 v9, 16, v64
  v_and_b32 v10, 0xffff0000, v64
  v_add_f32 v16, v16, v9
  v_add_f32 v17, v17, v10
  v_lshlrev_b32 v9, 16, v65
  v_and_b32 v10, 0xffff0000, v65
  v_add_f32 v18, v18, v9
  v_add_f32 v19, v19, v10
  v_lshlrev_b32 v9, 16, v66
  v_and_b32 v10, 0xffff0000, v66
  v_add_f32 v20, v20, v9
  v_add_f32 v21, v21, v10
  v_lshlrev_b32 v9, 16, v67
  v_and_b32 v10, 0xffff0000, v67
  v_add_f32 v22, v22, v9
  v_add_f32 v23, v23, v10
  v_lshlrev_b32 v9, 16, v68
  v_and_b32 v10, 0xffff0000, v68
  v_add_f32 v16, v16, v9
  v_add_f32 v17, v17, v10
  v_lshlrev_b32 v9, 16, v69
  v_and_b32 v10, 0xffff0000, v69
  v_add_f32 v18, v18, v9
  v_add_f32 v19, v19, v10
  v_lshlrev_b32 v9, 16, v70
  v_and_b32 v10, 0xffff0000, v70
  v_add_f32 v20, v20, v9
  v_add_f32 v21, v21, v10
  v_lshlrev_b32 v9, 16, v71
  v_and_b32 v10, 0xffff0000, v71
  v_add_f32 v22, v22, v9
  v_add_f32 v23, v23, v10
  v_lshlrev_b32 v9, 16, v72
  v_and_b32 v10, 0xffff0000, v72
  v_add_f32 v16, v16, v9
  v_add_f32 v17, v17, v10
  v_lshlrev_b32 v9, 16, v73
  v_and_b32 v10, 0xffff0000, v73
  v_add_f32 v18, v18, v9
  v_add_f32 v19, v19, v10
  v_lshlrev_b32 v9, 16, v74
  v_and_b32 v10, 0xffff0000, v74
  v_add_f32 v20, v20, v9
  v_add_f32 v21, v21, v10
  v_lshlrev_b32 v9, 16, v75
  v_and_b32 v10, 0xffff0000, v75
  v_add_f32 v22, v22, v9
  v_add_f32 v23, v23, v10
  v_lshlrev_b32 v9, 16, v76
  v_and_b32 v10, 0xffff0000, v76
  v_add_f32 v16, v16, v9
  v_add_f32 v17, v17, v10
  v_lshlrev_b32 v9, 16, v77
  v_and_b32 v10, 0xffff0000, v77
  v_add_f32 v18, v18, v9
  v_add_f32 v19, v19, v10
  v_lshlrev_b32 v9, 16, v78
  v_and_b32 v10, 0xffff0000, v78
  v_add_f32 v20, v20, v9
  v_add_f32 v21, v21, v10
  v_lshlrev_b32 v9, 16, v79
  v_and_b32 v10, 0xffff0000, v79
  v_add_f32 v22, v22, v9
  v_add_f32 v23, v23, v10
  v_lshlrev_b32 v9, 16, v80
  v_and_b32 v10, 0xffff0000, v80
  v_add_f32 v16, v16, v9
  v_add_f32 v17, v17, v10
  v_lshlrev_b32 v9, 16, v81
  v_and_b32 v10, 0xffff0000, v81
  v_add_f32 v18, v18, v9
  v_add_f32 v19, v19, v10
  v_lshlrev_b32 v9, 16, v82
  v_and_b32 v10, 0xffff0000, v82
  v_add_f32 v20, v20, v9
  v_add_f32 v21, v21, v10
  v_lshlrev_b32 v9, 16, v83
  v_and_b32 v10, 0xffff0000, v83
  v_add_f32 v22, v22, v9
  v_add_f32 v23, v23, v10
  v_lshlrev_b32 v9, 16, v84
  v_and_b32 v10, 0xffff0000, v84
  v_add_f32 v16, v16, v9
  v_add_f32 v17, v17, v10
  v_lshlrev_b32 v9, 16, v85
  v_and_b32 v10, 0xffff0000, v85
  v_add_f32 v18, v18, v9
  v_add_f32 v19, v19, v10
  v_lshlrev_b32 v9, 16, v86
  v_and_b32 v10, 0xffff0000, v86
  v_add_f32 v20, v20, v9
  v_add_f32 v21, v21, v10
  v_lshlrev_b32 v9, 16, v87
  v_and_b32 v10, 0xffff0000, v87
  v_add_f32 v22, v22, v9
  v_add_f32 v23, v23, v10
  v_lshlrev_b32 v9, 16, v88
  v_and_b32 v10, 0xffff0000, v88
  v_add_f32 v16, v16, v9
  v_add_f32 v17, v17, v10
  v_lshlrev_b32 v9, 16, v89
  v_and_b32 v10, 0xffff0000, v89
  v_add_f32 v18, v18, v9
  v_add_f32 v19, v19, v10
  v_lshlrev_b32 v9, 16, v90
  v_and_b32 v10, 0xffff0000, v90
  v_add_f32 v20, v20, v9
  v_add_f32 v21, v21, v10
  v_lshlrev_b32 v9, 16, v91
  v_and_b32 v10, 0xffff0000, v91
  v_add_f32 v22, v22, v9
  v_add_f32 v23, v23, v10
  v_lshlrev_b32 v9, 16, v92
  v_and_b32 v10, 0xffff0000, v92
  v_add_f32 v16, v16, v9
  v_add_f32 v17, v17, v10
  v_lshlrev_b32 v9, 16, v93
  v_and_b32 v10, 0xffff0000, v93
  v_add_f32 v18, v18, v9
  v_add_f32 v19, v19, v10
  v_lshlrev_b32 v9, 16, v94
  v_and_b32 v10, 0xffff0000, v94
  v_add_f32 v20, v20, v9
  v_add_f32 v21, v21, v10
  v_lshlrev_b32 v9, 16, v95
  v_and_b32 v10, 0xffff0000, v95
  v_add_f32 v22, v22, v9
  v_add_f32 v23, v23, v10
  v_lshlrev_b32 v9, 16, v96
  v_and_b32 v10, 0xffff0000, v96
  v_add_f32 v16, v16, v9
  v_add_f32 v17, v17, v10
  v_lshlrev_b32 v9, 16, v97
  v_and_b32 v10, 0xffff0000, v97
  v_add_f32 v18, v18, v9
  v_add_f32 v19, v19, v10
  v_lshlrev_b32 v9, 16, v98
  v_and_b32 v10, 0xffff0000, v98
  v_add_f32 v20, v20, v9
  v_add_f32 v21, v21, v10
  v_lshlrev_b32 v9, 16, v99
  v_and_b32 v10, 0xffff0000, v99
  v_add_f32 v22, v22, v9
  v_add_f32 v23, v23, v10
  v_lshlrev_b32 v9, 16, v100
  v_and_b32 v10, 0xffff0000, v100
  v_add_f32 v16, v16, v9
  v_add_f32 v17, v17, v10
  v_lshlrev_b32 v9, 16, v101
  v_and_b32 v10, 0xffff0000, v101
  v_add_f32 v18, v18, v9
  v_add_f32 v19, v19, v10
  v_lshlrev_b32 v9, 16, v102
  v_and_b32 v10, 0xffff0000, v102
  v_add_f32 v20, v20, v9
  v_add_f32 v21, v21, v10
  v_lshlrev_b32 v9, 16, v103
  v_and_b32 v10, 0xffff0000, v103
  v_add_f32 v22, v22, v9
  v_add_f32 v23, v23, v10
  v_lshlrev_b32 v9, 16, v104
  v_and_b32 v10, 0xffff0000, v104
  v_add_f32 v16, v16, v9
  v_add_f32 v17, v17, v10
  v_lshlrev_b32 v9, 16, v105
  v_and_b32 v10, 0xffff0000, v105
  v_add_f32 v18, v18, v9
  v_add_f32 v19, v19, v10
  v_lshlrev_b32 v9, 16, v106
  v_and_b32 v10, 0xffff0000, v106
  v_add_f32 v20, v20, v9
  v_add_f32 v21, v21, v10
  v_lshlrev_b32 v9, 16, v107
  v_and_b32 v10, 0xffff0000, v107
  v_add_f32 v22, v22, v9
  v_add_f32 v23, v23, v10
  v_lshlrev_b32 v9, 16, v108
  v_and_b32 v10, 0xffff0000, v108
  v_add_f32 v16, v16, v9
  v_add_f32 v17, v17, v10
  v_lshlrev_b32 v9, 16, v109
  v_and_b32 v10, 0xffff0000, v109
  v_add_f32 v18, v18, v9
  v_add_f32 v19, v19, v10
  v_lshlrev_b32 v9, 16, v110
  v_and_b32 v10, 0xffff0000, v110
  v_add_f32 v20, v20, v9
  v_add_f32 v21, v21, v10
  v_lshlrev_b32 v9, 16, v111
  v_and_b32 v10, 0xffff0000, v111
  v_add_f32 v22, v22, v9
  v_add_f32 v23, v23, v10
  v_lshlrev_b32 v9, 16, v112
  v_and_b32 v10, 0xffff0000, v112
  v_add_f32 v16, v16, v9
  v_add_f32 v17, v17, v10
  v_lshlrev_b32 v9, 16, v113
  v_and_b32 v10, 0xffff0000, v113
  v_add_f32 v18, v18, v9
  v_add_f32 v19, v19, v10
  v_lshlrev_b32 v9, 16, v114
  v_and_b32 v10, 0xffff0000, v114
  v_add_f32 v20, v20, v9
  v_add_f32 v21, v21, v10
  v_lshlrev_b32 v9, 16, v115
  v_and_b32 v10, 0xffff0000, v115
  v_add_f32 v22, v22, v9
  v_add_f32 v23, v23, v10
  v_lshlrev_b32 v9, 16, v116
  v_and_b32 v10, 0xffff0000, v116
  v_add_f32 v16, v16, v9
  v_add_f32 v17, v17, v10
  v_lshlrev_b32 v9, 16, v117
  v_and_b32 v10, 0xffff0000, v117
  v_add_f32 v18, v18, v9
  v_add_f32 v19, v19, v10
  v_lshlrev_b32 v9, 16, v118
  v_and_b32 v10, 0xffff0000, v118
  v_add_f32 v20, v20, v9
  v_add_f32 v21, v21, v10
  v_lshlrev_b32 v9, 16, v119
  v_and_b32 v10, 0xffff0000, v119
  v_add_f32 v22, v22, v9
  v_add_f32 v23, v23, v10
  v_lshlrev_b32 v9, 16, v120
  v_and_b32 v10, 0xffff0000, v120
  v_add_f32 v16, v16, v9
  v_add_f32 v17, v17, v10
  v_lshlrev_b32 v9, 16, v121
  v_and_b32 v10, 0xffff0000, v121
  v_add_f32 v18, v18, v9
  v_add_f32 v19, v19, v10
  v_lshlrev_b32 v9, 16, v122
  v_and_b32 v10, 0xffff0000, v122
  v_add_f32 v20, v20, v9
  v_add_f32 v21, v21, v10
  v_lshlrev_b32 v9, 16, v123
  v_and_b32 v10, 0xffff0000, v123
  v_add_f32 v22, v22, v9
  v_add_f32 v23, v23, v10
  v_lshlrev_b32 v9, 16, v124
  v_and_b32 v10, 0xffff0000, v124
  v_add_f32 v16, v16, v9
  v_add_f32 v17, v17, v10
  v_lshlrev_b32 v9, 16, v125
  v_and_b32 v10, 0xffff0000, v125
  v_add_f32 v18, v18, v9
  v_add_f32 v19, v19, v10
  v_lshlrev_b32 v9, 16, v126
  v_and_b32 v10, 0xffff0000, v126
  v_add_f32 v20, v20, v9
  v_add_f32 v21, v21, v10
  v_lshlrev_b32 v9, 16, v127
  v_and_b32 v10, 0xffff0000, v127
  v_add_f32 v22, v22, v9
  v_add_f32 v23, v23, v10
  v_xor_b32 v10, 8, v0
  v_lshlrev_b32 v10, 2, v10
  ds_bpermute_b32 v24, v10, v16
  ds_bpermute_b32 v25, v10, v17
  ds_bpermute_b32 v26, v10, v18
  ds_bpermute_b32 v27, v10, v19
  ds_bpermute_b32 v28, v10, v20
  ds_bpermute_b32 v29, v10, v21
  ds_bpermute_b32 v30, v10, v22
  ds_bpermute_b32 v31, v10, v23
  s_waitcnt lgkmcnt(0)
  v_add_f32 v16, v16, v24
  v_add_f32 v17, v17, v25
  v_add_f32 v18, v18, v26
  v_add_f32 v19, v19, v27
  v_add_f32 v20, v20, v28
  v_add_f32 v21, v21, v29
  v_add_f32 v22, v22, v30
  v_add_f32 v23, v23, v31
  v_xor_b32 v10, 16, v0
  v_lshlrev_b32 v10, 2, v10
  ds_bpermute_b32 v24, v10, v16
  ds_bpermute_b32 v25, v10, v17
  ds_bpermute_b32 v26, v10, v18
  ds_bpermute_b32 v27, v10, v19
  ds_bpermute_b32 v28, v10, v20
  ds_bpermute_b32 v29, v10, v21
  ds_bpermute_b32 v30, v10, v22
  ds_bpermute_b32 v31, v10, v23
  s_waitcnt lgkmcnt(0)
  v_add_f32 v16, v16, v24
  v_add_f32 v17, v17, v25
  v_add_f32 v18, v18, v26
  v_add_f32 v19, v19, v27
  v_add_f32 v20, v20, v28
  v_add_f32 v21, v21, v29
  v_add_f32 v22, v22, v30
  v_add_f32 v23, v23, v31
  v_xor_b32 v10, 32, v0
  v_lshlrev_b32 v10, 2, v10
  ds_bpermute_b32 v24, v10, v16
  ds_bpermute_b32 v25, v10, v17
  ds_bpermute_b32 v26, v10, v18
  ds_bpermute_b32 v27, v10, v19
  ds_bpermute_b32 v28, v10, v20
  ds_bpermute_b32 v29, v10, v21
  ds_bpermute_b32 v30, v10, v22
  ds_bpermute_b32 v31, v10, v23
  s_waitcnt lgkmcnt(0)
  v_add_f32 v16, v16, v24
  v_add_f32 v17, v17, v25
  v_add_f32 v18, v18, v26
  v_add_f32 v19, v19, v27
  v_add_f32 v20, v20, v28
  v_add_f32 v21, v21, v29
  v_add_f32 v22, v22, v30
  v_add_f32 v23, v23, v31
  s_add_u32 s64, s10, 0x560000
  s_addc_u32 s65, s11, 0
  s_mov_b32 s66, 0x1b000
  s_mov_b32 s67, 0x00020000
  s_mul_i32 s34, s43, 36864
  s_lshl_b32 s35, s42, 8
  s_add_u32 s34, s34, s35
  v_and_b32 v8, 7, v0
  v_lshlrev_b32 v8, 5, v8
  buffer_store_dwordx4 v[16:19], v8, s[64:67], s34 offen
  buffer_store_dwordx4 v[20:23], v8, s[64:67], s34 offen offset:16
k2_fin:
k2_end:
  s_endpgm
.globl k3_kernel
.p2align 8
.type k3_kernel,@function
k3_kernel:
  s_cmp_ge_u32 s2, 256
  s_cbranch_scc1 k3_end
  s_setprio 3
  s_load_dwordx4 s[4:7], s[0:1], 32
  s_load_dwordx2 s[8:9], s[0:1], 72
  s_load_dwordx2 s[48:49], s[0:1], 48
  v_lshrrev_b32 v1, 6, v0
  s_and_b32 s10, s2, 3
  v_readfirstlane_b32 s3, v1
  v_and_b32 v0, 63, v0
  s_and_b32 s10, s2, 7
  s_lshr_b32 s11, s2, 3
  s_and_b32 s12, s11, 3
  s_lshl_b32 s10, s10, 2
  s_add_u32 s10, s10, s12
  s_lshr_b32 s11, s11, 2
  s_and_b32 s12, s3, 3
  s_lshr_b32 s13, s3, 2
  s_lshl_b32 s35, s11, 8
  s_lshl_b32 s36, s3, 3
  s_add_u32 s35, s35, s36
  v_lshrrev_b32 v17, 3, v0
  v_add_u32 v17, s35, v17
  v_mul_u32_u24 v17, 1152, v17
  s_and_b32 s36, s3, 1
  s_lshl_b32 s36, s36, 2
  v_lshrrev_b32 v18, 4, v0
  v_or_b32 v18, s36, v18
  v_and_b32 v19, 7, v0
  v_xor_b32 v18, v18, v19
  v_lshl_add_u32 v5, v18, 4, v17
  s_mul_i32 s35, s3, 3
  s_cmp_ge_u32 s35, 18
  s_cselect_b32 s36, 18, 0
  s_sub_u32 s36, s35, s36
  s_mul_i32 s37, s10, 288
  s_add_u32 s38, s36, 0
  s_lshl_b32 s38, s38, 6
  v_add_u32 v17, s38, v0
  v_mul_u32_u24 v18, 3641, v17
  v_lshrrev_b32 v18, 16, v18
  v_mul_u32_u24 v19, 18, v18
  v_sub_u32 v19, v17, v19
  v_and_b32 v28, 0x33, v18
  v_and_b32 v29, 4, v18
  v_lshl_or_b32 v28, v29, 1, v28
  v_and_b32 v29, 8, v18
  v_lshrrev_b32 v29, 1, v29
  v_or_b32 v28, v28, v29
  v_mul_u32_u24 v28, 9216, v28
  v_lshl_add_u32 v28, v19, 4, v28
  v_add_u32 v6, s37, v28
  s_add_u32 s38, s36, 1
  s_lshl_b32 s38, s38, 6
  v_add_u32 v17, s38, v0
  v_mul_u32_u24 v18, 3641, v17
  v_lshrrev_b32 v18, 16, v18
  v_mul_u32_u24 v19, 18, v18
  v_sub_u32 v19, v17, v19
  v_and_b32 v28, 0x33, v18
  v_and_b32 v29, 4, v18
  v_lshl_or_b32 v28, v29, 1, v28
  v_and_b32 v29, 8, v18
  v_lshrrev_b32 v29, 1, v29
  v_or_b32 v28, v28, v29
  v_mul_u32_u24 v28, 9216, v28
  v_lshl_add_u32 v28, v19, 4, v28
  v_add_u32 v7, s37, v28
  s_add_u32 s38, s36, 2
  s_lshl_b32 s38, s38, 6
  v_add_u32 v17, s38, v0
  v_mul_u32_u24 v18, 3641, v17
  v_lshrrev_b32 v18, 16, v18
  v_mul_u32_u24 v19, 18, v18
  v_sub_u32 v19, v17, v19
  v_and_b32 v28, 0x33, v18
  v_and_b32 v29, 4, v18
  v_lshl_or_b32 v28, v29, 1, v28
  v_and_b32 v29, 8, v18
  v_lshrrev_b32 v29, 1, v29
  v_or_b32 v28, v28, v29
  v_mul_u32_u24 v28, 9216, v28
  v_lshl_add_u32 v28, v19, 4, v28
  v_add_u32 v8, s37, v28
  s_lshr_b32 s62, s2, 5
  s_bfe_u32 s63, s2, 0x20003
  s_lshl_b32 s63, s63, 1
  s_add_u32 s62, s62, s63
  s_cmp_ge_u32 s62, 9
  s_cselect_b32 s63, 9, 0
  s_sub_u32 s62, s62, s63
  s_mov_b32 s62, 0
  s_lshl_b32 s32, s3, 10
  s_lshl_b32 s33, s35, 10
  s_waitcnt lgkmcnt(0)
  s_add_u32 s16, s8, 0x240000
  s_addc_u32 s17, s9, 0
  s_mov_b32 s18, 0x240000
  s_mov_b32 s19, 0x00020000
  s_cmp_lt_u32 s3, 6
  s_cselect_b32 s20, s4, s6
  s_cselect_b32 s21, s5, s7
  s_mov_b32 s22, 5308416
  s_mov_b32 s23, 0x00020000
  s_add_u32 s64, s62, 0
  s_cmp_ge_u32 s64, 9
  s_cselect_b32 s65, 9, 0
  s_sub_u32 s64, s64, s65
  s_lshl_b32 s65, s64, 7
  s_mul_i32 s64, s64, 589824
  s_add_u32 m0, s33, 65536
  s_mov_b32 s34, s64
  buffer_load_dwordx4 v6, s[20:23], s34 offen lds
  s_add_u32 m0, s33, 66560
  s_mov_b32 s34, s64
  buffer_load_dwordx4 v7, s[20:23], s34 offen lds
  s_add_u32 m0, s33, 67584
  s_mov_b32 s34, s64
  buffer_load_dwordx4 v8, s[20:23], s34 offen lds
  s_add_u32 m0, s32, 0
  s_add_u32 s34, s65, 0
  buffer_load_dwordx4 v5, s[16:19], s34 offen lds
  s_add_u32 m0, s32, 12288
  s_add_u32 s34, s65, 110592
  buffer_load_dwordx4 v5, s[16:19], s34 offen lds
  s_cmp_ge_u32 s3, 8
  s_cbranch_scc1 k3_sk1
  s_add_u32 m0, s32, 24576
  s_add_u32 s34, s65, 221184
  buffer_load_dwordx4 v5, s[16:19], s34 offen lds
k3_sk1:
  s_setprio 0
  s_add_u32 s24, s8, 0x480000
  s_addc_u32 s25, s9, 0
  s_mov_b32 s26, 0x10000
  s_mov_b32 s27, 0x00020000
  s_add_u32 s44, s8, 0x560000
  s_addc_u32 s45, s9, 0
  s_mov_b32 s46, 0x1b000
  s_mov_b32 s47, 0x00020000
  v_and_b32 v16, 15, v0
  v_lshrrev_b32 v17, 4, v0
  s_lshl_b32 s34, s11, 8
  s_lshl_b32 s35, s12, 6
  s_add_u32 s34, s34, s35
  v_add_u32 v18, s34, v0
  v_lshlrev_b32 v18, 5, v18
  buffer_load_dwordx4 v[20:23], v18, s[24:27], 0 offen
  buffer_load_dwordx4 v[24:27], v18, s[24:27], 0 offen offset:16
  s_mul_i32 s34, s10, 576
  s_mul_i32 s35, s13, 192
  s_add_u32 s34, s34, s35
  v_and_b32 v19, 1, v17
  v_mul_u32_u24 v19, 18432, v19
  v_lshl_add_u32 v19, v16, 4, v19
  v_add_u32 v19, s34, v19
  buffer_load_dwordx4 v[32:35], v19, s[44:47], 0 offen
  s_mov_b32 s34, 36864
  s_mov_b32 s35, 73728
  buffer_load_dwordx4 v[40:43], v19, s[44:47], s34 offen
  buffer_load_dwordx4 v[44:47], v19, s[44:47], s35 offen
  s_add_u32 s28, s8, 0x600000
  s_addc_u32 s29, s9, 0
  s_mov_b32 s30, 0x1200000
  s_mov_b32 s31, 0x00020000
  s_mov_b32 s50, 5308416
  s_mov_b32 s51, 0x00020000
  s_mul_i32 s52, s2, 20736
  s_lshl_b32 s53, s3, 11
  s_add_u32 s52, s52, s53
  v_lshlrev_b32 v9, 4, v0
  s_add_u32 s56, s8, 0x1800000
  s_addc_u32 s57, s9, 0
  s_mov_b32 s58, 0x900000
  s_mov_b32 s59, 0x00020000
  s_mul_i32 s60, s2, 36864
  s_mul_i32 s61, s3, 3072
  s_add_u32 s60, s60, s61
  v_mov_b32 v12, -1
  v_mov_b32 v13, -1
  v_mov_b32 v14, -1
  v_mov_b32 v15, -1
  v_bfe_u32 v18, v0, 1, 3
  v_xor_b32 v18, v18, v17
  v_lshlrev_b32 v18, 4, v18
  v_lshl_add_u32 v18, v16, 7, v18
  s_lshl_b32 s34, s12, 13
  v_add_u32 v1, s34, v18
  v_xor_b32 v2, 64, v1
  v_bfe_u32 v18, v0, 2, 2
  v_and_b32 v19, 1, v17
  v_lshl_add_u32 v18, v19, 2, v18
  v_lshrrev_b32 v19, 1, v17
  v_lshl_add_u32 v18, v19, 4, v18
  v_mul_u32_u24 v18, 288, v18
  v_and_b32 v19, 3, v0
  v_lshl_add_u32 v18, v19, 3, v18
  s_mul_i32 s34, s13, 96
  s_add_u32 s34, s34, 65536
  v_add_u32 v3, s34, v18
  v_add_u32 v4, 36864, v3
  s_add_u32 s34, s32, 139264
  v_lshl_add_u32 v36, v0, 3, s34
  v_lshl_add_u32 v37, v16, 3, s34
  v_and_b32 v38, 31, v0
  v_lshl_add_u32 v38, v38, 4, s34
  v_lshl_add_u32 v39, v17, 4, s34
  s_waitcnt vmcnt(3)
  v_add_f32 v28, v20, v22
  v_add_f32 v29, v24, v26
  v_add_f32 v28, v28, v29
  v_mul_f32 v28, 0.25, v28
  v_add_f32 v29, v21, v23
  v_add_f32 v30, v25, v27
  v_add_f32 v29, v29, v30
  v_sub_f32 v20, v20, v28
  v_sub_f32 v22, v22, v28
  v_sub_f32 v24, v24, v28
  v_sub_f32 v26, v26, v28
  v_mul_f32 v30, v20, v20
  v_fmac_f32 v30, v22, v22
  v_fmac_f32 v30, v24, v24
  v_fmac_f32 v30, v26, v26
  v_mov_b32 v31, 0x43100000
  v_fmac_f32 v29, v31, v30
  v_mov_b32 v31, 0x3727c5ac
  v_mov_b32 v30, 0x3ae38e39
  v_fmac_f32 v31, v30, v29
  v_rsq_f32 v31, v31
  v_sub_f32 v30, 0, v28
  ds_write_b64 v36, v[30:31]
  s_waitcnt vmcnt(0)
  v_add_f32 v32, v32, v40
  v_add_f32 v32, v32, v44
  v_add_f32 v33, v33, v41
  v_add_f32 v33, v33, v45
  v_add_f32 v34, v34, v42
  v_add_f32 v34, v34, v46
  v_add_f32 v35, v35, v43
  v_add_f32 v35, v35, v47
  ds_write_b128 v38, v[32:35] offset:512
  ds_read_b64 v[20:21], v37 offset:0
  ds_read_b64 v[22:23], v37 offset:128
  ds_read_b64 v[24:25], v37 offset:256
  ds_read_b64 v[26:27], v37 offset:384
  ds_read_b128 v[48:51], v39 offset:512
  ds_read_b128 v[52:55], v39 offset:576
  ds_read_b128 v[56:59], v39 offset:640
  ds_read_b128 v[60:63], v39 offset:768
  ds_read_b128 v[64:67], v39 offset:832
  ds_read_b128 v[68:71], v39 offset:896
  s_waitcnt lgkmcnt(0)
  v_mul_f32 v72, v20, v48
  v_mul_f32 v73, v20, v49
  v_mul_f32 v74, v20, v50
  v_mul_f32 v75, v20, v51
  v_mul_f32 v76, v22, v48
  v_mul_f32 v77, v22, v49
  v_mul_f32 v78, v22, v50
  v_mul_f32 v79, v22, v51
  v_mul_f32 v80, v24, v48
  v_mul_f32 v81, v24, v49
  v_mul_f32 v82, v24, v50
  v_mul_f32 v83, v24, v51
  v_mul_f32 v84, v26, v48
  v_mul_f32 v85, v26, v49
  v_mul_f32 v86, v26, v50
  v_mul_f32 v87, v26, v51
  v_mul_f32 v88, v20, v52
  v_mul_f32 v89, v20, v53
  v_mul_f32 v90, v20, v54
  v_mul_f32 v91, v20, v55
  v_mul_f32 v92, v22, v52
  v_mul_f32 v93, v22, v53
  v_mul_f32 v94, v22, v54
  v_mul_f32 v95, v22, v55
  v_mul_f32 v96, v24, v52
  v_mul_f32 v97, v24, v53
  v_mul_f32 v98, v24, v54
  v_mul_f32 v99, v24, v55
  v_mul_f32 v100, v26, v52
  v_mul_f32 v101, v26, v53
  v_mul_f32 v102, v26, v54
  v_mul_f32 v103, v26, v55
  v_mul_f32 v104, v20, v56
  v_mul_f32 v105, v20, v57
  v_mul_f32 v106, v20, v58
  v_mul_f32 v107, v20, v59
  v_mul_f32 v108, v22, v56
  v_mul_f32 v109, v22, v57
  v_mul_f32 v110, v22, v58
  v_mul_f32 v111, v22, v59
  v_mul_f32 v112, v24, v56
  v_mul_f32 v113, v24, v57
  v_mul_f32 v114, v24, v58
  v_mul_f32 v115, v24, v59
  v_mul_f32 v116, v26, v56
  v_mul_f32 v117, v26, v57
  v_mul_f32 v118, v26, v58
  v_mul_f32 v119, v26, v59
  v_mul_f32 v120, v20, v60
  v_mul_f32 v121, v20, v61
  v_mul_f32 v122, v20, v62
  v_mul_f32 v123, v20, v63
  v_mul_f32 v124, v22, v60
  v_mul_f32 v125, v22, v61
  v_mul_f32 v126, v22, v62
  v_mul_f32 v127, v22, v63
  v_mul_f32 v128, v24, v60
  v_mul_f32 v129, v24, v61
  v_mul_f32 v130, v24, v62
  v_mul_f32 v131, v24, v63
  v_mul_f32 v132, v26, v60
  v_mul_f32 v133, v26, v61
  v_mul_f32 v134, v26, v62
  v_mul_f32 v135, v26, v63
  v_mul_f32 v136, v20, v64
  v_mul_f32 v137, v20, v65
  v_mul_f32 v138, v20, v66
  v_mul_f32 v139, v20, v67
  v_mul_f32 v140, v22, v64
  v_mul_f32 v141, v22, v65
  v_mul_f32 v142, v22, v66
  v_mul_f32 v143, v22, v67
  v_mul_f32 v144, v24, v64
  v_mul_f32 v145, v24, v65
  v_mul_f32 v146, v24, v66
  v_mul_f32 v147, v24, v67
  v_mul_f32 v148, v26, v64
  v_mul_f32 v149, v26, v65
  v_mul_f32 v150, v26, v66
  v_mul_f32 v151, v26, v67
  v_mul_f32 v152, v20, v68
  v_mul_f32 v153, v20, v69
  v_mul_f32 v154, v20, v70
  v_mul_f32 v155, v20, v71
  v_mul_f32 v156, v22, v68
  v_mul_f32 v157, v22, v69
  v_mul_f32 v158, v22, v70
  v_mul_f32 v159, v22, v71
  v_mul_f32 v160, v24, v68
  v_mul_f32 v161, v24, v69
  v_mul_f32 v162, v24, v70
  v_mul_f32 v163, v24, v71
  v_mul_f32 v164, v26, v68
  v_mul_f32 v165, v26, v69
  v_mul_f32 v166, v26, v70
  v_mul_f32 v167, v26, v71
  s_barrier
  ds_read_b128 v[16:19], v1 offset:0
  ds_read_b128 v[20:23], v1 offset:2048
  ds_read_b128 v[24:27], v1 offset:4096
  ds_read_b128 v[28:31], v1 offset:6144
  ds_read_b64_tr_b16 v[48:49], v3 offset:0
  ds_read_b64_tr_b16 v[50:51], v3 offset:2304
  ds_read_b64_tr_b16 v[52:53], v3 offset:32
  ds_read_b64_tr_b16 v[54:55], v3 offset:2336
  ds_read_b64_tr_b16 v[56:57], v3 offset:64
  ds_read_b64_tr_b16 v[58:59], v3 offset:2368
  ds_read_b64_tr_b16 v[60:61], v3 offset:18432
  ds_read_b64_tr_b16 v[62:63], v3 offset:20736
  ds_read_b64_tr_b16 v[64:65], v3 offset:18464
  ds_read_b64_tr_b16 v[66:67], v3 offset:20768
  ds_read_b64_tr_b16 v[68:69], v3 offset:18496
  ds_read_b64_tr_b16 v[70:71], v3 offset:20800
  ds_read_b128 v[32:35], v2 offset:0
  ds_read_b128 v[36:39], v2 offset:2048
  ds_read_b128 v[40:43], v2 offset:4096
  ds_read_b128 v[44:47], v2 offset:6144
  s_waitcnt lgkmcnt(14)
  v_mfma_f32_16x16x32_bf16 v[72:75], v[48:51], v[16:19], v[72:75]
  v_mfma_f32_16x16x32_bf16 v[76:79], v[48:51], v[20:23], v[76:79]
  v_mfma_f32_16x16x32_bf16 v[80:83], v[48:51], v[24:27], v[80:83]
  v_mfma_f32_16x16x32_bf16 v[84:87], v[48:51], v[28:31], v[84:87]
  ds_read_b64_tr_b16 v[48:49], v3 offset:9216
  ds_read_b64_tr_b16 v[50:51], v3 offset:11520
  s_add_u32 s64, s62, 1
  s_cmp_ge_u32 s64, 9
  s_cselect_b32 s65, 9, 0
  s_sub_u32 s64, s64, s65
  s_lshl_b32 s65, s64, 7
  s_mul_i32 s64, s64, 589824
  s_add_u32 m0, s33, 102400
  s_mov_b32 s34, s64
  buffer_load_dwordx4 v6, s[20:23], s34 offen lds
  s_waitcnt lgkmcnt(14)
  v_mfma_f32_16x16x32_bf16 v[88:91], v[52:55], v[16:19], v[88:91]
  v_mfma_f32_16x16x32_bf16 v[92:95], v[52:55], v[20:23], v[92:95]
  v_mfma_f32_16x16x32_bf16 v[96:99], v[52:55], v[24:27], v[96:99]
  v_mfma_f32_16x16x32_bf16 v[100:103], v[52:55], v[28:31], v[100:103]
  ds_read_b64_tr_b16 v[52:53], v3 offset:9248
  ds_read_b64_tr_b16 v[54:55], v3 offset:11552
  s_add_u32 m0, s33, 103424
  s_mov_b32 s34, s64
  buffer_load_dwordx4 v7, s[20:23], s34 offen lds
  s_waitcnt lgkmcnt(14)
  v_mfma_f32_16x16x32_bf16 v[104:107], v[56:59], v[16:19], v[104:107]
  v_mfma_f32_16x16x32_bf16 v[108:111], v[56:59], v[20:23], v[108:111]
  v_mfma_f32_16x16x32_bf16 v[112:115], v[56:59], v[24:27], v[112:115]
  v_mfma_f32_16x16x32_bf16 v[116:119], v[56:59], v[28:31], v[116:119]
  ds_read_b64_tr_b16 v[56:57], v3 offset:9280
  ds_read_b64_tr_b16 v[58:59], v3 offset:11584
  s_add_u32 m0, s33, 104448
  s_mov_b32 s34, s64
  buffer_load_dwordx4 v8, s[20:23], s34 offen lds
  s_waitcnt lgkmcnt(14)
  v_mfma_f32_16x16x32_bf16 v[120:123], v[60:63], v[16:19], v[120:123]
  v_mfma_f32_16x16x32_bf16 v[124:127], v[60:63], v[20:23], v[124:127]
  v_mfma_f32_16x16x32_bf16 v[128:131], v[60:63], v[24:27], v[128:131]
  v_mfma_f32_16x16x32_bf16 v[132:135], v[60:63], v[28:31], v[132:135]
  ds_read_b64_tr_b16 v[60:61], v3 offset:27648
  ds_read_b64_tr_b16 v[62:63], v3 offset:29952
  s_add_u32 m0, s32, 32768
  s_add_u32 s34, s65, 0
  buffer_load_dwordx4 v5, s[16:19], s34 offen lds
  s_waitcnt lgkmcnt(14)
  v_mfma_f32_16x16x32_bf16 v[136:139], v[64:67], v[16:19], v[136:139]
  v_mfma_f32_16x16x32_bf16 v[140:143], v[64:67], v[20:23], v[140:143]
  v_mfma_f32_16x16x32_bf16 v[144:147], v[64:67], v[24:27], v[144:147]
  v_mfma_f32_16x16x32_bf16 v[148:151], v[64:67], v[28:31], v[148:151]
  ds_read_b64_tr_b16 v[64:65], v3 offset:27680
  ds_read_b64_tr_b16 v[66:67], v3 offset:29984
  s_add_u32 m0, s32, 45056
  s_add_u32 s34, s65, 110592
  buffer_load_dwordx4 v5, s[16:19], s34 offen lds
  s_waitcnt lgkmcnt(14)
  v_mfma_f32_16x16x32_bf16 v[152:155], v[68:71], v[16:19], v[152:155]
  v_mfma_f32_16x16x32_bf16 v[156:159], v[68:71], v[20:23], v[156:159]
  v_mfma_f32_16x16x32_bf16 v[160:163], v[68:71], v[24:27], v[160:163]
  v_mfma_f32_16x16x32_bf16 v[164:167], v[68:71], v[28:31], v[164:167]
  ds_read_b64_tr_b16 v[68:69], v3 offset:27712
  ds_read_b64_tr_b16 v[70:71], v3 offset:30016
  s_cmp_ge_u32 s3, 8
  s_cbranch_scc1 k3_sk2
  s_add_u32 m0, s32, 57344
  s_add_u32 s34, s65, 221184
  buffer_load_dwordx4 v5, s[16:19], s34 offen lds
k3_sk2:
  s_waitcnt lgkmcnt(10)
  v_mfma_f32_16x16x32_bf16 v[72:75], v[48:51], v[32:35], v[72:75]
  v_mfma_f32_16x16x32_bf16 v[76:79], v[48:51], v[36:39], v[76:79]
  v_mfma_f32_16x16x32_bf16 v[80:83], v[48:51], v[40:43], v[80:83]
  v_mfma_f32_16x16x32_bf16 v[84:87], v[48:51], v[44:47], v[84:87]
  s_waitcnt lgkmcnt(8)
  v_mfma_f32_16x16x32_bf16 v[88:91], v[52:55], v[32:35], v[88:91]
  v_mfma_f32_16x16x32_bf16 v[92:95], v[52:55], v[36:39], v[92:95]
  v_mfma_f32_16x16x32_bf16 v[96:99], v[52:55], v[40:43], v[96:99]
  v_mfma_f32_16x16x32_bf16 v[100:103], v[52:55], v[44:47], v[100:103]
  s_waitcnt lgkmcnt(6)
  v_mfma_f32_16x16x32_bf16 v[104:107], v[56:59], v[32:35], v[104:107]
  v_mfma_f32_16x16x32_bf16 v[108:111], v[56:59], v[36:39], v[108:111]
  v_mfma_f32_16x16x32_bf16 v[112:115], v[56:59], v[40:43], v[112:115]
  v_mfma_f32_16x16x32_bf16 v[116:119], v[56:59], v[44:47], v[116:119]
  s_waitcnt lgkmcnt(0)
  s_waitcnt vmcnt(0)
  s_barrier
  ds_read_b128 v[16:19], v1 offset:32768
  ds_read_b128 v[20:23], v1 offset:34816
  ds_read_b128 v[24:27], v1 offset:36864
  ds_read_b128 v[28:31], v1 offset:38912
  ds_read_b64_tr_b16 v[48:49], v4 offset:0
  ds_read_b64_tr_b16 v[50:51], v4 offset:2304
  ds_read_b64_tr_b16 v[52:53], v4 offset:32
  ds_read_b64_tr_b16 v[54:55], v4 offset:2336
  ds_read_b64_tr_b16 v[56:57], v4 offset:64
  ds_read_b64_tr_b16 v[58:59], v4 offset:2368
  s_add_u32 s64, s62, 2
  s_cmp_ge_u32 s64, 9
  s_cselect_b32 s65, 9, 0
  s_sub_u32 s64, s64, s65
  s_lshl_b32 s65, s64, 7
  s_mul_i32 s64, s64, 589824
  s_add_u32 m0, s33, 65536
  s_mov_b32 s34, s64
  buffer_load_dwordx4 v6, s[20:23], s34 offen lds
  v_mfma_f32_16x16x32_bf16 v[120:123], v[60:63], v[32:35], v[120:123]
  v_mfma_f32_16x16x32_bf16 v[124:127], v[60:63], v[36:39], v[124:127]
  v_mfma_f32_16x16x32_bf16 v[128:131], v[60:63], v[40:43], v[128:131]
  v_mfma_f32_16x16x32_bf16 v[132:135], v[60:63], v[44:47], v[132:135]
  ds_read_b64_tr_b16 v[60:61], v4 offset:18432
  ds_read_b64_tr_b16 v[62:63], v4 offset:20736
  s_add_u32 m0, s33, 66560
  s_mov_b32 s34, s64
  buffer_load_dwordx4 v7, s[20:23], s34 offen lds
  v_mfma_f32_16x16x32_bf16 v[136:139], v[64:67], v[32:35], v[136:139]
  v_mfma_f32_16x16x32_bf16 v[140:143], v[64:67], v[36:39], v[140:143]
  v_mfma_f32_16x16x32_bf16 v[144:147], v[64:67], v[40:43], v[144:147]
  v_mfma_f32_16x16x32_bf16 v[148:151], v[64:67], v[44:47], v[148:151]
  ds_read_b64_tr_b16 v[64:65], v4 offset:18464
  ds_read_b64_tr_b16 v[66:67], v4 offset:20768
  s_add_u32 m0, s33, 67584
  s_mov_b32 s34, s64
  buffer_load_dwordx4 v8, s[20:23], s34 offen lds
  v_mfma_f32_16x16x32_bf16 v[152:155], v[68:71], v[32:35], v[152:155]
  v_mfma_f32_16x16x32_bf16 v[156:159], v[68:71], v[36:39], v[156:159]
  v_mfma_f32_16x16x32_bf16 v[160:163], v[68:71], v[40:43], v[160:163]
  v_mfma_f32_16x16x32_bf16 v[164:167], v[68:71], v[44:47], v[164:167]
  ds_read_b64_tr_b16 v[68:69], v4 offset:18496
  ds_read_b64_tr_b16 v[70:71], v4 offset:20800
  s_add_u32 m0, s32, 0
  s_add_u32 s34, s65, 0
  buffer_load_dwordx4 v5, s[16:19], s34 offen lds
  ds_read_b128 v[32:35], v2 offset:32768
  ds_read_b128 v[36:39], v2 offset:34816
  ds_read_b128 v[40:43], v2 offset:36864
  ds_read_b128 v[44:47], v2 offset:38912
  s_waitcnt lgkmcnt(14)
  v_mfma_f32_16x16x32_bf16 v[72:75], v[48:51], v[16:19], v[72:75]
  v_mfma_f32_16x16x32_bf16 v[76:79], v[48:51], v[20:23], v[76:79]
  v_mfma_f32_16x16x32_bf16 v[80:83], v[48:51], v[24:27], v[80:83]
  v_mfma_f32_16x16x32_bf16 v[84:87], v[48:51], v[28:31], v[84:87]
  ds_read_b64_tr_b16 v[48:49], v4 offset:9216
  ds_read_b64_tr_b16 v[50:51], v4 offset:11520
  s_add_u32 m0, s32, 12288
  s_add_u32 s34, s65, 110592
  buffer_load_dwordx4 v5, s[16:19], s34 offen lds
  s_waitcnt lgkmcnt(14)
  v_mfma_f32_16x16x32_bf16 v[88:91], v[52:55], v[16:19], v[88:91]
  v_mfma_f32_16x16x32_bf16 v[92:95], v[52:55], v[20:23], v[92:95]
  v_mfma_f32_16x16x32_bf16 v[96:99], v[52:55], v[24:27], v[96:99]
  v_mfma_f32_16x16x32_bf16 v[100:103], v[52:55], v[28:31], v[100:103]
  ds_read_b64_tr_b16 v[52:53], v4 offset:9248
  ds_read_b64_tr_b16 v[54:55], v4 offset:11552
  s_cmp_ge_u32 s3, 8
  s_cbranch_scc1 k3_sk3
  s_add_u32 m0, s32, 24576
  s_add_u32 s34, s65, 221184
  buffer_load_dwordx4 v5, s[16:19], s34 offen lds
k3_sk3:
  s_waitcnt lgkmcnt(14)
  v_mfma_f32_16x16x32_bf16 v[104:107], v[56:59], v[16:19], v[104:107]
  v_mfma_f32_16x16x32_bf16 v[108:111], v[56:59], v[20:23], v[108:111]
  v_mfma_f32_16x16x32_bf16 v[112:115], v[56:59], v[24:27], v[112:115]
  v_mfma_f32_16x16x32_bf16 v[116:119], v[56:59], v[28:31], v[116:119]
  ds_read_b64_tr_b16 v[56:57], v4 offset:9280
  ds_read_b64_tr_b16 v[58:59], v4 offset:11584
  s_waitcnt lgkmcnt(14)
  v_mfma_f32_16x16x32_bf16 v[120:123], v[60:63], v[16:19], v[120:123]
  v_mfma_f32_16x16x32_bf16 v[124:127], v[60:63], v[20:23], v[124:127]
  v_mfma_f32_16x16x32_bf16 v[128:131], v[60:63], v[24:27], v[128:131]
  v_mfma_f32_16x16x32_bf16 v[132:135], v[60:63], v[28:31], v[132:135]
  ds_read_b64_tr_b16 v[60:61], v4 offset:27648
  ds_read_b64_tr_b16 v[62:63], v4 offset:29952
  s_waitcnt lgkmcnt(14)
  v_mfma_f32_16x16x32_bf16 v[136:139], v[64:67], v[16:19], v[136:139]
  v_mfma_f32_16x16x32_bf16 v[140:143], v[64:67], v[20:23], v[140:143]
  v_mfma_f32_16x16x32_bf16 v[144:147], v[64:67], v[24:27], v[144:147]
  v_mfma_f32_16x16x32_bf16 v[148:151], v[64:67], v[28:31], v[148:151]
  ds_read_b64_tr_b16 v[64:65], v4 offset:27680
  ds_read_b64_tr_b16 v[66:67], v4 offset:29984
  s_waitcnt lgkmcnt(14)
  v_mfma_f32_16x16x32_bf16 v[152:155], v[68:71], v[16:19], v[152:155]
  v_mfma_f32_16x16x32_bf16 v[156:159], v[68:71], v[20:23], v[156:159]
  v_mfma_f32_16x16x32_bf16 v[160:163], v[68:71], v[24:27], v[160:163]
  v_mfma_f32_16x16x32_bf16 v[164:167], v[68:71], v[28:31], v[164:167]
  ds_read_b64_tr_b16 v[68:69], v4 offset:27712
  ds_read_b64_tr_b16 v[70:71], v4 offset:30016
  buffer_store_dwordx4 v[12:15], v9, s[56:59], s60 offen offset:0 sc1
  s_waitcnt lgkmcnt(10)
  v_mfma_f32_16x16x32_bf16 v[72:75], v[48:51], v[32:35], v[72:75]
  v_mfma_f32_16x16x32_bf16 v[76:79], v[48:51], v[36:39], v[76:79]
  v_mfma_f32_16x16x32_bf16 v[80:83], v[48:51], v[40:43], v[80:83]
  v_mfma_f32_16x16x32_bf16 v[84:87], v[48:51], v[44:47], v[84:87]
  s_waitcnt lgkmcnt(8)
  v_mfma_f32_16x16x32_bf16 v[88:91], v[52:55], v[32:35], v[88:91]
  v_mfma_f32_16x16x32_bf16 v[92:95], v[52:55], v[36:39], v[92:95]
  v_mfma_f32_16x16x32_bf16 v[96:99], v[52:55], v[40:43], v[96:99]
  v_mfma_f32_16x16x32_bf16 v[100:103], v[52:55], v[44:47], v[100:103]
  s_waitcnt lgkmcnt(6)
  v_mfma_f32_16x16x32_bf16 v[104:107], v[56:59], v[32:35], v[104:107]
  v_mfma_f32_16x16x32_bf16 v[108:111], v[56:59], v[36:39], v[108:111]
  v_mfma_f32_16x16x32_bf16 v[112:115], v[56:59], v[40:43], v[112:115]
  v_mfma_f32_16x16x32_bf16 v[116:119], v[56:59], v[44:47], v[116:119]
  s_waitcnt lgkmcnt(0)
  s_waitcnt vmcnt(0)
  s_barrier
  ds_read_b128 v[16:19], v1 offset:0
  ds_read_b128 v[20:23], v1 offset:2048
  ds_read_b128 v[24:27], v1 offset:4096
  ds_read_b128 v[28:31], v1 offset:6144
  ds_read_b64_tr_b16 v[48:49], v3 offset:0
  ds_read_b64_tr_b16 v[50:51], v3 offset:2304
  ds_read_b64_tr_b16 v[52:53], v3 offset:32
  ds_read_b64_tr_b16 v[54:55], v3 offset:2336
  ds_read_b64_tr_b16 v[56:57], v3 offset:64
  ds_read_b64_tr_b16 v[58:59], v3 offset:2368
  s_add_u32 s64, s62, 3
  s_cmp_ge_u32 s64, 9
  s_cselect_b32 s65, 9, 0
  s_sub_u32 s64, s64, s65
  s_lshl_b32 s65, s64, 7
  s_mul_i32 s64, s64, 589824
  s_add_u32 m0, s33, 102400
  s_mov_b32 s34, s64
  buffer_load_dwordx4 v6, s[20:23], s34 offen lds
  v_mfma_f32_16x16x32_bf16 v[120:123], v[60:63], v[32:35], v[120:123]
  v_mfma_f32_16x16x32_bf16 v[124:127], v[60:63], v[36:39], v[124:127]
  v_mfma_f32_16x16x32_bf16 v[128:131], v[60:63], v[40:43], v[128:131]
  v_mfma_f32_16x16x32_bf16 v[132:135], v[60:63], v[44:47], v[132:135]
  ds_read_b64_tr_b16 v[60:61], v3 offset:18432
  ds_read_b64_tr_b16 v[62:63], v3 offset:20736
  s_add_u32 m0, s33, 103424
  s_mov_b32 s34, s64
  buffer_load_dwordx4 v7, s[20:23], s34 offen lds
  v_mfma_f32_16x16x32_bf16 v[136:139], v[64:67], v[32:35], v[136:139]
  v_mfma_f32_16x16x32_bf16 v[140:143], v[64:67], v[36:39], v[140:143]
  v_mfma_f32_16x16x32_bf16 v[144:147], v[64:67], v[40:43], v[144:147]
  v_mfma_f32_16x16x32_bf16 v[148:151], v[64:67], v[44:47], v[148:151]
  ds_read_b64_tr_b16 v[64:65], v3 offset:18464
  ds_read_b64_tr_b16 v[66:67], v3 offset:20768
  s_add_u32 m0, s33, 104448
  s_mov_b32 s34, s64
  buffer_load_dwordx4 v8, s[20:23], s34 offen lds
  v_mfma_f32_16x16x32_bf16 v[152:155], v[68:71], v[32:35], v[152:155]
  v_mfma_f32_16x16x32_bf16 v[156:159], v[68:71], v[36:39], v[156:159]
  v_mfma_f32_16x16x32_bf16 v[160:163], v[68:71], v[40:43], v[160:163]
  v_mfma_f32_16x16x32_bf16 v[164:167], v[68:71], v[44:47], v[164:167]
  ds_read_b64_tr_b16 v[68:69], v3 offset:18496
  ds_read_b64_tr_b16 v[70:71], v3 offset:20800
  s_add_u32 m0, s32, 32768
  s_add_u32 s34, s65, 0
  buffer_load_dwordx4 v5, s[16:19], s34 offen lds
  ds_read_b128 v[32:35], v2 offset:0
  ds_read_b128 v[36:39], v2 offset:2048
  ds_read_b128 v[40:43], v2 offset:4096
  ds_read_b128 v[44:47], v2 offset:6144
  s_waitcnt lgkmcnt(14)
  v_mfma_f32_16x16x32_bf16 v[72:75], v[48:51], v[16:19], v[72:75]
  v_mfma_f32_16x16x32_bf16 v[76:79], v[48:51], v[20:23], v[76:79]
  v_mfma_f32_16x16x32_bf16 v[80:83], v[48:51], v[24:27], v[80:83]
  v_mfma_f32_16x16x32_bf16 v[84:87], v[48:51], v[28:31], v[84:87]
  ds_read_b64_tr_b16 v[48:49], v3 offset:9216
  ds_read_b64_tr_b16 v[50:51], v3 offset:11520
  s_add_u32 m0, s32, 45056
  s_add_u32 s34, s65, 110592
  buffer_load_dwordx4 v5, s[16:19], s34 offen lds
  s_waitcnt lgkmcnt(14)
  v_mfma_f32_16x16x32_bf16 v[88:91], v[52:55], v[16:19], v[88:91]
  v_mfma_f32_16x16x32_bf16 v[92:95], v[52:55], v[20:23], v[92:95]
  v_mfma_f32_16x16x32_bf16 v[96:99], v[52:55], v[24:27], v[96:99]
  v_mfma_f32_16x16x32_bf16 v[100:103], v[52:55], v[28:31], v[100:103]
  ds_read_b64_tr_b16 v[52:53], v3 offset:9248
  ds_read_b64_tr_b16 v[54:55], v3 offset:11552
  s_cmp_ge_u32 s3, 8
  s_cbranch_scc1 k3_sk4
  s_add_u32 m0, s32, 57344
  s_add_u32 s34, s65, 221184
  buffer_load_dwordx4 v5, s[16:19], s34 offen lds
k3_sk4:
  s_waitcnt lgkmcnt(14)
  v_mfma_f32_16x16x32_bf16 v[104:107], v[56:59], v[16:19], v[104:107]
  v_mfma_f32_16x16x32_bf16 v[108:111], v[56:59], v[20:23], v[108:111]
  v_mfma_f32_16x16x32_bf16 v[112:115], v[56:59], v[24:27], v[112:115]
  v_mfma_f32_16x16x32_bf16 v[116:119], v[56:59], v[28:31], v[116:119]
  ds_read_b64_tr_b16 v[56:57], v3 offset:9280
  ds_read_b64_tr_b16 v[58:59], v3 offset:11584
  s_waitcnt lgkmcnt(14)
  v_mfma_f32_16x16x32_bf16 v[120:123], v[60:63], v[16:19], v[120:123]
  v_mfma_f32_16x16x32_bf16 v[124:127], v[60:63], v[20:23], v[124:127]
  v_mfma_f32_16x16x32_bf16 v[128:131], v[60:63], v[24:27], v[128:131]
  v_mfma_f32_16x16x32_bf16 v[132:135], v[60:63], v[28:31], v[132:135]
  ds_read_b64_tr_b16 v[60:61], v3 offset:27648
  ds_read_b64_tr_b16 v[62:63], v3 offset:29952
  s_waitcnt lgkmcnt(14)
  v_mfma_f32_16x16x32_bf16 v[136:139], v[64:67], v[16:19], v[136:139]
  v_mfma_f32_16x16x32_bf16 v[140:143], v[64:67], v[20:23], v[140:143]
  v_mfma_f32_16x16x32_bf16 v[144:147], v[64:67], v[24:27], v[144:147]
  v_mfma_f32_16x16x32_bf16 v[148:151], v[64:67], v[28:31], v[148:151]
  ds_read_b64_tr_b16 v[64:65], v3 offset:27680
  ds_read_b64_tr_b16 v[66:67], v3 offset:29984
  s_waitcnt lgkmcnt(14)
  v_mfma_f32_16x16x32_bf16 v[152:155], v[68:71], v[16:19], v[152:155]
  v_mfma_f32_16x16x32_bf16 v[156:159], v[68:71], v[20:23], v[156:159]
  v_mfma_f32_16x16x32_bf16 v[160:163], v[68:71], v[24:27], v[160:163]
  v_mfma_f32_16x16x32_bf16 v[164:167], v[68:71], v[28:31], v[164:167]
  ds_read_b64_tr_b16 v[68:69], v3 offset:27712
  ds_read_b64_tr_b16 v[70:71], v3 offset:30016
  s_mov_b32 m0, 151552
  s_add_u32 s53, s52, 0
  buffer_load_dwordx4 v9, s[48:51], s53 offen lds
  s_waitcnt lgkmcnt(10)
  v_mfma_f32_16x16x32_bf16 v[72:75], v[48:51], v[32:35], v[72:75]
  v_mfma_f32_16x16x32_bf16 v[76:79], v[48:51], v[36:39], v[76:79]
  v_mfma_f32_16x16x32_bf16 v[80:83], v[48:51], v[40:43], v[80:83]
  v_mfma_f32_16x16x32_bf16 v[84:87], v[48:51], v[44:47], v[84:87]
  s_waitcnt lgkmcnt(8)
  v_mfma_f32_16x16x32_bf16 v[88:91], v[52:55], v[32:35], v[88:91]
  v_mfma_f32_16x16x32_bf16 v[92:95], v[52:55], v[36:39], v[92:95]
  v_mfma_f32_16x16x32_bf16 v[96:99], v[52:55], v[40:43], v[96:99]
  v_mfma_f32_16x16x32_bf16 v[100:103], v[52:55], v[44:47], v[100:103]
  s_waitcnt lgkmcnt(6)
  v_mfma_f32_16x16x32_bf16 v[104:107], v[56:59], v[32:35], v[104:107]
  v_mfma_f32_16x16x32_bf16 v[108:111], v[56:59], v[36:39], v[108:111]
  v_mfma_f32_16x16x32_bf16 v[112:115], v[56:59], v[40:43], v[112:115]
  v_mfma_f32_16x16x32_bf16 v[116:119], v[56:59], v[44:47], v[116:119]
  s_waitcnt lgkmcnt(0)
  s_waitcnt vmcnt(0)
  s_barrier
  ds_read_b128 v[16:19], v1 offset:32768
  ds_read_b128 v[20:23], v1 offset:34816
  ds_read_b128 v[24:27], v1 offset:36864
  ds_read_b128 v[28:31], v1 offset:38912
  ds_read_b64_tr_b16 v[48:49], v4 offset:0
  ds_read_b64_tr_b16 v[50:51], v4 offset:2304
  ds_read_b64_tr_b16 v[52:53], v4 offset:32
  ds_read_b64_tr_b16 v[54:55], v4 offset:2336
  ds_read_b64_tr_b16 v[56:57], v4 offset:64
  ds_read_b64_tr_b16 v[58:59], v4 offset:2368
  s_add_u32 s64, s62, 4
  s_cmp_ge_u32 s64, 9
  s_cselect_b32 s65, 9, 0
  s_sub_u32 s64, s64, s65
  s_lshl_b32 s65, s64, 7
  s_mul_i32 s64, s64, 589824
  s_add_u32 m0, s33, 65536
  s_mov_b32 s34, s64
  buffer_load_dwordx4 v6, s[20:23], s34 offen lds
  v_mfma_f32_16x16x32_bf16 v[120:123], v[60:63], v[32:35], v[120:123]
  v_mfma_f32_16x16x32_bf16 v[124:127], v[60:63], v[36:39], v[124:127]
  v_mfma_f32_16x16x32_bf16 v[128:131], v[60:63], v[40:43], v[128:131]
  v_mfma_f32_16x16x32_bf16 v[132:135], v[60:63], v[44:47], v[132:135]
  ds_read_b64_tr_b16 v[60:61], v4 offset:18432
  ds_read_b64_tr_b16 v[62:63], v4 offset:20736
  s_add_u32 m0, s33, 66560
  s_mov_b32 s34, s64
  buffer_load_dwordx4 v7, s[20:23], s34 offen lds
  v_mfma_f32_16x16x32_bf16 v[136:139], v[64:67], v[32:35], v[136:139]
  v_mfma_f32_16x16x32_bf16 v[140:143], v[64:67], v[36:39], v[140:143]
  v_mfma_f32_16x16x32_bf16 v[144:147], v[64:67], v[40:43], v[144:147]
  v_mfma_f32_16x16x32_bf16 v[148:151], v[64:67], v[44:47], v[148:151]
  ds_read_b64_tr_b16 v[64:65], v4 offset:18464
  ds_read_b64_tr_b16 v[66:67], v4 offset:20768
  s_add_u32 m0, s33, 67584
  s_mov_b32 s34, s64
  buffer_load_dwordx4 v8, s[20:23], s34 offen lds
  v_mfma_f32_16x16x32_bf16 v[152:155], v[68:71], v[32:35], v[152:155]
  v_mfma_f32_16x16x32_bf16 v[156:159], v[68:71], v[36:39], v[156:159]
  v_mfma_f32_16x16x32_bf16 v[160:163], v[68:71], v[40:43], v[160:163]
  v_mfma_f32_16x16x32_bf16 v[164:167], v[68:71], v[44:47], v[164:167]
  ds_read_b64_tr_b16 v[68:69], v4 offset:18496
  ds_read_b64_tr_b16 v[70:71], v4 offset:20800
  s_add_u32 m0, s32, 0
  s_add_u32 s34, s65, 0
  buffer_load_dwordx4 v5, s[16:19], s34 offen lds
  ds_read_b128 v[32:35], v2 offset:32768
  ds_read_b128 v[36:39], v2 offset:34816
  ds_read_b128 v[40:43], v2 offset:36864
  ds_read_b128 v[44:47], v2 offset:38912
  s_waitcnt lgkmcnt(14)
  v_mfma_f32_16x16x32_bf16 v[72:75], v[48:51], v[16:19], v[72:75]
  v_mfma_f32_16x16x32_bf16 v[76:79], v[48:51], v[20:23], v[76:79]
  v_mfma_f32_16x16x32_bf16 v[80:83], v[48:51], v[24:27], v[80:83]
  v_mfma_f32_16x16x32_bf16 v[84:87], v[48:51], v[28:31], v[84:87]
  ds_read_b64_tr_b16 v[48:49], v4 offset:9216
  ds_read_b64_tr_b16 v[50:51], v4 offset:11520
  s_add_u32 m0, s32, 12288
  s_add_u32 s34, s65, 110592
  buffer_load_dwordx4 v5, s[16:19], s34 offen lds
  s_waitcnt lgkmcnt(14)
  v_mfma_f32_16x16x32_bf16 v[88:91], v[52:55], v[16:19], v[88:91]
  v_mfma_f32_16x16x32_bf16 v[92:95], v[52:55], v[20:23], v[92:95]
  v_mfma_f32_16x16x32_bf16 v[96:99], v[52:55], v[24:27], v[96:99]
  v_mfma_f32_16x16x32_bf16 v[100:103], v[52:55], v[28:31], v[100:103]
  ds_read_b64_tr_b16 v[52:53], v4 offset:9248
  ds_read_b64_tr_b16 v[54:55], v4 offset:11552
  s_cmp_ge_u32 s3, 8
  s_cbranch_scc1 k3_sk5
  s_add_u32 m0, s32, 24576
  s_add_u32 s34, s65, 221184
  buffer_load_dwordx4 v5, s[16:19], s34 offen lds
k3_sk5:
  s_waitcnt lgkmcnt(14)
  v_mfma_f32_16x16x32_bf16 v[104:107], v[56:59], v[16:19], v[104:107]
  v_mfma_f32_16x16x32_bf16 v[108:111], v[56:59], v[20:23], v[108:111]
  v_mfma_f32_16x16x32_bf16 v[112:115], v[56:59], v[24:27], v[112:115]
  v_mfma_f32_16x16x32_bf16 v[116:119], v[56:59], v[28:31], v[116:119]
  ds_read_b64_tr_b16 v[56:57], v4 offset:9280
  ds_read_b64_tr_b16 v[58:59], v4 offset:11584
  s_waitcnt lgkmcnt(14)
  v_mfma_f32_16x16x32_bf16 v[120:123], v[60:63], v[16:19], v[120:123]
  v_mfma_f32_16x16x32_bf16 v[124:127], v[60:63], v[20:23], v[124:127]
  v_mfma_f32_16x16x32_bf16 v[128:131], v[60:63], v[24:27], v[128:131]
  v_mfma_f32_16x16x32_bf16 v[132:135], v[60:63], v[28:31], v[132:135]
  ds_read_b64_tr_b16 v[60:61], v4 offset:27648
  ds_read_b64_tr_b16 v[62:63], v4 offset:29952
  s_waitcnt lgkmcnt(14)
  v_mfma_f32_16x16x32_bf16 v[136:139], v[64:67], v[16:19], v[136:139]
  v_mfma_f32_16x16x32_bf16 v[140:143], v[64:67], v[20:23], v[140:143]
  v_mfma_f32_16x16x32_bf16 v[144:147], v[64:67], v[24:27], v[144:147]
  v_mfma_f32_16x16x32_bf16 v[148:151], v[64:67], v[28:31], v[148:151]
  ds_read_b64_tr_b16 v[64:65], v4 offset:27680
  ds_read_b64_tr_b16 v[66:67], v4 offset:29984
  s_waitcnt lgkmcnt(14)
  v_mfma_f32_16x16x32_bf16 v[152:155], v[68:71], v[16:19], v[152:155]
  v_mfma_f32_16x16x32_bf16 v[156:159], v[68:71], v[20:23], v[156:159]
  v_mfma_f32_16x16x32_bf16 v[160:163], v[68:71], v[24:27], v[160:163]
  v_mfma_f32_16x16x32_bf16 v[164:167], v[68:71], v[28:31], v[164:167]
  ds_read_b64_tr_b16 v[68:69], v4 offset:27712
  ds_read_b64_tr_b16 v[70:71], v4 offset:30016
  buffer_store_dwordx4 v[12:15], v9, s[56:59], s60 offen offset:1024 sc1
  s_waitcnt lgkmcnt(10)
  v_mfma_f32_16x16x32_bf16 v[72:75], v[48:51], v[32:35], v[72:75]
  v_mfma_f32_16x16x32_bf16 v[76:79], v[48:51], v[36:39], v[76:79]
  v_mfma_f32_16x16x32_bf16 v[80:83], v[48:51], v[40:43], v[80:83]
  v_mfma_f32_16x16x32_bf16 v[84:87], v[48:51], v[44:47], v[84:87]
  s_waitcnt lgkmcnt(8)
  v_mfma_f32_16x16x32_bf16 v[88:91], v[52:55], v[32:35], v[88:91]
  v_mfma_f32_16x16x32_bf16 v[92:95], v[52:55], v[36:39], v[92:95]
  v_mfma_f32_16x16x32_bf16 v[96:99], v[52:55], v[40:43], v[96:99]
  v_mfma_f32_16x16x32_bf16 v[100:103], v[52:55], v[44:47], v[100:103]
  s_waitcnt lgkmcnt(6)
  v_mfma_f32_16x16x32_bf16 v[104:107], v[56:59], v[32:35], v[104:107]
  v_mfma_f32_16x16x32_bf16 v[108:111], v[56:59], v[36:39], v[108:111]
  v_mfma_f32_16x16x32_bf16 v[112:115], v[56:59], v[40:43], v[112:115]
  v_mfma_f32_16x16x32_bf16 v[116:119], v[56:59], v[44:47], v[116:119]
  s_waitcnt lgkmcnt(0)
  s_waitcnt vmcnt(0)
  s_barrier
  ds_read_b128 v[16:19], v1 offset:0
  ds_read_b128 v[20:23], v1 offset:2048
  ds_read_b128 v[24:27], v1 offset:4096
  ds_read_b128 v[28:31], v1 offset:6144
  ds_read_b64_tr_b16 v[48:49], v3 offset:0
  ds_read_b64_tr_b16 v[50:51], v3 offset:2304
  ds_read_b64_tr_b16 v[52:53], v3 offset:32
  ds_read_b64_tr_b16 v[54:55], v3 offset:2336
  ds_read_b64_tr_b16 v[56:57], v3 offset:64
  ds_read_b64_tr_b16 v[58:59], v3 offset:2368
  s_add_u32 s64, s62, 5
  s_cmp_ge_u32 s64, 9
  s_cselect_b32 s65, 9, 0
  s_sub_u32 s64, s64, s65
  s_lshl_b32 s65, s64, 7
  s_mul_i32 s64, s64, 589824
  s_add_u32 m0, s33, 102400
  s_mov_b32 s34, s64
  buffer_load_dwordx4 v6, s[20:23], s34 offen lds
  v_mfma_f32_16x16x32_bf16 v[120:123], v[60:63], v[32:35], v[120:123]
  v_mfma_f32_16x16x32_bf16 v[124:127], v[60:63], v[36:39], v[124:127]
  v_mfma_f32_16x16x32_bf16 v[128:131], v[60:63], v[40:43], v[128:131]
  v_mfma_f32_16x16x32_bf16 v[132:135], v[60:63], v[44:47], v[132:135]
  ds_read_b64_tr_b16 v[60:61], v3 offset:18432
  ds_read_b64_tr_b16 v[62:63], v3 offset:20736
  s_add_u32 m0, s33, 103424
  s_mov_b32 s34, s64
  buffer_load_dwordx4 v7, s[20:23], s34 offen lds
  v_mfma_f32_16x16x32_bf16 v[136:139], v[64:67], v[32:35], v[136:139]
  v_mfma_f32_16x16x32_bf16 v[140:143], v[64:67], v[36:39], v[140:143]
  v_mfma_f32_16x16x32_bf16 v[144:147], v[64:67], v[40:43], v[144:147]
  v_mfma_f32_16x16x32_bf16 v[148:151], v[64:67], v[44:47], v[148:151]
  ds_read_b64_tr_b16 v[64:65], v3 offset:18464
  ds_read_b64_tr_b16 v[66:67], v3 offset:20768
  s_add_u32 m0, s33, 104448
  s_mov_b32 s34, s64
  buffer_load_dwordx4 v8, s[20:23], s34 offen lds
  v_mfma_f32_16x16x32_bf16 v[152:155], v[68:71], v[32:35], v[152:155]
  v_mfma_f32_16x16x32_bf16 v[156:159], v[68:71], v[36:39], v[156:159]
  v_mfma_f32_16x16x32_bf16 v[160:163], v[68:71], v[40:43], v[160:163]
  v_mfma_f32_16x16x32_bf16 v[164:167], v[68:71], v[44:47], v[164:167]
  ds_read_b64_tr_b16 v[68:69], v3 offset:18496
  ds_read_b64_tr_b16 v[70:71], v3 offset:20800
  s_add_u32 m0, s32, 32768
  s_add_u32 s34, s65, 0
  buffer_load_dwordx4 v5, s[16:19], s34 offen lds
  ds_read_b128 v[32:35], v2 offset:0
  ds_read_b128 v[36:39], v2 offset:2048
  ds_read_b128 v[40:43], v2 offset:4096
  ds_read_b128 v[44:47], v2 offset:6144
  s_waitcnt lgkmcnt(14)
  v_mfma_f32_16x16x32_bf16 v[72:75], v[48:51], v[16:19], v[72:75]
  v_mfma_f32_16x16x32_bf16 v[76:79], v[48:51], v[20:23], v[76:79]
  v_mfma_f32_16x16x32_bf16 v[80:83], v[48:51], v[24:27], v[80:83]
  v_mfma_f32_16x16x32_bf16 v[84:87], v[48:51], v[28:31], v[84:87]
  ds_read_b64_tr_b16 v[48:49], v3 offset:9216
  ds_read_b64_tr_b16 v[50:51], v3 offset:11520
  s_add_u32 m0, s32, 45056
  s_add_u32 s34, s65, 110592
  buffer_load_dwordx4 v5, s[16:19], s34 offen lds
  s_waitcnt lgkmcnt(14)
  v_mfma_f32_16x16x32_bf16 v[88:91], v[52:55], v[16:19], v[88:91]
  v_mfma_f32_16x16x32_bf16 v[92:95], v[52:55], v[20:23], v[92:95]
  v_mfma_f32_16x16x32_bf16 v[96:99], v[52:55], v[24:27], v[96:99]
  v_mfma_f32_16x16x32_bf16 v[100:103], v[52:55], v[28:31], v[100:103]
  ds_read_b64_tr_b16 v[52:53], v3 offset:9248
  ds_read_b64_tr_b16 v[54:55], v3 offset:11552
  s_cmp_ge_u32 s3, 8
  s_cbranch_scc1 k3_sk6
  s_add_u32 m0, s32, 57344
  s_add_u32 s34, s65, 221184
  buffer_load_dwordx4 v5, s[16:19], s34 offen lds
k3_sk6:
  s_waitcnt lgkmcnt(14)
  v_mfma_f32_16x16x32_bf16 v[104:107], v[56:59], v[16:19], v[104:107]
  v_mfma_f32_16x16x32_bf16 v[108:111], v[56:59], v[20:23], v[108:111]
  v_mfma_f32_16x16x32_bf16 v[112:115], v[56:59], v[24:27], v[112:115]
  v_mfma_f32_16x16x32_bf16 v[116:119], v[56:59], v[28:31], v[116:119]
  ds_read_b64_tr_b16 v[56:57], v3 offset:9280
  ds_read_b64_tr_b16 v[58:59], v3 offset:11584
  s_waitcnt lgkmcnt(14)
  v_mfma_f32_16x16x32_bf16 v[120:123], v[60:63], v[16:19], v[120:123]
  v_mfma_f32_16x16x32_bf16 v[124:127], v[60:63], v[20:23], v[124:127]
  v_mfma_f32_16x16x32_bf16 v[128:131], v[60:63], v[24:27], v[128:131]
  v_mfma_f32_16x16x32_bf16 v[132:135], v[60:63], v[28:31], v[132:135]
  ds_read_b64_tr_b16 v[60:61], v3 offset:27648
  ds_read_b64_tr_b16 v[62:63], v3 offset:29952
  s_waitcnt lgkmcnt(14)
  v_mfma_f32_16x16x32_bf16 v[136:139], v[64:67], v[16:19], v[136:139]
  v_mfma_f32_16x16x32_bf16 v[140:143], v[64:67], v[20:23], v[140:143]
  v_mfma_f32_16x16x32_bf16 v[144:147], v[64:67], v[24:27], v[144:147]
  v_mfma_f32_16x16x32_bf16 v[148:151], v[64:67], v[28:31], v[148:151]
  ds_read_b64_tr_b16 v[64:65], v3 offset:27680
  ds_read_b64_tr_b16 v[66:67], v3 offset:29984
  s_waitcnt lgkmcnt(14)
  v_mfma_f32_16x16x32_bf16 v[152:155], v[68:71], v[16:19], v[152:155]
  v_mfma_f32_16x16x32_bf16 v[156:159], v[68:71], v[20:23], v[156:159]
  v_mfma_f32_16x16x32_bf16 v[160:163], v[68:71], v[24:27], v[160:163]
  v_mfma_f32_16x16x32_bf16 v[164:167], v[68:71], v[28:31], v[164:167]
  ds_read_b64_tr_b16 v[68:69], v3 offset:27712
  ds_read_b64_tr_b16 v[70:71], v3 offset:30016
  s_mov_b32 m0, 151552
  s_add_u32 s53, s52, 1024
  buffer_load_dwordx4 v9, s[48:51], s53 offen lds
  s_waitcnt lgkmcnt(10)
  v_mfma_f32_16x16x32_bf16 v[72:75], v[48:51], v[32:35], v[72:75]
  v_mfma_f32_16x16x32_bf16 v[76:79], v[48:51], v[36:39], v[76:79]
  v_mfma_f32_16x16x32_bf16 v[80:83], v[48:51], v[40:43], v[80:83]
  v_mfma_f32_16x16x32_bf16 v[84:87], v[48:51], v[44:47], v[84:87]
  s_waitcnt lgkmcnt(8)
  v_mfma_f32_16x16x32_bf16 v[88:91], v[52:55], v[32:35], v[88:91]
  v_mfma_f32_16x16x32_bf16 v[92:95], v[52:55], v[36:39], v[92:95]
  v_mfma_f32_16x16x32_bf16 v[96:99], v[52:55], v[40:43], v[96:99]
  v_mfma_f32_16x16x32_bf16 v[100:103], v[52:55], v[44:47], v[100:103]
  s_waitcnt lgkmcnt(6)
  v_mfma_f32_16x16x32_bf16 v[104:107], v[56:59], v[32:35], v[104:107]
  v_mfma_f32_16x16x32_bf16 v[108:111], v[56:59], v[36:39], v[108:111]
  v_mfma_f32_16x16x32_bf16 v[112:115], v[56:59], v[40:43], v[112:115]
  v_mfma_f32_16x16x32_bf16 v[116:119], v[56:59], v[44:47], v[116:119]
  s_waitcnt lgkmcnt(0)
  s_waitcnt vmcnt(0)
  s_barrier
  ds_read_b128 v[16:19], v1 offset:32768
  ds_read_b128 v[20:23], v1 offset:34816
  ds_read_b128 v[24:27], v1 offset:36864
  ds_read_b128 v[28:31], v1 offset:38912
  ds_read_b64_tr_b16 v[48:49], v4 offset:0
  ds_read_b64_tr_b16 v[50:51], v4 offset:2304
  ds_read_b64_tr_b16 v[52:53], v4 offset:32
  ds_read_b64_tr_b16 v[54:55], v4 offset:2336
  ds_read_b64_tr_b16 v[56:57], v4 offset:64
  ds_read_b64_tr_b16 v[58:59], v4 offset:2368
  s_add_u32 s64, s62, 6
  s_cmp_ge_u32 s64, 9
  s_cselect_b32 s65, 9, 0
  s_sub_u32 s64, s64, s65
  s_lshl_b32 s65, s64, 7
  s_mul_i32 s64, s64, 589824
  s_add_u32 m0, s33, 65536
  s_mov_b32 s34, s64
  buffer_load_dwordx4 v6, s[20:23], s34 offen lds
  v_mfma_f32_16x16x32_bf16 v[120:123], v[60:63], v[32:35], v[120:123]
  v_mfma_f32_16x16x32_bf16 v[124:127], v[60:63], v[36:39], v[124:127]
  v_mfma_f32_16x16x32_bf16 v[128:131], v[60:63], v[40:43], v[128:131]
  v_mfma_f32_16x16x32_bf16 v[132:135], v[60:63], v[44:47], v[132:135]
  ds_read_b64_tr_b16 v[60:61], v4 offset:18432
  ds_read_b64_tr_b16 v[62:63], v4 offset:20736
  s_add_u32 m0, s33, 66560
  s_mov_b32 s34, s64
  buffer_load_dwordx4 v7, s[20:23], s34 offen lds
  v_mfma_f32_16x16x32_bf16 v[136:139], v[64:67], v[32:35], v[136:139]
  v_mfma_f32_16x16x32_bf16 v[140:143], v[64:67], v[36:39], v[140:143]
  v_mfma_f32_16x16x32_bf16 v[144:147], v[64:67], v[40:43], v[144:147]
  v_mfma_f32_16x16x32_bf16 v[148:151], v[64:67], v[44:47], v[148:151]
  ds_read_b64_tr_b16 v[64:65], v4 offset:18464
  ds_read_b64_tr_b16 v[66:67], v4 offset:20768
  s_add_u32 m0, s33, 67584
  s_mov_b32 s34, s64
  buffer_load_dwordx4 v8, s[20:23], s34 offen lds
  v_mfma_f32_16x16x32_bf16 v[152:155], v[68:71], v[32:35], v[152:155]
  v_mfma_f32_16x16x32_bf16 v[156:159], v[68:71], v[36:39], v[156:159]
  v_mfma_f32_16x16x32_bf16 v[160:163], v[68:71], v[40:43], v[160:163]
  v_mfma_f32_16x16x32_bf16 v[164:167], v[68:71], v[44:47], v[164:167]
  ds_read_b64_tr_b16 v[68:69], v4 offset:18496
  ds_read_b64_tr_b16 v[70:71], v4 offset:20800
  s_add_u32 m0, s32, 0
  s_add_u32 s34, s65, 0
  buffer_load_dwordx4 v5, s[16:19], s34 offen lds
  ds_read_b128 v[32:35], v2 offset:32768
  ds_read_b128 v[36:39], v2 offset:34816
  ds_read_b128 v[40:43], v2 offset:36864
  ds_read_b128 v[44:47], v2 offset:38912
  s_waitcnt lgkmcnt(14)
  v_mfma_f32_16x16x32_bf16 v[72:75], v[48:51], v[16:19], v[72:75]
  v_mfma_f32_16x16x32_bf16 v[76:79], v[48:51], v[20:23], v[76:79]
  v_mfma_f32_16x16x32_bf16 v[80:83], v[48:51], v[24:27], v[80:83]
  v_mfma_f32_16x16x32_bf16 v[84:87], v[48:51], v[28:31], v[84:87]
  ds_read_b64_tr_b16 v[48:49], v4 offset:9216
  ds_read_b64_tr_b16 v[50:51], v4 offset:11520
  s_add_u32 m0, s32, 12288
  s_add_u32 s34, s65, 110592
  buffer_load_dwordx4 v5, s[16:19], s34 offen lds
  s_waitcnt lgkmcnt(14)
  v_mfma_f32_16x16x32_bf16 v[88:91], v[52:55], v[16:19], v[88:91]
  v_mfma_f32_16x16x32_bf16 v[92:95], v[52:55], v[20:23], v[92:95]
  v_mfma_f32_16x16x32_bf16 v[96:99], v[52:55], v[24:27], v[96:99]
  v_mfma_f32_16x16x32_bf16 v[100:103], v[52:55], v[28:31], v[100:103]
  ds_read_b64_tr_b16 v[52:53], v4 offset:9248
  ds_read_b64_tr_b16 v[54:55], v4 offset:11552
  s_cmp_ge_u32 s3, 8
  s_cbranch_scc1 k3_sk7
  s_add_u32 m0, s32, 24576
  s_add_u32 s34, s65, 221184
  buffer_load_dwordx4 v5, s[16:19], s34 offen lds
k3_sk7:
  s_waitcnt lgkmcnt(14)
  v_mfma_f32_16x16x32_bf16 v[104:107], v[56:59], v[16:19], v[104:107]
  v_mfma_f32_16x16x32_bf16 v[108:111], v[56:59], v[20:23], v[108:111]
  v_mfma_f32_16x16x32_bf16 v[112:115], v[56:59], v[24:27], v[112:115]
  v_mfma_f32_16x16x32_bf16 v[116:119], v[56:59], v[28:31], v[116:119]
  ds_read_b64_tr_b16 v[56:57], v4 offset:9280
  ds_read_b64_tr_b16 v[58:59], v4 offset:11584
  s_waitcnt lgkmcnt(14)
  v_mfma_f32_16x16x32_bf16 v[120:123], v[60:63], v[16:19], v[120:123]
  v_mfma_f32_16x16x32_bf16 v[124:127], v[60:63], v[20:23], v[124:127]
  v_mfma_f32_16x16x32_bf16 v[128:131], v[60:63], v[24:27], v[128:131]
  v_mfma_f32_16x16x32_bf16 v[132:135], v[60:63], v[28:31], v[132:135]
  ds_read_b64_tr_b16 v[60:61], v4 offset:27648
  ds_read_b64_tr_b16 v[62:63], v4 offset:29952
  s_waitcnt lgkmcnt(14)
  v_mfma_f32_16x16x32_bf16 v[136:139], v[64:67], v[16:19], v[136:139]
  v_mfma_f32_16x16x32_bf16 v[140:143], v[64:67], v[20:23], v[140:143]
  v_mfma_f32_16x16x32_bf16 v[144:147], v[64:67], v[24:27], v[144:147]
  v_mfma_f32_16x16x32_bf16 v[148:151], v[64:67], v[28:31], v[148:151]
  ds_read_b64_tr_b16 v[64:65], v4 offset:27680
  ds_read_b64_tr_b16 v[66:67], v4 offset:29984
  s_waitcnt lgkmcnt(14)
  v_mfma_f32_16x16x32_bf16 v[152:155], v[68:71], v[16:19], v[152:155]
  v_mfma_f32_16x16x32_bf16 v[156:159], v[68:71], v[20:23], v[156:159]
  v_mfma_f32_16x16x32_bf16 v[160:163], v[68:71], v[24:27], v[160:163]
  v_mfma_f32_16x16x32_bf16 v[164:167], v[68:71], v[28:31], v[164:167]
  ds_read_b64_tr_b16 v[68:69], v4 offset:27712
  ds_read_b64_tr_b16 v[70:71], v4 offset:30016
  buffer_store_dwordx4 v[12:15], v9, s[56:59], s60 offen offset:2048 sc1
  s_waitcnt lgkmcnt(10)
  v_mfma_f32_16x16x32_bf16 v[72:75], v[48:51], v[32:35], v[72:75]
  v_mfma_f32_16x16x32_bf16 v[76:79], v[48:51], v[36:39], v[76:79]
  v_mfma_f32_16x16x32_bf16 v[80:83], v[48:51], v[40:43], v[80:83]
  v_mfma_f32_16x16x32_bf16 v[84:87], v[48:51], v[44:47], v[84:87]
  s_waitcnt lgkmcnt(8)
  v_mfma_f32_16x16x32_bf16 v[88:91], v[52:55], v[32:35], v[88:91]
  v_mfma_f32_16x16x32_bf16 v[92:95], v[52:55], v[36:39], v[92:95]
  v_mfma_f32_16x16x32_bf16 v[96:99], v[52:55], v[40:43], v[96:99]
  v_mfma_f32_16x16x32_bf16 v[100:103], v[52:55], v[44:47], v[100:103]
  s_waitcnt lgkmcnt(6)
  v_mfma_f32_16x16x32_bf16 v[104:107], v[56:59], v[32:35], v[104:107]
  v_mfma_f32_16x16x32_bf16 v[108:111], v[56:59], v[36:39], v[108:111]
  v_mfma_f32_16x16x32_bf16 v[112:115], v[56:59], v[40:43], v[112:115]
  v_mfma_f32_16x16x32_bf16 v[116:119], v[56:59], v[44:47], v[116:119]
  s_waitcnt lgkmcnt(0)
  s_waitcnt vmcnt(0)
  s_barrier
  ds_read_b128 v[16:19], v1 offset:0
  ds_read_b128 v[20:23], v1 offset:2048
  ds_read_b128 v[24:27], v1 offset:4096
  ds_read_b128 v[28:31], v1 offset:6144
  ds_read_b64_tr_b16 v[48:49], v3 offset:0
  ds_read_b64_tr_b16 v[50:51], v3 offset:2304
  ds_read_b64_tr_b16 v[52:53], v3 offset:32
  ds_read_b64_tr_b16 v[54:55], v3 offset:2336
  ds_read_b64_tr_b16 v[56:57], v3 offset:64
  ds_read_b64_tr_b16 v[58:59], v3 offset:2368
  s_add_u32 s64, s62, 7
  s_cmp_ge_u32 s64, 9
  s_cselect_b32 s65, 9, 0
  s_sub_u32 s64, s64, s65
  s_lshl_b32 s65, s64, 7
  s_mul_i32 s64, s64, 589824
  s_add_u32 m0, s33, 102400
  s_mov_b32 s34, s64
  buffer_load_dwordx4 v6, s[20:23], s34 offen lds
  v_mfma_f32_16x16x32_bf16 v[120:123], v[60:63], v[32:35], v[120:123]
  v_mfma_f32_16x16x32_bf16 v[124:127], v[60:63], v[36:39], v[124:127]
  v_mfma_f32_16x16x32_bf16 v[128:131], v[60:63], v[40:43], v[128:131]
  v_mfma_f32_16x16x32_bf16 v[132:135], v[60:63], v[44:47], v[132:135]
  ds_read_b64_tr_b16 v[60:61], v3 offset:18432
  ds_read_b64_tr_b16 v[62:63], v3 offset:20736
  s_add_u32 m0, s33, 103424
  s_mov_b32 s34, s64
  buffer_load_dwordx4 v7, s[20:23], s34 offen lds
  v_mfma_f32_16x16x32_bf16 v[136:139], v[64:67], v[32:35], v[136:139]
  v_mfma_f32_16x16x32_bf16 v[140:143], v[64:67], v[36:39], v[140:143]
  v_mfma_f32_16x16x32_bf16 v[144:147], v[64:67], v[40:43], v[144:147]
  v_mfma_f32_16x16x32_bf16 v[148:151], v[64:67], v[44:47], v[148:151]
  ds_read_b64_tr_b16 v[64:65], v3 offset:18464
  ds_read_b64_tr_b16 v[66:67], v3 offset:20768
  s_add_u32 m0, s33, 104448
  s_mov_b32 s34, s64
  buffer_load_dwordx4 v8, s[20:23], s34 offen lds
  v_mfma_f32_16x16x32_bf16 v[152:155], v[68:71], v[32:35], v[152:155]
  v_mfma_f32_16x16x32_bf16 v[156:159], v[68:71], v[36:39], v[156:159]
  v_mfma_f32_16x16x32_bf16 v[160:163], v[68:71], v[40:43], v[160:163]
  v_mfma_f32_16x16x32_bf16 v[164:167], v[68:71], v[44:47], v[164:167]
  ds_read_b64_tr_b16 v[68:69], v3 offset:18496
  ds_read_b64_tr_b16 v[70:71], v3 offset:20800
  s_add_u32 m0, s32, 32768
  s_add_u32 s34, s65, 0
  buffer_load_dwordx4 v5, s[16:19], s34 offen lds
  ds_read_b128 v[32:35], v2 offset:0
  ds_read_b128 v[36:39], v2 offset:2048
  ds_read_b128 v[40:43], v2 offset:4096
  ds_read_b128 v[44:47], v2 offset:6144
  s_waitcnt lgkmcnt(14)
  v_mfma_f32_16x16x32_bf16 v[72:75], v[48:51], v[16:19], v[72:75]
  v_mfma_f32_16x16x32_bf16 v[76:79], v[48:51], v[20:23], v[76:79]
  v_mfma_f32_16x16x32_bf16 v[80:83], v[48:51], v[24:27], v[80:83]
  v_mfma_f32_16x16x32_bf16 v[84:87], v[48:51], v[28:31], v[84:87]
  ds_read_b64_tr_b16 v[48:49], v3 offset:9216
  ds_read_b64_tr_b16 v[50:51], v3 offset:11520
  s_add_u32 m0, s32, 45056
  s_add_u32 s34, s65, 110592
  buffer_load_dwordx4 v5, s[16:19], s34 offen lds
  s_waitcnt lgkmcnt(14)
  v_mfma_f32_16x16x32_bf16 v[88:91], v[52:55], v[16:19], v[88:91]
  v_mfma_f32_16x16x32_bf16 v[92:95], v[52:55], v[20:23], v[92:95]
  v_mfma_f32_16x16x32_bf16 v[96:99], v[52:55], v[24:27], v[96:99]
  v_mfma_f32_16x16x32_bf16 v[100:103], v[52:55], v[28:31], v[100:103]
  ds_read_b64_tr_b16 v[52:53], v3 offset:9248
  ds_read_b64_tr_b16 v[54:55], v3 offset:11552
  s_cmp_ge_u32 s3, 8
  s_cbranch_scc1 k3_sk8
  s_add_u32 m0, s32, 57344
  s_add_u32 s34, s65, 221184
  buffer_load_dwordx4 v5, s[16:19], s34 offen lds
k3_sk8:
  s_waitcnt lgkmcnt(14)
  v_mfma_f32_16x16x32_bf16 v[104:107], v[56:59], v[16:19], v[104:107]
  v_mfma_f32_16x16x32_bf16 v[108:111], v[56:59], v[20:23], v[108:111]
  v_mfma_f32_16x16x32_bf16 v[112:115], v[56:59], v[24:27], v[112:115]
  v_mfma_f32_16x16x32_bf16 v[116:119], v[56:59], v[28:31], v[116:119]
  ds_read_b64_tr_b16 v[56:57], v3 offset:9280
  ds_read_b64_tr_b16 v[58:59], v3 offset:11584
  s_waitcnt lgkmcnt(14)
  v_mfma_f32_16x16x32_bf16 v[120:123], v[60:63], v[16:19], v[120:123]
  v_mfma_f32_16x16x32_bf16 v[124:127], v[60:63], v[20:23], v[124:127]
  v_mfma_f32_16x16x32_bf16 v[128:131], v[60:63], v[24:27], v[128:131]
  v_mfma_f32_16x16x32_bf16 v[132:135], v[60:63], v[28:31], v[132:135]
  ds_read_b64_tr_b16 v[60:61], v3 offset:27648
  ds_read_b64_tr_b16 v[62:63], v3 offset:29952
  s_waitcnt lgkmcnt(14)
  v_mfma_f32_16x16x32_bf16 v[136:139], v[64:67], v[16:19], v[136:139]
  v_mfma_f32_16x16x32_bf16 v[140:143], v[64:67], v[20:23], v[140:143]
  v_mfma_f32_16x16x32_bf16 v[144:147], v[64:67], v[24:27], v[144:147]
  v_mfma_f32_16x16x32_bf16 v[148:151], v[64:67], v[28:31], v[148:151]
  ds_read_b64_tr_b16 v[64:65], v3 offset:27680
  ds_read_b64_tr_b16 v[66:67], v3 offset:29984
  s_waitcnt lgkmcnt(14)
  v_mfma_f32_16x16x32_bf16 v[152:155], v[68:71], v[16:19], v[152:155]
  v_mfma_f32_16x16x32_bf16 v[156:159], v[68:71], v[20:23], v[156:159]
  v_mfma_f32_16x16x32_bf16 v[160:163], v[68:71], v[24:27], v[160:163]
  v_mfma_f32_16x16x32_bf16 v[164:167], v[68:71], v[28:31], v[164:167]
  ds_read_b64_tr_b16 v[68:69], v3 offset:27712
  ds_read_b64_tr_b16 v[70:71], v3 offset:30016
  s_waitcnt lgkmcnt(10)
  v_mfma_f32_16x16x32_bf16 v[72:75], v[48:51], v[32:35], v[72:75]
  v_mfma_f32_16x16x32_bf16 v[76:79], v[48:51], v[36:39], v[76:79]
  v_mfma_f32_16x16x32_bf16 v[80:83], v[48:51], v[40:43], v[80:83]
  v_mfma_f32_16x16x32_bf16 v[84:87], v[48:51], v[44:47], v[84:87]
  s_waitcnt lgkmcnt(8)
  v_mfma_f32_16x16x32_bf16 v[88:91], v[52:55], v[32:35], v[88:91]
  v_mfma_f32_16x16x32_bf16 v[92:95], v[52:55], v[36:39], v[92:95]
  v_mfma_f32_16x16x32_bf16 v[96:99], v[52:55], v[40:43], v[96:99]
  v_mfma_f32_16x16x32_bf16 v[100:103], v[52:55], v[44:47], v[100:103]
  s_waitcnt lgkmcnt(6)
  v_mfma_f32_16x16x32_bf16 v[104:107], v[56:59], v[32:35], v[104:107]
  v_mfma_f32_16x16x32_bf16 v[108:111], v[56:59], v[36:39], v[108:111]
  v_mfma_f32_16x16x32_bf16 v[112:115], v[56:59], v[40:43], v[112:115]
  v_mfma_f32_16x16x32_bf16 v[116:119], v[56:59], v[44:47], v[116:119]
  s_waitcnt lgkmcnt(0)
  s_waitcnt vmcnt(0)
  s_barrier
  ds_read_b128 v[16:19], v1 offset:32768
  ds_read_b128 v[20:23], v1 offset:34816
  ds_read_b128 v[24:27], v1 offset:36864
  ds_read_b128 v[28:31], v1 offset:38912
  ds_read_b64_tr_b16 v[48:49], v4 offset:0
  ds_read_b64_tr_b16 v[50:51], v4 offset:2304
  ds_read_b64_tr_b16 v[52:53], v4 offset:32
  ds_read_b64_tr_b16 v[54:55], v4 offset:2336
  ds_read_b64_tr_b16 v[56:57], v4 offset:64
  ds_read_b64_tr_b16 v[58:59], v4 offset:2368
  s_add_u32 s64, s62, 8
  s_cmp_ge_u32 s64, 9
  s_cselect_b32 s65, 9, 0
  s_sub_u32 s64, s64, s65
  s_lshl_b32 s65, s64, 7
  s_mul_i32 s64, s64, 589824
  s_add_u32 m0, s33, 65536
  s_mov_b32 s34, s64
  buffer_load_dwordx4 v6, s[20:23], s34 offen lds
  v_mfma_f32_16x16x32_bf16 v[120:123], v[60:63], v[32:35], v[120:123]
  v_mfma_f32_16x16x32_bf16 v[124:127], v[60:63], v[36:39], v[124:127]
  v_mfma_f32_16x16x32_bf16 v[128:131], v[60:63], v[40:43], v[128:131]
  v_mfma_f32_16x16x32_bf16 v[132:135], v[60:63], v[44:47], v[132:135]
  ds_read_b64_tr_b16 v[60:61], v4 offset:18432
  ds_read_b64_tr_b16 v[62:63], v4 offset:20736
  s_add_u32 m0, s33, 66560
  s_mov_b32 s34, s64
  buffer_load_dwordx4 v7, s[20:23], s34 offen lds
  v_mfma_f32_16x16x32_bf16 v[136:139], v[64:67], v[32:35], v[136:139]
  v_mfma_f32_16x16x32_bf16 v[140:143], v[64:67], v[36:39], v[140:143]
  v_mfma_f32_16x16x32_bf16 v[144:147], v[64:67], v[40:43], v[144:147]
  v_mfma_f32_16x16x32_bf16 v[148:151], v[64:67], v[44:47], v[148:151]
  ds_read_b64_tr_b16 v[64:65], v4 offset:18464
  ds_read_b64_tr_b16 v[66:67], v4 offset:20768
  s_add_u32 m0, s33, 67584
  s_mov_b32 s34, s64
  buffer_load_dwordx4 v8, s[20:23], s34 offen lds
  v_mfma_f32_16x16x32_bf16 v[152:155], v[68:71], v[32:35], v[152:155]
  v_mfma_f32_16x16x32_bf16 v[156:159], v[68:71], v[36:39], v[156:159]
  v_mfma_f32_16x16x32_bf16 v[160:163], v[68:71], v[40:43], v[160:163]
  v_mfma_f32_16x16x32_bf16 v[164:167], v[68:71], v[44:47], v[164:167]
  ds_read_b64_tr_b16 v[68:69], v4 offset:18496
  ds_read_b64_tr_b16 v[70:71], v4 offset:20800
  s_add_u32 m0, s32, 0
  s_add_u32 s34, s65, 0
  buffer_load_dwordx4 v5, s[16:19], s34 offen lds
  ds_read_b128 v[32:35], v2 offset:32768
  ds_read_b128 v[36:39], v2 offset:34816
  ds_read_b128 v[40:43], v2 offset:36864
  ds_read_b128 v[44:47], v2 offset:38912
  s_waitcnt lgkmcnt(14)
  v_mfma_f32_16x16x32_bf16 v[72:75], v[48:51], v[16:19], v[72:75]
  v_mfma_f32_16x16x32_bf16 v[76:79], v[48:51], v[20:23], v[76:79]
  v_mfma_f32_16x16x32_bf16 v[80:83], v[48:51], v[24:27], v[80:83]
  v_mfma_f32_16x16x32_bf16 v[84:87], v[48:51], v[28:31], v[84:87]
  ds_read_b64_tr_b16 v[48:49], v4 offset:9216
  ds_read_b64_tr_b16 v[50:51], v4 offset:11520
  s_add_u32 m0, s32, 12288
  s_add_u32 s34, s65, 110592
  buffer_load_dwordx4 v5, s[16:19], s34 offen lds
  s_waitcnt lgkmcnt(14)
  v_mfma_f32_16x16x32_bf16 v[88:91], v[52:55], v[16:19], v[88:91]
  v_mfma_f32_16x16x32_bf16 v[92:95], v[52:55], v[20:23], v[92:95]
  v_mfma_f32_16x16x32_bf16 v[96:99], v[52:55], v[24:27], v[96:99]
  v_mfma_f32_16x16x32_bf16 v[100:103], v[52:55], v[28:31], v[100:103]
  ds_read_b64_tr_b16 v[52:53], v4 offset:9248
  ds_read_b64_tr_b16 v[54:55], v4 offset:11552
  s_cmp_ge_u32 s3, 8
  s_cbranch_scc1 k3_sk9
  s_add_u32 m0, s32, 24576
  s_add_u32 s34, s65, 221184
  buffer_load_dwordx4 v5, s[16:19], s34 offen lds
k3_sk9:
  s_waitcnt lgkmcnt(14)
  v_mfma_f32_16x16x32_bf16 v[104:107], v[56:59], v[16:19], v[104:107]
  v_mfma_f32_16x16x32_bf16 v[108:111], v[56:59], v[20:23], v[108:111]
  v_mfma_f32_16x16x32_bf16 v[112:115], v[56:59], v[24:27], v[112:115]
  v_mfma_f32_16x16x32_bf16 v[116:119], v[56:59], v[28:31], v[116:119]
  ds_read_b64_tr_b16 v[56:57], v4 offset:9280
  ds_read_b64_tr_b16 v[58:59], v4 offset:11584
  s_waitcnt lgkmcnt(14)
  v_mfma_f32_16x16x32_bf16 v[120:123], v[60:63], v[16:19], v[120:123]
  v_mfma_f32_16x16x32_bf16 v[124:127], v[60:63], v[20:23], v[124:127]
  v_mfma_f32_16x16x32_bf16 v[128:131], v[60:63], v[24:27], v[128:131]
  v_mfma_f32_16x16x32_bf16 v[132:135], v[60:63], v[28:31], v[132:135]
  ds_read_b64_tr_b16 v[60:61], v4 offset:27648
  ds_read_b64_tr_b16 v[62:63], v4 offset:29952
  s_waitcnt lgkmcnt(14)
  v_mfma_f32_16x16x32_bf16 v[136:139], v[64:67], v[16:19], v[136:139]
  v_mfma_f32_16x16x32_bf16 v[140:143], v[64:67], v[20:23], v[140:143]
  v_mfma_f32_16x16x32_bf16 v[144:147], v[64:67], v[24:27], v[144:147]
  v_mfma_f32_16x16x32_bf16 v[148:151], v[64:67], v[28:31], v[148:151]
  ds_read_b64_tr_b16 v[64:65], v4 offset:27680
  ds_read_b64_tr_b16 v[66:67], v4 offset:29984
  s_waitcnt lgkmcnt(14)
  v_mfma_f32_16x16x32_bf16 v[152:155], v[68:71], v[16:19], v[152:155]
  v_mfma_f32_16x16x32_bf16 v[156:159], v[68:71], v[20:23], v[156:159]
  v_mfma_f32_16x16x32_bf16 v[160:163], v[68:71], v[24:27], v[160:163]
  v_mfma_f32_16x16x32_bf16 v[164:167], v[68:71], v[28:31], v[164:167]
  ds_read_b64_tr_b16 v[68:69], v4 offset:27712
  ds_read_b64_tr_b16 v[70:71], v4 offset:30016
  s_waitcnt lgkmcnt(10)
  v_mfma_f32_16x16x32_bf16 v[72:75], v[48:51], v[32:35], v[72:75]
  v_mfma_f32_16x16x32_bf16 v[76:79], v[48:51], v[36:39], v[76:79]
  v_mfma_f32_16x16x32_bf16 v[80:83], v[48:51], v[40:43], v[80:83]
  v_mfma_f32_16x16x32_bf16 v[84:87], v[48:51], v[44:47], v[84:87]
  s_waitcnt lgkmcnt(8)
  v_mfma_f32_16x16x32_bf16 v[88:91], v[52:55], v[32:35], v[88:91]
  v_mfma_f32_16x16x32_bf16 v[92:95], v[52:55], v[36:39], v[92:95]
  v_mfma_f32_16x16x32_bf16 v[96:99], v[52:55], v[40:43], v[96:99]
  v_mfma_f32_16x16x32_bf16 v[100:103], v[52:55], v[44:47], v[100:103]
  s_waitcnt lgkmcnt(6)
  v_mfma_f32_16x16x32_bf16 v[104:107], v[56:59], v[32:35], v[104:107]
  v_mfma_f32_16x16x32_bf16 v[108:111], v[56:59], v[36:39], v[108:111]
  v_mfma_f32_16x16x32_bf16 v[112:115], v[56:59], v[40:43], v[112:115]
  v_mfma_f32_16x16x32_bf16 v[116:119], v[56:59], v[44:47], v[116:119]
  s_waitcnt lgkmcnt(0)
  s_waitcnt vmcnt(0)
  s_barrier
  ds_read_b128 v[16:19], v1 offset:0
  ds_read_b128 v[20:23], v1 offset:2048
  ds_read_b128 v[24:27], v1 offset:4096
  ds_read_b128 v[28:31], v1 offset:6144
  ds_read_b64_tr_b16 v[48:49], v3 offset:0
  ds_read_b64_tr_b16 v[50:51], v3 offset:2304
  ds_read_b64_tr_b16 v[52:53], v3 offset:32
  ds_read_b64_tr_b16 v[54:55], v3 offset:2336
  ds_read_b64_tr_b16 v[56:57], v3 offset:64
  ds_read_b64_tr_b16 v[58:59], v3 offset:2368
  v_mfma_f32_16x16x32_bf16 v[120:123], v[60:63], v[32:35], v[120:123]
  v_mfma_f32_16x16x32_bf16 v[124:127], v[60:63], v[36:39], v[124:127]
  v_mfma_f32_16x16x32_bf16 v[128:131], v[60:63], v[40:43], v[128:131]
  v_mfma_f32_16x16x32_bf16 v[132:135], v[60:63], v[44:47], v[132:135]
  ds_read_b64_tr_b16 v[60:61], v3 offset:18432
  ds_read_b64_tr_b16 v[62:63], v3 offset:20736
  v_mfma_f32_16x16x32_bf16 v[136:139], v[64:67], v[32:35], v[136:139]
  v_mfma_f32_16x16x32_bf16 v[140:143], v[64:67], v[36:39], v[140:143]
  v_mfma_f32_16x16x32_bf16 v[144:147], v[64:67], v[40:43], v[144:147]
  v_mfma_f32_16x16x32_bf16 v[148:151], v[64:67], v[44:47], v[148:151]
  ds_read_b64_tr_b16 v[64:65], v3 offset:18464
  ds_read_b64_tr_b16 v[66:67], v3 offset:20768
  v_mfma_f32_16x16x32_bf16 v[152:155], v[68:71], v[32:35], v[152:155]
  v_mfma_f32_16x16x32_bf16 v[156:159], v[68:71], v[36:39], v[156:159]
  v_mfma_f32_16x16x32_bf16 v[160:163], v[68:71], v[40:43], v[160:163]
  v_mfma_f32_16x16x32_bf16 v[164:167], v[68:71], v[44:47], v[164:167]
  ds_read_b64_tr_b16 v[68:69], v3 offset:18496
  ds_read_b64_tr_b16 v[70:71], v3 offset:20800
  ds_read_b128 v[32:35], v2 offset:0
  ds_read_b128 v[36:39], v2 offset:2048
  ds_read_b128 v[40:43], v2 offset:4096
  ds_read_b128 v[44:47], v2 offset:6144
  s_waitcnt lgkmcnt(14)
  v_mfma_f32_16x16x32_bf16 v[72:75], v[48:51], v[16:19], v[72:75]
  v_mfma_f32_16x16x32_bf16 v[76:79], v[48:51], v[20:23], v[76:79]
  v_mfma_f32_16x16x32_bf16 v[80:83], v[48:51], v[24:27], v[80:83]
  v_mfma_f32_16x16x32_bf16 v[84:87], v[48:51], v[28:31], v[84:87]
  ds_read_b64_tr_b16 v[48:49], v3 offset:9216
  ds_read_b64_tr_b16 v[50:51], v3 offset:11520
  s_waitcnt lgkmcnt(14)
  v_mfma_f32_16x16x32_bf16 v[88:91], v[52:55], v[16:19], v[88:91]
  v_mfma_f32_16x16x32_bf16 v[92:95], v[52:55], v[20:23], v[92:95]
  v_mfma_f32_16x16x32_bf16 v[96:99], v[52:55], v[24:27], v[96:99]
  v_mfma_f32_16x16x32_bf16 v[100:103], v[52:55], v[28:31], v[100:103]
  ds_read_b64_tr_b16 v[52:53], v3 offset:9248
  ds_read_b64_tr_b16 v[54:55], v3 offset:11552
  s_waitcnt lgkmcnt(14)
  v_mfma_f32_16x16x32_bf16 v[104:107], v[56:59], v[16:19], v[104:107]
  v_mfma_f32_16x16x32_bf16 v[108:111], v[56:59], v[20:23], v[108:111]
  v_mfma_f32_16x16x32_bf16 v[112:115], v[56:59], v[24:27], v[112:115]
  v_mfma_f32_16x16x32_bf16 v[116:119], v[56:59], v[28:31], v[116:119]
  ds_read_b64_tr_b16 v[56:57], v3 offset:9280
  ds_read_b64_tr_b16 v[58:59], v3 offset:11584
  s_waitcnt lgkmcnt(14)
  v_mfma_f32_16x16x32_bf16 v[120:123], v[60:63], v[16:19], v[120:123]
  v_mfma_f32_16x16x32_bf16 v[124:127], v[60:63], v[20:23], v[124:127]
  v_mfma_f32_16x16x32_bf16 v[128:131], v[60:63], v[24:27], v[128:131]
  v_mfma_f32_16x16x32_bf16 v[132:135], v[60:63], v[28:31], v[132:135]
  ds_read_b64_tr_b16 v[60:61], v3 offset:27648
  ds_read_b64_tr_b16 v[62:63], v3 offset:29952
  s_waitcnt lgkmcnt(14)
  v_mfma_f32_16x16x32_bf16 v[136:139], v[64:67], v[16:19], v[136:139]
  v_mfma_f32_16x16x32_bf16 v[140:143], v[64:67], v[20:23], v[140:143]
  v_mfma_f32_16x16x32_bf16 v[144:147], v[64:67], v[24:27], v[144:147]
  v_mfma_f32_16x16x32_bf16 v[148:151], v[64:67], v[28:31], v[148:151]
  ds_read_b64_tr_b16 v[64:65], v3 offset:27680
  ds_read_b64_tr_b16 v[66:67], v3 offset:29984
  s_waitcnt lgkmcnt(14)
  v_mfma_f32_16x16x32_bf16 v[152:155], v[68:71], v[16:19], v[152:155]
  v_mfma_f32_16x16x32_bf16 v[156:159], v[68:71], v[20:23], v[156:159]
  v_mfma_f32_16x16x32_bf16 v[160:163], v[68:71], v[24:27], v[160:163]
  v_mfma_f32_16x16x32_bf16 v[164:167], v[68:71], v[28:31], v[164:167]
  ds_read_b64_tr_b16 v[68:69], v3 offset:27712
  ds_read_b64_tr_b16 v[70:71], v3 offset:30016
  s_waitcnt lgkmcnt(10)
  v_mfma_f32_16x16x32_bf16 v[72:75], v[48:51], v[32:35], v[72:75]
  v_mfma_f32_16x16x32_bf16 v[76:79], v[48:51], v[36:39], v[76:79]
  v_mfma_f32_16x16x32_bf16 v[80:83], v[48:51], v[40:43], v[80:83]
  v_mfma_f32_16x16x32_bf16 v[84:87], v[48:51], v[44:47], v[84:87]
  s_waitcnt lgkmcnt(8)
  v_mfma_f32_16x16x32_bf16 v[88:91], v[52:55], v[32:35], v[88:91]
  v_mfma_f32_16x16x32_bf16 v[92:95], v[52:55], v[36:39], v[92:95]
  v_mfma_f32_16x16x32_bf16 v[96:99], v[52:55], v[40:43], v[96:99]
  v_mfma_f32_16x16x32_bf16 v[100:103], v[52:55], v[44:47], v[100:103]
  s_waitcnt lgkmcnt(6)
  v_mfma_f32_16x16x32_bf16 v[104:107], v[56:59], v[32:35], v[104:107]
  v_mfma_f32_16x16x32_bf16 v[108:111], v[56:59], v[36:39], v[108:111]
  v_mfma_f32_16x16x32_bf16 v[112:115], v[56:59], v[40:43], v[112:115]
  v_mfma_f32_16x16x32_bf16 v[116:119], v[56:59], v[44:47], v[116:119]
  s_waitcnt lgkmcnt(4)
  v_mfma_f32_16x16x32_bf16 v[120:123], v[60:63], v[32:35], v[120:123]
  v_mfma_f32_16x16x32_bf16 v[124:127], v[60:63], v[36:39], v[124:127]
  v_mfma_f32_16x16x32_bf16 v[128:131], v[60:63], v[40:43], v[128:131]
  v_mfma_f32_16x16x32_bf16 v[132:135], v[60:63], v[44:47], v[132:135]
  s_waitcnt lgkmcnt(2)
  v_mfma_f32_16x16x32_bf16 v[136:139], v[64:67], v[32:35], v[136:139]
  v_mfma_f32_16x16x32_bf16 v[140:143], v[64:67], v[36:39], v[140:143]
  v_mfma_f32_16x16x32_bf16 v[144:147], v[64:67], v[40:43], v[144:147]
  v_mfma_f32_16x16x32_bf16 v[148:151], v[64:67], v[44:47], v[148:151]
  s_waitcnt lgkmcnt(0)
  v_mfma_f32_16x16x32_bf16 v[152:155], v[68:71], v[32:35], v[152:155]
  v_mfma_f32_16x16x32_bf16 v[156:159], v[68:71], v[36:39], v[156:159]
  v_mfma_f32_16x16x32_bf16 v[160:163], v[68:71], v[40:43], v[160:163]
  v_mfma_f32_16x16x32_bf16 v[164:167], v[68:71], v[44:47], v[164:167]
  s_lshl_b32 s35, s11, 2
  s_add_u32 s35, s35, s12
  s_lshl_b32 s35, s35, 5
  s_add_u32 s35, s35, s10
  s_mul_i32 s35, s35, 3
  s_add_u32 s35, s35, s13
  s_mul_i32 s35, s35, 6144
  v_lshlrev_b32 v18, 4, v0
  s_add_u32 s36, s35, 4096
  v_and_b32 v16, 15, v0
  s_add_u32 s34, s32, 139268
  v_lshl_add_u32 v17, v16, 3, s34
  ds_read_b32 v20, v17 offset:0
  ds_read_b32 v21, v17 offset:128
  ds_read_b32 v22, v17 offset:256
  ds_read_b32 v23, v17 offset:384
  s_waitcnt lgkmcnt(0)
  v_mul_f32 v28, 0xbfb8aa3b, v20
  v_rcp_f32 v24, v20
  v_mul_f32 v29, 0xbfb8aa3b, v21
  v_rcp_f32 v25, v21
  v_mul_f32 v30, 0xbfb8aa3b, v22
  v_rcp_f32 v26, v22
  v_mul_f32 v31, 0xbfb8aa3b, v23
  v_rcp_f32 v27, v23
  v_mul_f32 v72, v28, v72
  v_mul_f32 v73, v28, v73
  v_mul_f32 v74, v28, v74
  v_mul_f32 v75, v28, v75
  v_exp_f32 v72, v72
  v_exp_f32 v73, v73
  v_exp_f32 v74, v74
  v_exp_f32 v75, v75
  s_nop 0
  v_fma_f32 v72, v72, v24, v24
  v_fma_f32 v73, v73, v24, v24
  v_fma_f32 v74, v74, v24, v24
  v_fma_f32 v75, v75, v24, v24
  v_rcp_f32 v72, v72
  v_rcp_f32 v73, v73
  v_rcp_f32 v74, v74
  v_rcp_f32 v75, v75
  s_nop 0
  v_mul_f32 v120, v72, v120
  v_mul_f32 v121, v73, v121
  v_mul_f32 v122, v74, v122
  v_mul_f32 v123, v75, v123
  v_cvt_pk_bf16_f32 v32, v120, v121
  v_cvt_pk_bf16_f32 v33, v122, v123
  v_mul_f32 v88, v28, v88
  v_mul_f32 v89, v28, v89
  v_mul_f32 v90, v28, v90
  v_mul_f32 v91, v28, v91
  v_exp_f32 v88, v88
  v_exp_f32 v89, v89
  v_exp_f32 v90, v90
  v_exp_f32 v91, v91
  s_nop 0
  v_fma_f32 v88, v88, v24, v24
  v_fma_f32 v89, v89, v24, v24
  v_fma_f32 v90, v90, v24, v24
  v_fma_f32 v91, v91, v24, v24
  v_rcp_f32 v88, v88
  v_rcp_f32 v89, v89
  v_rcp_f32 v90, v90
  v_rcp_f32 v91, v91
  s_nop 0
  v_mul_f32 v136, v88, v136
  v_mul_f32 v137, v89, v137
  v_mul_f32 v138, v90, v138
  v_mul_f32 v139, v91, v139
  v_cvt_pk_bf16_f32 v34, v136, v137
  v_cvt_pk_bf16_f32 v35, v138, v139
  buffer_store_dwordx4 v[32:35], v18, s[28:31], s35 offen offset:0 sc1
  v_mul_f32 v104, v28, v104
  v_mul_f32 v105, v28, v105
  v_mul_f32 v106, v28, v106
  v_mul_f32 v107, v28, v107
  v_exp_f32 v104, v104
  v_exp_f32 v105, v105
  v_exp_f32 v106, v106
  v_exp_f32 v107, v107
  s_nop 0
  v_fma_f32 v104, v104, v24, v24
  v_fma_f32 v105, v105, v24, v24
  v_fma_f32 v106, v106, v24, v24
  v_fma_f32 v107, v107, v24, v24
  v_rcp_f32 v104, v104
  v_rcp_f32 v105, v105
  v_rcp_f32 v106, v106
  v_rcp_f32 v107, v107
  s_nop 0
  v_mul_f32 v152, v104, v152
  v_mul_f32 v153, v105, v153
  v_mul_f32 v154, v106, v154
  v_mul_f32 v155, v107, v155
  v_cvt_pk_bf16_f32 v40, v152, v153
  v_cvt_pk_bf16_f32 v41, v154, v155
  v_mul_f32 v76, v29, v76
  v_mul_f32 v77, v29, v77
  v_mul_f32 v78, v29, v78
  v_mul_f32 v79, v29, v79
  v_exp_f32 v76, v76
  v_exp_f32 v77, v77
  v_exp_f32 v78, v78
  v_exp_f32 v79, v79
  s_nop 0
  v_fma_f32 v76, v76, v25, v25
  v_fma_f32 v77, v77, v25, v25
  v_fma_f32 v78, v78, v25, v25
  v_fma_f32 v79, v79, v25, v25
  v_rcp_f32 v76, v76
  v_rcp_f32 v77, v77
  v_rcp_f32 v78, v78
  v_rcp_f32 v79, v79
  s_nop 0
  v_mul_f32 v124, v76, v124
  v_mul_f32 v125, v77, v125
  v_mul_f32 v126, v78, v126
  v_mul_f32 v127, v79, v127
  v_cvt_pk_bf16_f32 v36, v124, v125
  v_cvt_pk_bf16_f32 v37, v126, v127
  v_mul_f32 v92, v29, v92
  v_mul_f32 v93, v29, v93
  v_mul_f32 v94, v29, v94
  v_mul_f32 v95, v29, v95
  v_exp_f32 v92, v92
  v_exp_f32 v93, v93
  v_exp_f32 v94, v94
  v_exp_f32 v95, v95
  s_nop 0
  v_fma_f32 v92, v92, v25, v25
  v_fma_f32 v93, v93, v25, v25
  v_fma_f32 v94, v94, v25, v25
  v_fma_f32 v95, v95, v25, v25
  v_rcp_f32 v92, v92
  v_rcp_f32 v93, v93
  v_rcp_f32 v94, v94
  v_rcp_f32 v95, v95
  s_nop 0
  v_mul_f32 v140, v92, v140
  v_mul_f32 v141, v93, v141
  v_mul_f32 v142, v94, v142
  v_mul_f32 v143, v95, v143
  v_cvt_pk_bf16_f32 v38, v140, v141
  v_cvt_pk_bf16_f32 v39, v142, v143
  buffer_store_dwordx4 v[36:39], v18, s[28:31], s35 offen offset:1024 sc1
  v_mul_f32 v108, v29, v108
  v_mul_f32 v109, v29, v109
  v_mul_f32 v110, v29, v110
  v_mul_f32 v111, v29, v111
  v_exp_f32 v108, v108
  v_exp_f32 v109, v109
  v_exp_f32 v110, v110
  v_exp_f32 v111, v111
  s_nop 0
  v_fma_f32 v108, v108, v25, v25
  v_fma_f32 v109, v109, v25, v25
  v_fma_f32 v110, v110, v25, v25
  v_fma_f32 v111, v111, v25, v25
  v_rcp_f32 v108, v108
  v_rcp_f32 v109, v109
  v_rcp_f32 v110, v110
  v_rcp_f32 v111, v111
  s_nop 0
  v_mul_f32 v156, v108, v156
  v_mul_f32 v157, v109, v157
  v_mul_f32 v158, v110, v158
  v_mul_f32 v159, v111, v159
  v_cvt_pk_bf16_f32 v42, v156, v157
  v_cvt_pk_bf16_f32 v43, v158, v159
  buffer_store_dwordx4 v[40:43], v18, s[28:31], s36 offen offset:0 sc1
  v_mul_f32 v80, v30, v80
  v_mul_f32 v81, v30, v81
  v_mul_f32 v82, v30, v82
  v_mul_f32 v83, v30, v83
  v_exp_f32 v80, v80
  v_exp_f32 v81, v81
  v_exp_f32 v82, v82
  v_exp_f32 v83, v83
  s_nop 0
  v_fma_f32 v80, v80, v26, v26
  v_fma_f32 v81, v81, v26, v26
  v_fma_f32 v82, v82, v26, v26
  v_fma_f32 v83, v83, v26, v26
  v_rcp_f32 v80, v80
  v_rcp_f32 v81, v81
  v_rcp_f32 v82, v82
  v_rcp_f32 v83, v83
  s_nop 0
  v_mul_f32 v128, v80, v128
  v_mul_f32 v129, v81, v129
  v_mul_f32 v130, v82, v130
  v_mul_f32 v131, v83, v131
  v_cvt_pk_bf16_f32 v32, v128, v129
  v_cvt_pk_bf16_f32 v33, v130, v131
  v_mul_f32 v96, v30, v96
  v_mul_f32 v97, v30, v97
  v_mul_f32 v98, v30, v98
  v_mul_f32 v99, v30, v99
  v_exp_f32 v96, v96
  v_exp_f32 v97, v97
  v_exp_f32 v98, v98
  v_exp_f32 v99, v99
  s_nop 0
  v_fma_f32 v96, v96, v26, v26
  v_fma_f32 v97, v97, v26, v26
  v_fma_f32 v98, v98, v26, v26
  v_fma_f32 v99, v99, v26, v26
  v_rcp_f32 v96, v96
  v_rcp_f32 v97, v97
  v_rcp_f32 v98, v98
  v_rcp_f32 v99, v99
  s_nop 0
  v_mul_f32 v144, v96, v144
  v_mul_f32 v145, v97, v145
  v_mul_f32 v146, v98, v146
  v_mul_f32 v147, v99, v147
  v_cvt_pk_bf16_f32 v34, v144, v145
  v_cvt_pk_bf16_f32 v35, v146, v147
  buffer_store_dwordx4 v[32:35], v18, s[28:31], s35 offen offset:2048 sc1
  v_mul_f32 v112, v30, v112
  v_mul_f32 v113, v30, v113
  v_mul_f32 v114, v30, v114
  v_mul_f32 v115, v30, v115
  v_exp_f32 v112, v112
  v_exp_f32 v113, v113
  v_exp_f32 v114, v114
  v_exp_f32 v115, v115
  s_nop 0
  v_fma_f32 v112, v112, v26, v26
  v_fma_f32 v113, v113, v26, v26
  v_fma_f32 v114, v114, v26, v26
  v_fma_f32 v115, v115, v26, v26
  v_rcp_f32 v112, v112
  v_rcp_f32 v113, v113
  v_rcp_f32 v114, v114
  v_rcp_f32 v115, v115
  s_nop 0
  v_mul_f32 v160, v112, v160
  v_mul_f32 v161, v113, v161
  v_mul_f32 v162, v114, v162
  v_mul_f32 v163, v115, v163
  v_cvt_pk_bf16_f32 v44, v160, v161
  v_cvt_pk_bf16_f32 v45, v162, v163
  v_mul_f32 v84, v31, v84
  v_mul_f32 v85, v31, v85
  v_mul_f32 v86, v31, v86
  v_mul_f32 v87, v31, v87
  v_exp_f32 v84, v84
  v_exp_f32 v85, v85
  v_exp_f32 v86, v86
  v_exp_f32 v87, v87
  s_nop 0
  v_fma_f32 v84, v84, v27, v27
  v_fma_f32 v85, v85, v27, v27
  v_fma_f32 v86, v86, v27, v27
  v_fma_f32 v87, v87, v27, v27
  v_rcp_f32 v84, v84
  v_rcp_f32 v85, v85
  v_rcp_f32 v86, v86
  v_rcp_f32 v87, v87
  s_nop 0
  v_mul_f32 v132, v84, v132
  v_mul_f32 v133, v85, v133
  v_mul_f32 v134, v86, v134
  v_mul_f32 v135, v87, v135
  v_cvt_pk_bf16_f32 v36, v132, v133
  v_cvt_pk_bf16_f32 v37, v134, v135
  v_mul_f32 v100, v31, v100
  v_mul_f32 v101, v31, v101
  v_mul_f32 v102, v31, v102
  v_mul_f32 v103, v31, v103
  v_exp_f32 v100, v100
  v_exp_f32 v101, v101
  v_exp_f32 v102, v102
  v_exp_f32 v103, v103
  s_nop 0
  v_fma_f32 v100, v100, v27, v27
  v_fma_f32 v101, v101, v27, v27
  v_fma_f32 v102, v102, v27, v27
  v_fma_f32 v103, v103, v27, v27
  v_rcp_f32 v100, v100
  v_rcp_f32 v101, v101
  v_rcp_f32 v102, v102
  v_rcp_f32 v103, v103
  s_nop 0
  v_mul_f32 v148, v100, v148
  v_mul_f32 v149, v101, v149
  v_mul_f32 v150, v102, v150
  v_mul_f32 v151, v103, v151
  v_cvt_pk_bf16_f32 v38, v148, v149
  v_cvt_pk_bf16_f32 v39, v150, v151
  buffer_store_dwordx4 v[36:39], v18, s[28:31], s35 offen offset:3072 sc1
  v_mul_f32 v116, v31, v116
  v_mul_f32 v117, v31, v117
  v_mul_f32 v118, v31, v118
  v_mul_f32 v119, v31, v119
  v_exp_f32 v116, v116
  v_exp_f32 v117, v117
  v_exp_f32 v118, v118
  v_exp_f32 v119, v119
  s_nop 0
  v_fma_f32 v116, v116, v27, v27
  v_fma_f32 v117, v117, v27, v27
  v_fma_f32 v118, v118, v27, v27
  v_fma_f32 v119, v119, v27, v27
  v_rcp_f32 v116, v116
  v_rcp_f32 v117, v117
  v_rcp_f32 v118, v118
  v_rcp_f32 v119, v119
  s_nop 0
  v_mul_f32 v164, v116, v164
  v_mul_f32 v165, v117, v165
  v_mul_f32 v166, v118, v166
  v_mul_f32 v167, v119, v167
  v_cvt_pk_bf16_f32 v46, v164, v165
  v_cvt_pk_bf16_f32 v47, v166, v167
  buffer_store_dwordx4 v[44:47], v18, s[28:31], s36 offen offset:1024 sc1
k3_end:
  s_endpgm
.globl k4_kernel
.p2align 8
.type k4_kernel,@function
k4_kernel:
  s_cmp_ge_u32 s2, 256
  s_cbranch_scc1 k4_end
  s_load_dwordx4 s[4:7], s[0:1], 48
  s_load_dwordx4 s[8:11], s[0:1], 64
  v_lshrrev_b32 v1, 6, v0
  s_and_b32 s12, s2, 3
  v_readfirstlane_b32 s3, v1
  v_and_b32 v0, 63, v0
  s_bfe_u32 s14, s2, 0x10002
  s_lshr_b32 s15, s2, 3
  s_and_b32 s13, s15, 3
  s_lshr_b32 s15, s15, 2
  s_lshl_b32 s14, s14, 3
  s_add_u32 s14, s14, s15
  s_and_b32 s28, s3, 3
  s_bfe_u32 s15, s3, 0x10002
  s_cmp_lt_u32 s3, 8
  s_cbranch_scc1 k4_compute
  s_and_b32 s29, s3, 1
  v_lshlrev_b32 v7, 4, v0
  s_lshl_b32 s39, s14, 6
  s_lshl_b32 s36, s12, 3
  s_add_u32 s39, s39, s36
  s_mul_i32 s39, s39, 18432
  s_lshl_b32 s38, s29, 13
  s_add_u32 s38, s38, 18432
  s_mul_i32 s33, s12, 1327104
  s_mul_i32 s32, s29, 9216
  s_mul_i32 s37, s13, 288
  s_waitcnt lgkmcnt(0)
  s_add_u32 s16, s10, 0x600000
  s_addc_u32 s17, s11, 0
  s_mov_b32 s18, 0x1200000
  s_mov_b32 s19, 0x00020000
  s_mov_b32 s20, s4
  s_mov_b32 s21, s5
  s_mov_b32 s22, 0x510000
  s_mov_b32 s23, 0x00020000
  s_cmp_ge_u32 s3, 10
  s_cbranch_scc1 k4_load1
  s_mul_i32 s34, s29, 6144
  s_add_u32 s34, s34, 0
  s_add_u32 s34, s34, s39
  s_add_u32 m0, s38, 0
  s_add_u32 s35, s34, 0
  buffer_load_dwordx4 v7, s[16:19], s35 offen lds
  s_add_u32 m0, s38, 1024
  s_add_u32 s35, s34, 1024
  buffer_load_dwordx4 v7, s[16:19], s35 offen lds
  s_add_u32 m0, s38, 4096
  s_add_u32 s35, s34, 589824
  buffer_load_dwordx4 v7, s[16:19], s35 offen lds
  v_add_u32 v20, 0, v0
  v_mul_u32_u24 v21, 3641, v20
  v_lshrrev_b32 v21, 16, v21
  v_mul_u32_u24 v22, 18, v21
  v_sub_u32 v22, v20, v22
  v_mul_u32_u24 v21, 1152, v21
  v_lshl_add_u32 v21, v22, 4, v21
  v_add_u32 v8, s37, v21
  v_add_u32 v20, 64, v0
  v_mul_u32_u24 v21, 3641, v20
  v_lshrrev_b32 v21, 16, v21
  v_mul_u32_u24 v22, 18, v21
  v_sub_u32 v22, v20, v22
  v_mul_u32_u24 v21, 1152, v21
  v_lshl_add_u32 v21, v22, 4, v21
  v_add_u32 v9, s37, v21
  v_add_u32 v20, 128, v0
  v_mul_u32_u24 v21, 3641, v20
  v_lshrrev_b32 v21, 16, v21
  v_mul_u32_u24 v22, 18, v21
  v_sub_u32 v22, v20, v22
  v_mul_u32_u24 v21, 1152, v21
  v_lshl_add_u32 v21, v22, 4, v21
  v_add_u32 v10, s37, v21
  v_add_u32 v20, 192, v0
  v_mul_u32_u24 v21, 3641, v20
  v_lshrrev_b32 v21, 16, v21
  v_mul_u32_u24 v22, 18, v21
  v_sub_u32 v22, v20, v22
  v_mul_u32_u24 v21, 1152, v21
  v_lshl_add_u32 v21, v22, 4, v21
  v_add_u32 v11, s37, v21
  v_add_u32 v20, 256, v0
  v_mul_u32_u24 v21, 3641, v20
  v_lshrrev_b32 v21, 16, v21
  v_mul_u32_u24 v22, 18, v21
  v_sub_u32 v22, v20, v22
  v_lshrrev_b32 v18, 4, v21
  v_mul_u32_u24 v21, 1152, v21
  v_lshl_add_u32 v21, v22, 4, v21
  v_add_u32 v12, s37, v21
  s_mul_i32 s34, s29, 55296
  s_add_u32 s34, s34, 0
  s_add_u32 s34, s34, s33
  s_mul_i32 s35, s29, 0
  s_add_u32 s35, s35, 0
  v_mad_u32_u24 v19, v18, s35, v12
  s_add_u32 s35, s35, s34
  s_add_u32 m0, s32, 0
  s_nop 0
  buffer_load_dwordx4 v8, s[20:23], s34 offen lds
  s_add_u32 m0, s32, 1024
  s_nop 0
  buffer_load_dwordx4 v9, s[20:23], s34 offen lds
  s_add_u32 m0, s32, 2048
  s_nop 0
  buffer_load_dwordx4 v10, s[20:23], s34 offen lds
  s_add_u32 m0, s32, 3072
  s_nop 0
  buffer_load_dwordx4 v11, s[20:23], s34 offen lds
  s_add_u32 m0, s32, 4096
  s_nop 0
  buffer_load_dwordx4 v19, s[20:23], s34 offen lds
  s_mul_i32 s34, s29, -73728
  s_add_u32 s34, s34, 110592
  s_add_u32 s34, s34, s33
  s_mul_i32 s35, s29, 36864
  s_add_u32 s35, s35, 0
  v_mad_u32_u24 v19, v18, s35, v12
  s_add_u32 s35, s35, s34
  s_add_u32 m0, s32, 34816
  s_nop 0
  buffer_load_dwordx4 v8, s[20:23], s34 offen lds
  s_add_u32 m0, s32, 35840
  s_nop 0
  buffer_load_dwordx4 v9, s[20:23], s34 offen lds
  s_add_u32 m0, s32, 36864
  s_nop 0
  buffer_load_dwordx4 v10, s[20:23], s34 offen lds
  s_add_u32 m0, s32, 37888
  s_nop 0
  buffer_load_dwordx4 v11, s[20:23], s34 offen lds
  s_add_u32 m0, s32, 38912
  s_nop 0
  buffer_load_dwordx4 v19, s[20:23], s34 offen lds
  s_mul_i32 s34, s29, -8192
  s_add_u32 s34, s34, 12288
  s_add_u32 s34, s34, s39
  s_add_u32 m0, s38, 34816
  s_add_u32 s35, s34, 0
  buffer_load_dwordx4 v7, s[16:19], s35 offen lds
  s_add_u32 m0, s38, 35840
  s_add_u32 s35, s34, 1024
  buffer_load_dwordx4 v7, s[16:19], s35 offen lds
  s_add_u32 m0, s38, 38912
  s_add_u32 s35, s34, 589824
  buffer_load_dwordx4 v7, s[16:19], s35 offen lds
  s_waitcnt vmcnt(8)
  s_barrier
  s_mul_i32 s34, s29, 55296
  s_add_u32 s34, s34, 165888
  s_add_u32 s34, s34, s33
  s_mul_i32 s35, s29, 0
  s_add_u32 s35, s35, 0
  v_mad_u32_u24 v19, v18, s35, v12
  s_add_u32 s35, s35, s34
  s_add_u32 m0, s32, 69632
  s_nop 0
  buffer_load_dwordx4 v8, s[20:23], s34 offen lds
  s_add_u32 m0, s32, 70656
  s_nop 0
  buffer_load_dwordx4 v9, s[20:23], s34 offen lds
  s_add_u32 m0, s32, 71680
  s_nop 0
  buffer_load_dwordx4 v10, s[20:23], s34 offen lds
  s_add_u32 m0, s32, 72704
  s_nop 0
  buffer_load_dwordx4 v11, s[20:23], s34 offen lds
  s_add_u32 m0, s32, 73728
  s_nop 0
  buffer_load_dwordx4 v19, s[20:23], s34 offen lds
  s_mul_i32 s34, s29, 6144
  s_add_u32 s34, s34, 18432
  s_add_u32 s34, s34, s39
  s_add_u32 m0, s38, 69632
  s_add_u32 s35, s34, 0
  buffer_load_dwordx4 v7, s[16:19], s35 offen lds
  s_add_u32 m0, s38, 70656
  s_add_u32 s35, s34, 1024
  buffer_load_dwordx4 v7, s[16:19], s35 offen lds
  s_add_u32 m0, s38, 73728
  s_add_u32 s35, s34, 589824
  buffer_load_dwordx4 v7, s[16:19], s35 offen lds
  s_waitcnt vmcnt(8)
  s_barrier
  s_mul_i32 s34, s29, -73728
  s_add_u32 s34, s34, 276480
  s_add_u32 s34, s34, s33
  s_mul_i32 s35, s29, 36864
  s_add_u32 s35, s35, 0
  v_mad_u32_u24 v19, v18, s35, v12
  s_add_u32 s35, s35, s34
  s_add_u32 m0, s32, 104448
  s_nop 0
  buffer_load_dwordx4 v8, s[20:23], s34 offen lds
  s_add_u32 m0, s32, 105472
  s_nop 0
  buffer_load_dwordx4 v9, s[20:23], s34 offen lds
  s_add_u32 m0, s32, 106496
  s_nop 0
  buffer_load_dwordx4 v10, s[20:23], s34 offen lds
  s_add_u32 m0, s32, 107520
  s_nop 0
  buffer_load_dwordx4 v11, s[20:23], s34 offen lds
  s_add_u32 m0, s32, 108544
  s_nop 0
  buffer_load_dwordx4 v19, s[20:23], s34 offen lds
  s_mul_i32 s34, s29, -8192
  s_add_u32 s34, s34, 30720
  s_add_u32 s34, s34, s39
  s_add_u32 m0, s38, 104448
  s_add_u32 s35, s34, 0
  buffer_load_dwordx4 v7, s[16:19], s35 offen lds
  s_add_u32 m0, s38, 105472
  s_add_u32 s35, s34, 1024
  buffer_load_dwordx4 v7, s[16:19], s35 offen lds
  s_add_u32 m0, s38, 108544
  s_add_u32 s35, s34, 589824
  buffer_load_dwordx4 v7, s[16:19], s35 offen lds
  s_mul_i32 s34, s29, 184320
  s_add_u32 s34, s34, 147456
  s_add_u32 s34, s34, s33
  s_mul_i32 s35, s29, -147456
  s_add_u32 s35, s35, 147456
  v_mad_u32_u24 v19, v18, s35, v12
  s_add_u32 s35, s35, s34
  s_add_u32 m0, s32, 0
  s_nop 0
  buffer_load_dwordx4 v8, s[20:23], s34 offen lds
  s_add_u32 m0, s32, 1024
  s_nop 0
  buffer_load_dwordx4 v9, s[20:23], s34 offen lds
  s_add_u32 m0, s32, 2048
  s_nop 0
  buffer_load_dwordx4 v10, s[20:23], s34 offen lds
  s_add_u32 m0, s32, 3072
  s_nop 0
  buffer_load_dwordx4 v11, s[20:23], s34 offen lds
  s_add_u32 m0, s32, 4096
  s_nop 0
  buffer_load_dwordx4 v19, s[20:23], s34 offen lds
  s_mul_i32 s34, s29, 20480
  s_add_u32 s34, s34, 16384
  s_add_u32 s34, s34, s39
  s_add_u32 m0, s38, 0
  s_add_u32 s35, s34, 0
  buffer_load_dwordx4 v7, s[16:19], s35 offen lds
  s_add_u32 m0, s38, 1024
  s_add_u32 s35, s34, 1024
  buffer_load_dwordx4 v7, s[16:19], s35 offen lds
  s_add_u32 m0, s38, 4096
  s_add_u32 s35, s34, 589824
  buffer_load_dwordx4 v7, s[16:19], s35 offen lds
  s_waitcnt vmcnt(16)
  s_barrier
  s_mul_i32 s34, s29, 55296
  s_add_u32 s34, s34, 387072
  s_add_u32 s34, s34, s33
  s_mul_i32 s35, s29, 0
  s_add_u32 s35, s35, 0
  v_mad_u32_u24 v19, v18, s35, v12
  s_add_u32 s35, s35, s34
  s_add_u32 m0, s32, 34816
  s_nop 0
  buffer_load_dwordx4 v8, s[20:23], s34 offen lds
  s_add_u32 m0, s32, 35840
  s_nop 0
  buffer_load_dwordx4 v9, s[20:23], s34 offen lds
  s_add_u32 m0, s32, 36864
  s_nop 0
  buffer_load_dwordx4 v10, s[20:23], s34 offen lds
  s_add_u32 m0, s32, 37888
  s_nop 0
  buffer_load_dwordx4 v11, s[20:23], s34 offen lds
  s_add_u32 m0, s32, 38912
  s_nop 0
  buffer_load_dwordx4 v19, s[20:23], s34 offen lds
  s_mul_i32 s34, s29, 6144
  s_add_u32 s34, s34, 43008
  s_add_u32 s34, s34, s39
  s_add_u32 m0, s38, 34816
  s_add_u32 s35, s34, 0
  buffer_load_dwordx4 v7, s[16:19], s35 offen lds
  s_add_u32 m0, s38, 35840
  s_add_u32 s35, s34, 1024
  buffer_load_dwordx4 v7, s[16:19], s35 offen lds
  s_add_u32 m0, s38, 38912
  s_add_u32 s35, s34, 589824
  buffer_load_dwordx4 v7, s[16:19], s35 offen lds
  s_waitcnt vmcnt(16)
  s_barrier
  s_mul_i32 s34, s29, 129024
  s_add_u32 s34, s34, 368640
  s_add_u32 s34, s34, s33
  s_mul_i32 s35, s29, -36864
  s_add_u32 s35, s35, 36864
  v_mad_u32_u24 v19, v18, s35, v12
  s_add_u32 s35, s35, s34
  s_add_u32 m0, s32, 69632
  s_nop 0
  buffer_load_dwordx4 v8, s[20:23], s34 offen lds
  s_add_u32 m0, s32, 70656
  s_nop 0
  buffer_load_dwordx4 v9, s[20:23], s34 offen lds
  s_add_u32 m0, s32, 71680
  s_nop 0
  buffer_load_dwordx4 v10, s[20:23], s34 offen lds
  s_add_u32 m0, s32, 72704
  s_nop 0
  buffer_load_dwordx4 v11, s[20:23], s34 offen lds
  s_add_u32 m0, s32, 73728
  s_nop 0
  buffer_load_dwordx4 v19, s[20:23], s34 offen lds
  s_mul_i32 s34, s29, 14336
  s_add_u32 s34, s34, 40960
  s_add_u32 s34, s34, s39
  s_add_u32 m0, s38, 69632
  s_add_u32 s35, s34, 0
  buffer_load_dwordx4 v7, s[16:19], s35 offen lds
  s_add_u32 m0, s38, 70656
  s_add_u32 s35, s34, 1024
  buffer_load_dwordx4 v7, s[16:19], s35 offen lds
  s_add_u32 m0, s38, 73728
  s_add_u32 s35, s34, 589824
  buffer_load_dwordx4 v7, s[16:19], s35 offen lds
  s_waitcnt vmcnt(16)
  s_barrier
  s_mul_i32 s34, s29, 55296
  s_add_u32 s34, s34, 552960
  s_add_u32 s34, s34, s33
  s_mul_i32 s35, s29, 0
  s_add_u32 s35, s35, 0
  v_mad_u32_u24 v19, v18, s35, v12
  s_add_u32 s35, s35, s34
  s_add_u32 m0, s32, 104448
  s_nop 0
  buffer_load_dwordx4 v8, s[20:23], s34 offen lds
  s_add_u32 m0, s32, 105472
  s_nop 0
  buffer_load_dwordx4 v9, s[20:23], s34 offen lds
  s_add_u32 m0, s32, 106496
  s_nop 0
  buffer_load_dwordx4 v10, s[20:23], s34 offen lds
  s_add_u32 m0, s32, 107520
  s_nop 0
  buffer_load_dwordx4 v11, s[20:23], s34 offen lds
  s_add_u32 m0, s32, 108544
  s_nop 0
  buffer_load_dwordx4 v19, s[20:23], s34 offen lds
  s_mul_i32 s34, s29, 6144
  s_add_u32 s34, s34, 61440
  s_add_u32 s34, s34, s39
  s_add_u32 m0, s38, 104448
  s_add_u32 s35, s34, 0
  buffer_load_dwordx4 v7, s[16:19], s35 offen lds
  s_add_u32 m0, s38, 105472
  s_add_u32 s35, s34, 1024
  buffer_load_dwordx4 v7, s[16:19], s35 offen lds
  s_add_u32 m0, s38, 108544
  s_add_u32 s35, s34, 589824
  buffer_load_dwordx4 v7, s[16:19], s35 offen lds
  s_waitcnt vmcnt(16)
  s_barrier
  s_mul_i32 s34, s29, -55296
  s_add_u32 s34, s34, 534528
  s_add_u32 s34, s34, s33
  s_mul_i32 s35, s29, 110592
  s_add_u32 s35, s35, 36864
  v_mad_u32_u24 v19, v18, s35, v12
  s_add_u32 s35, s35, s34
  s_add_u32 m0, s32, 0
  s_nop 0
  buffer_load_dwordx4 v8, s[20:23], s34 offen lds
  s_add_u32 m0, s32, 1024
  s_nop 0
  buffer_load_dwordx4 v9, s[20:23], s34 offen lds
  s_add_u32 m0, s32, 2048
  s_nop 0
  buffer_load_dwordx4 v10, s[20:23], s34 offen lds
  s_add_u32 m0, s32, 3072
  s_nop 0
  buffer_load_dwordx4 v11, s[20:23], s34 offen lds
  s_add_u32 m0, s32, 4096
  s_nop 0
  buffer_load_dwordx4 v19, s[20:23], s34 offen lds
  s_mul_i32 s34, s29, -6144
  s_add_u32 s34, s34, 59392
  s_add_u32 s34, s34, s39
  s_add_u32 m0, s38, 0
  s_add_u32 s35, s34, 0
  buffer_load_dwordx4 v7, s[16:19], s35 offen lds
  s_add_u32 m0, s38, 1024
  s_add_u32 s35, s34, 1024
  buffer_load_dwordx4 v7, s[16:19], s35 offen lds
  s_add_u32 m0, s38, 4096
  s_add_u32 s35, s34, 589824
  buffer_load_dwordx4 v7, s[16:19], s35 offen lds
  s_waitcnt vmcnt(16)
  s_barrier
  s_mul_i32 s34, s29, 55296
  s_add_u32 s34, s34, 663552
  s_add_u32 s34, s34, s33
  s_mul_i32 s35, s29, 0
  s_add_u32 s35, s35, 0
  v_mad_u32_u24 v19, v18, s35, v12
  s_add_u32 s35, s35, s34
  s_add_u32 m0, s32, 34816
  s_nop 0
  buffer_load_dwordx4 v8, s[20:23], s34 offen lds
  s_add_u32 m0, s32, 35840
  s_nop 0
  buffer_load_dwordx4 v9, s[20:23], s34 offen lds
  s_add_u32 m0, s32, 36864
  s_nop 0
  buffer_load_dwordx4 v10, s[20:23], s34 offen lds
  s_add_u32 m0, s32, 37888
  s_nop 0
  buffer_load_dwordx4 v11, s[20:23], s34 offen lds
  s_add_u32 m0, s32, 38912
  s_nop 0
  buffer_load_dwordx4 v19, s[20:23], s34 offen lds
  s_mul_i32 s34, s29, 6144
  s_add_u32 s34, s34, 73728
  s_add_u32 s34, s34, s39
  s_add_u32 m0, s38, 34816
  s_add_u32 s35, s34, 0
  buffer_load_dwordx4 v7, s[16:19], s35 offen lds
  s_add_u32 m0, s38, 35840
  s_add_u32 s35, s34, 1024
  buffer_load_dwordx4 v7, s[16:19], s35 offen lds
  s_add_u32 m0, s38, 38912
  s_add_u32 s35, s34, 589824
  buffer_load_dwordx4 v7, s[16:19], s35 offen lds
  s_waitcnt vmcnt(16)
  s_barrier
  s_mul_i32 s34, s29, -73728
  s_add_u32 s34, s34, 774144
  s_add_u32 s34, s34, s33
  s_mul_i32 s35, s29, 36864
  s_add_u32 s35, s35, 0
  v_mad_u32_u24 v19, v18, s35, v12
  s_add_u32 s35, s35, s34
  s_add_u32 m0, s32, 69632
  s_nop 0
  buffer_load_dwordx4 v8, s[20:23], s34 offen lds
  s_add_u32 m0, s32, 70656
  s_nop 0
  buffer_load_dwordx4 v9, s[20:23], s34 offen lds
  s_add_u32 m0, s32, 71680
  s_nop 0
  buffer_load_dwordx4 v10, s[20:23], s34 offen lds
  s_add_u32 m0, s32, 72704
  s_nop 0
  buffer_load_dwordx4 v11, s[20:23], s34 offen lds
  s_add_u32 m0, s32, 73728
  s_nop 0
  buffer_load_dwordx4 v19, s[20:23], s34 offen lds
  s_mul_i32 s34, s29, -8192
  s_add_u32 s34, s34, 86016
  s_add_u32 s34, s34, s39
  s_add_u32 m0, s38, 69632
  s_add_u32 s35, s34, 0
  buffer_load_dwordx4 v7, s[16:19], s35 offen lds
  s_add_u32 m0, s38, 70656
  s_add_u32 s35, s34, 1024
  buffer_load_dwordx4 v7, s[16:19], s35 offen lds
  s_add_u32 m0, s38, 73728
  s_add_u32 s35, s34, 589824
  buffer_load_dwordx4 v7, s[16:19], s35 offen lds
  s_waitcnt vmcnt(16)
  s_barrier
  s_mul_i32 s34, s29, 55296
  s_add_u32 s34, s34, 829440
  s_add_u32 s34, s34, s33
  s_mul_i32 s35, s29, 0
  s_add_u32 s35, s35, 0
  v_mad_u32_u24 v19, v18, s35, v12
  s_add_u32 s35, s35, s34
  s_add_u32 m0, s32, 104448
  s_nop 0
  buffer_load_dwordx4 v8, s[20:23], s34 offen lds
  s_add_u32 m0, s32, 105472
  s_nop 0
  buffer_load_dwordx4 v9, s[20:23], s34 offen lds
  s_add_u32 m0, s32, 106496
  s_nop 0
  buffer_load_dwordx4 v10, s[20:23], s34 offen lds
  s_add_u32 m0, s32, 107520
  s_nop 0
  buffer_load_dwordx4 v11, s[20:23], s34 offen lds
  s_add_u32 m0, s32, 108544
  s_nop 0
  buffer_load_dwordx4 v19, s[20:23], s34 offen lds
  s_mul_i32 s34, s29, 6144
  s_add_u32 s34, s34, 92160
  s_add_u32 s34, s34, s39
  s_add_u32 m0, s38, 104448
  s_add_u32 s35, s34, 0
  buffer_load_dwordx4 v7, s[16:19], s35 offen lds
  s_add_u32 m0, s38, 105472
  s_add_u32 s35, s34, 1024
  buffer_load_dwordx4 v7, s[16:19], s35 offen lds
  s_add_u32 m0, s38, 108544
  s_add_u32 s35, s34, 589824
  buffer_load_dwordx4 v7, s[16:19], s35 offen lds
  s_waitcnt vmcnt(16)
  s_barrier
  s_mul_i32 s34, s29, -73728
  s_add_u32 s34, s34, 940032
  s_add_u32 s34, s34, s33
  s_mul_i32 s35, s29, 36864
  s_add_u32 s35, s35, 0
  v_mad_u32_u24 v19, v18, s35, v12
  s_add_u32 s35, s35, s34
  s_add_u32 m0, s32, 0
  s_nop 0
  buffer_load_dwordx4 v8, s[20:23], s34 offen lds
  s_add_u32 m0, s32, 1024
  s_nop 0
  buffer_load_dwordx4 v9, s[20:23], s34 offen lds
  s_add_u32 m0, s32, 2048
  s_nop 0
  buffer_load_dwordx4 v10, s[20:23], s34 offen lds
  s_add_u32 m0, s32, 3072
  s_nop 0
  buffer_load_dwordx4 v11, s[20:23], s34 offen lds
  s_add_u32 m0, s32, 4096
  s_nop 0
  buffer_load_dwordx4 v19, s[20:23], s34 offen lds
  s_mul_i32 s34, s29, -8192
  s_add_u32 s34, s34, 104448
  s_add_u32 s34, s34, s39
  s_add_u32 m0, s38, 0
  s_add_u32 s35, s34, 0
  buffer_load_dwordx4 v7, s[16:19], s35 offen lds
  s_add_u32 m0, s38, 1024
  s_add_u32 s35, s34, 1024
  buffer_load_dwordx4 v7, s[16:19], s35 offen lds
  s_add_u32 m0, s38, 4096
  s_add_u32 s35, s34, 589824
  buffer_load_dwordx4 v7, s[16:19], s35 offen lds
  s_waitcnt vmcnt(16)
  s_barrier
  s_mul_i32 s34, s29, 184320
  s_add_u32 s34, s34, 811008
  s_add_u32 s34, s34, s33
  s_mul_i32 s35, s29, -147456
  s_add_u32 s35, s35, 147456
  v_mad_u32_u24 v19, v18, s35, v12
  s_add_u32 s35, s35, s34
  s_add_u32 m0, s32, 34816
  s_nop 0
  buffer_load_dwordx4 v8, s[20:23], s34 offen lds
  s_add_u32 m0, s32, 35840
  s_nop 0
  buffer_load_dwordx4 v9, s[20:23], s34 offen lds
  s_add_u32 m0, s32, 36864
  s_nop 0
  buffer_load_dwordx4 v10, s[20:23], s34 offen lds
  s_add_u32 m0, s32, 37888
  s_nop 0
  buffer_load_dwordx4 v11, s[20:23], s34 offen lds
  s_add_u32 m0, s32, 38912
  s_nop 0
  buffer_load_dwordx4 v19, s[20:23], s34 offen lds
  s_mul_i32 s34, s29, 20480
  s_add_u32 s34, s34, 90112
  s_add_u32 s34, s34, s39
  s_add_u32 m0, s38, 34816
  s_add_u32 s35, s34, 0
  buffer_load_dwordx4 v7, s[16:19], s35 offen lds
  s_add_u32 m0, s38, 35840
  s_add_u32 s35, s34, 1024
  buffer_load_dwordx4 v7, s[16:19], s35 offen lds
  s_add_u32 m0, s38, 38912
  s_add_u32 s35, s34, 589824
  buffer_load_dwordx4 v7, s[16:19], s35 offen lds
  s_waitcnt vmcnt(16)
  s_barrier
  s_mul_i32 s34, s29, 55296
  s_add_u32 s34, s34, 1050624
  s_add_u32 s34, s34, s33
  s_mul_i32 s35, s29, 0
  s_add_u32 s35, s35, 0
  v_mad_u32_u24 v19, v18, s35, v12
  s_add_u32 s35, s35, s34
  s_add_u32 m0, s32, 69632
  s_nop 0
  buffer_load_dwordx4 v8, s[20:23], s34 offen lds
  s_add_u32 m0, s32, 70656
  s_nop 0
  buffer_load_dwordx4 v9, s[20:23], s34 offen lds
  s_add_u32 m0, s32, 71680
  s_nop 0
  buffer_load_dwordx4 v10, s[20:23], s34 offen lds
  s_add_u32 m0, s32, 72704
  s_nop 0
  buffer_load_dwordx4 v11, s[20:23], s34 offen lds
  s_add_u32 m0, s32, 73728
  s_nop 0
  buffer_load_dwordx4 v19, s[20:23], s34 offen lds
  s_mul_i32 s34, s29, 6144
  s_add_u32 s34, s34, 116736
  s_add_u32 s34, s34, s39
  s_add_u32 m0, s38, 69632
  s_add_u32 s35, s34, 0
  buffer_load_dwordx4 v7, s[16:19], s35 offen lds
  s_add_u32 m0, s38, 70656
  s_add_u32 s35, s34, 1024
  buffer_load_dwordx4 v7, s[16:19], s35 offen lds
  s_add_u32 m0, s38, 73728
  s_add_u32 s35, s34, 589824
  buffer_load_dwordx4 v7, s[16:19], s35 offen lds
  s_waitcnt vmcnt(16)
  s_barrier
  s_mul_i32 s34, s29, 129024
  s_add_u32 s34, s34, 1032192
  s_add_u32 s34, s34, s33
  s_mul_i32 s35, s29, -36864
  s_add_u32 s35, s35, 36864
  v_mad_u32_u24 v19, v18, s35, v12
  s_add_u32 s35, s35, s34
  s_add_u32 m0, s32, 104448
  s_nop 0
  buffer_load_dwordx4 v8, s[20:23], s34 offen lds
  s_add_u32 m0, s32, 105472
  s_nop 0
  buffer_load_dwordx4 v9, s[20:23], s34 offen lds
  s_add_u32 m0, s32, 106496
  s_nop 0
  buffer_load_dwordx4 v10, s[20:23], s34 offen lds
  s_add_u32 m0, s32, 107520
  s_nop 0
  buffer_load_dwordx4 v11, s[20:23], s34 offen lds
  s_add_u32 m0, s32, 108544
  s_nop 0
  buffer_load_dwordx4 v19, s[20:23], s34 offen lds
  s_mul_i32 s34, s29, 14336
  s_add_u32 s34, s34, 114688
  s_add_u32 s34, s34, s39
  s_add_u32 m0, s38, 104448
  s_add_u32 s35, s34, 0
  buffer_load_dwordx4 v7, s[16:19], s35 offen lds
  s_add_u32 m0, s38, 105472
  s_add_u32 s35, s34, 1024
  buffer_load_dwordx4 v7, s[16:19], s35 offen lds
  s_add_u32 m0, s38, 108544
  s_add_u32 s35, s34, 589824
  buffer_load_dwordx4 v7, s[16:19], s35 offen lds
  s_waitcnt vmcnt(16)
  s_barrier
  s_mul_i32 s34, s29, 55296
  s_add_u32 s34, s34, 1216512
  s_add_u32 s34, s34, s33
  s_mul_i32 s35, s29, 0
  s_add_u32 s35, s35, 0
  v_mad_u32_u24 v19, v18, s35, v12
  s_add_u32 s35, s35, s34
  s_add_u32 m0, s32, 0
  s_nop 0
  buffer_load_dwordx4 v8, s[20:23], s34 offen lds
  s_add_u32 m0, s32, 1024
  s_nop 0
  buffer_load_dwordx4 v9, s[20:23], s34 offen lds
  s_add_u32 m0, s32, 2048
  s_nop 0
  buffer_load_dwordx4 v10, s[20:23], s34 offen lds
  s_add_u32 m0, s32, 3072
  s_nop 0
  buffer_load_dwordx4 v11, s[20:23], s34 offen lds
  s_add_u32 m0, s32, 4096
  s_nop 0
  buffer_load_dwordx4 v19, s[20:23], s34 offen lds
  s_mul_i32 s34, s29, 6144
  s_add_u32 s34, s34, 135168
  s_add_u32 s34, s34, s39
  s_add_u32 m0, s38, 0
  s_add_u32 s35, s34, 0
  buffer_load_dwordx4 v7, s[16:19], s35 offen lds
  s_add_u32 m0, s38, 1024
  s_add_u32 s35, s34, 1024
  buffer_load_dwordx4 v7, s[16:19], s35 offen lds
  s_add_u32 m0, s38, 4096
  s_add_u32 s35, s34, 589824
  buffer_load_dwordx4 v7, s[16:19], s35 offen lds
  s_waitcnt vmcnt(16)
  s_barrier
  s_mul_i32 s34, s29, -55296
  s_add_u32 s34, s34, 1198080
  s_add_u32 s34, s34, s33
  s_mul_i32 s35, s29, 110592
  s_add_u32 s35, s35, 36864
  v_mad_u32_u24 v19, v18, s35, v12
  s_add_u32 s35, s35, s34
  s_add_u32 m0, s32, 34816
  s_nop 0
  buffer_load_dwordx4 v8, s[20:23], s34 offen lds
  s_add_u32 m0, s32, 35840
  s_nop 0
  buffer_load_dwordx4 v9, s[20:23], s34 offen lds
  s_add_u32 m0, s32, 36864
  s_nop 0
  buffer_load_dwordx4 v10, s[20:23], s34 offen lds
  s_add_u32 m0, s32, 37888
  s_nop 0
  buffer_load_dwordx4 v11, s[20:23], s34 offen lds
  s_add_u32 m0, s32, 38912
  s_nop 0
  buffer_load_dwordx4 v19, s[20:23], s34 offen lds
  s_mul_i32 s34, s29, -6144
  s_add_u32 s34, s34, 133120
  s_add_u32 s34, s34, s39
  s_add_u32 m0, s38, 34816
  s_add_u32 s35, s34, 0
  buffer_load_dwordx4 v7, s[16:19], s35 offen lds
  s_add_u32 m0, s38, 35840
  s_add_u32 s35, s34, 1024
  buffer_load_dwordx4 v7, s[16:19], s35 offen lds
  s_add_u32 m0, s38, 38912
  s_add_u32 s35, s34, 589824
  buffer_load_dwordx4 v7, s[16:19], s35 offen lds
  s_waitcnt vmcnt(16)
  s_barrier
  s_waitcnt vmcnt(8)
  s_barrier
  s_waitcnt vmcnt(0)
  s_barrier
  s_barrier
  s_branch k4_fin
k4_load1:
  s_mul_i32 s34, s29, 6144
  s_add_u32 s34, s34, 0
  s_add_u32 s34, s34, s39
  s_add_u32 m0, s38, 5120
  s_add_u32 s35, s34, 590848
  buffer_load_dwordx4 v7, s[16:19], s35 offen lds
  s_mul_i32 s34, s29, 6144
  s_add_u32 s34, s34, 2048
  s_add_u32 s34, s34, s39
  s_add_u32 m0, s38, 2048
  s_add_u32 s35, s34, 0
  buffer_load_dwordx4 v7, s[16:19], s35 offen lds
  s_add_u32 m0, s38, 3072
  s_add_u32 s35, s34, 1024
  buffer_load_dwordx4 v7, s[16:19], s35 offen lds
  s_add_u32 m0, s38, 6144
  s_add_u32 s35, s34, 589824
  buffer_load_dwordx4 v7, s[16:19], s35 offen lds
  s_add_u32 m0, s38, 7168
  s_add_u32 s35, s34, 590848
  buffer_load_dwordx4 v7, s[16:19], s35 offen lds
  v_add_u32 v20, 320, v0
  v_mul_u32_u24 v21, 3641, v20
  v_lshrrev_b32 v21, 16, v21
  v_mul_u32_u24 v22, 18, v21
  v_sub_u32 v22, v20, v22
  v_mul_u32_u24 v21, 1152, v21
  v_lshl_add_u32 v21, v22, 4, v21
  v_add_u32 v13, s37, v21
  v_add_u32 v20, 384, v0
  v_mul_u32_u24 v21, 3641, v20
  v_lshrrev_b32 v21, 16, v21
  v_mul_u32_u24 v22, 18, v21
  v_sub_u32 v22, v20, v22
  v_mul_u32_u24 v21, 1152, v21
  v_lshl_add_u32 v21, v22, 4, v21
  v_add_u32 v14, s37, v21
  v_add_u32 v20, 448, v0
  v_mul_u32_u24 v21, 3641, v20
  v_lshrrev_b32 v21, 16, v21
  v_mul_u32_u24 v22, 18, v21
  v_sub_u32 v22, v20, v22
  v_mul_u32_u24 v21, 1152, v21
  v_lshl_add_u32 v21, v22, 4, v21
  v_add_u32 v15, s37, v21
  v_add_u32 v20, 512, v0
  v_mul_u32_u24 v21, 3641, v20
  v_lshrrev_b32 v21, 16, v21
  v_mul_u32_u24 v22, 18, v21
  v_sub_u32 v22, v20, v22
  v_mul_u32_u24 v21, 1152, v21
  v_lshl_add_u32 v21, v22, 4, v21
  v_add_u32 v16, s37, v21
  s_mul_i32 s34, s29, 55296
  s_add_u32 s34, s34, 0
  s_add_u32 s34, s34, s33
  s_mul_i32 s35, s29, 0
  s_add_u32 s35, s35, 0
  s_add_u32 s35, s35, s34
  s_add_u32 m0, s32, 5120
  s_nop 0
  buffer_load_dwordx4 v13, s[20:23], s35 offen lds
  s_add_u32 m0, s32, 6144
  s_nop 0
  buffer_load_dwordx4 v14, s[20:23], s35 offen lds
  s_add_u32 m0, s32, 7168
  s_nop 0
  buffer_load_dwordx4 v15, s[20:23], s35 offen lds
  s_add_u32 m0, s32, 8192
  s_nop 0
  buffer_load_dwordx4 v16, s[20:23], s35 offen lds
  s_mul_i32 s34, s29, -73728
  s_add_u32 s34, s34, 110592
  s_add_u32 s34, s34, s33
  s_mul_i32 s35, s29, 36864
  s_add_u32 s35, s35, 0
  s_add_u32 s35, s35, s34
  s_add_u32 m0, s32, 39936
  s_nop 0
  buffer_load_dwordx4 v13, s[20:23], s35 offen lds
  s_add_u32 m0, s32, 40960
  s_nop 0
  buffer_load_dwordx4 v14, s[20:23], s35 offen lds
  s_add_u32 m0, s32, 41984
  s_nop 0
  buffer_load_dwordx4 v15, s[20:23], s35 offen lds
  s_add_u32 m0, s32, 43008
  s_nop 0
  buffer_load_dwordx4 v16, s[20:23], s35 offen lds
  s_mul_i32 s34, s29, -8192
  s_add_u32 s34, s34, 12288
  s_add_u32 s34, s34, s39
  s_add_u32 m0, s38, 39936
  s_add_u32 s35, s34, 590848
  buffer_load_dwordx4 v7, s[16:19], s35 offen lds
  s_mul_i32 s34, s29, -4096
  s_add_u32 s34, s34, 14336
  s_add_u32 s34, s34, s39
  s_add_u32 m0, s38, 36864
  s_add_u32 s35, s34, 0
  buffer_load_dwordx4 v7, s[16:19], s35 offen lds
  s_add_u32 m0, s38, 37888
  s_add_u32 s35, s34, 1024
  buffer_load_dwordx4 v7, s[16:19], s35 offen lds
  s_add_u32 m0, s38, 40960
  s_add_u32 s35, s34, 589824
  buffer_load_dwordx4 v7, s[16:19], s35 offen lds
  s_add_u32 m0, s38, 41984
  s_add_u32 s35, s34, 590848
  buffer_load_dwordx4 v7, s[16:19], s35 offen lds
  s_waitcnt vmcnt(9)
  s_barrier
  s_mul_i32 s34, s29, 55296
  s_add_u32 s34, s34, 165888
  s_add_u32 s34, s34, s33
  s_mul_i32 s35, s29, 0
  s_add_u32 s35, s35, 0
  s_add_u32 s35, s35, s34
  s_add_u32 m0, s32, 74752
  s_nop 0
  buffer_load_dwordx4 v13, s[20:23], s35 offen lds
  s_add_u32 m0, s32, 75776
  s_nop 0
  buffer_load_dwordx4 v14, s[20:23], s35 offen lds
  s_add_u32 m0, s32, 76800
  s_nop 0
  buffer_load_dwordx4 v15, s[20:23], s35 offen lds
  s_add_u32 m0, s32, 77824
  s_nop 0
  buffer_load_dwordx4 v16, s[20:23], s35 offen lds
  s_mul_i32 s34, s29, 6144
  s_add_u32 s34, s34, 18432
  s_add_u32 s34, s34, s39
  s_add_u32 m0, s38, 74752
  s_add_u32 s35, s34, 590848
  buffer_load_dwordx4 v7, s[16:19], s35 offen lds
  s_mul_i32 s34, s29, 6144
  s_add_u32 s34, s34, 20480
  s_add_u32 s34, s34, s39
  s_add_u32 m0, s38, 71680
  s_add_u32 s35, s34, 0
  buffer_load_dwordx4 v7, s[16:19], s35 offen lds
  s_add_u32 m0, s38, 72704
  s_add_u32 s35, s34, 1024
  buffer_load_dwordx4 v7, s[16:19], s35 offen lds
  s_add_u32 m0, s38, 75776
  s_add_u32 s35, s34, 589824
  buffer_load_dwordx4 v7, s[16:19], s35 offen lds
  s_add_u32 m0, s38, 76800
  s_add_u32 s35, s34, 590848
  buffer_load_dwordx4 v7, s[16:19], s35 offen lds
  s_waitcnt vmcnt(9)
  s_barrier
  s_mul_i32 s34, s29, -73728
  s_add_u32 s34, s34, 276480
  s_add_u32 s34, s34, s33
  s_mul_i32 s35, s29, 36864
  s_add_u32 s35, s35, 0
  s_add_u32 s35, s35, s34
  s_add_u32 m0, s32, 109568
  s_nop 0
  buffer_load_dwordx4 v13, s[20:23], s35 offen lds
  s_add_u32 m0, s32, 110592
  s_nop 0
  buffer_load_dwordx4 v14, s[20:23], s35 offen lds
  s_add_u32 m0, s32, 111616
  s_nop 0
  buffer_load_dwordx4 v15, s[20:23], s35 offen lds
  s_add_u32 m0, s32, 112640
  s_nop 0
  buffer_load_dwordx4 v16, s[20:23], s35 offen lds
  s_mul_i32 s34, s29, -8192
  s_add_u32 s34, s34, 30720
  s_add_u32 s34, s34, s39
  s_add_u32 m0, s38, 109568
  s_add_u32 s35, s34, 590848
  buffer_load_dwordx4 v7, s[16:19], s35 offen lds
  s_mul_i32 s34, s29, -4096
  s_add_u32 s34, s34, 32768
  s_add_u32 s34, s34, s39
  s_add_u32 m0, s38, 106496
  s_add_u32 s35, s34, 0
  buffer_load_dwordx4 v7, s[16:19], s35 offen lds
  s_add_u32 m0, s38, 107520
  s_add_u32 s35, s34, 1024
  buffer_load_dwordx4 v7, s[16:19], s35 offen lds
  s_add_u32 m0, s38, 110592
  s_add_u32 s35, s34, 589824
  buffer_load_dwordx4 v7, s[16:19], s35 offen lds
  s_add_u32 m0, s38, 111616
  s_add_u32 s35, s34, 590848
  buffer_load_dwordx4 v7, s[16:19], s35 offen lds
  s_mul_i32 s34, s29, 184320
  s_add_u32 s34, s34, 147456
  s_add_u32 s34, s34, s33
  s_mul_i32 s35, s29, -147456
  s_add_u32 s35, s35, 147456
  s_add_u32 s35, s35, s34
  s_add_u32 m0, s32, 5120
  s_nop 0
  buffer_load_dwordx4 v13, s[20:23], s35 offen lds
  s_add_u32 m0, s32, 6144
  s_nop 0
  buffer_load_dwordx4 v14, s[20:23], s35 offen lds
  s_add_u32 m0, s32, 7168
  s_nop 0
  buffer_load_dwordx4 v15, s[20:23], s35 offen lds
  s_add_u32 m0, s32, 8192
  s_nop 0
  buffer_load_dwordx4 v16, s[20:23], s35 offen lds
  s_mul_i32 s34, s29, 20480
  s_add_u32 s34, s34, 16384
  s_add_u32 s34, s34, s39
  s_add_u32 m0, s38, 5120
  s_add_u32 s35, s34, 590848
  buffer_load_dwordx4 v7, s[16:19], s35 offen lds
  s_mul_i32 s34, s29, 4096
  s_add_u32 s34, s34, 34816
  s_add_u32 s34, s34, s39
  s_add_u32 m0, s38, 2048
  s_add_u32 s35, s34, 0
  buffer_load_dwordx4 v7, s[16:19], s35 offen lds
  s_add_u32 m0, s38, 3072
  s_add_u32 s35, s34, 1024
  buffer_load_dwordx4 v7, s[16:19], s35 offen lds
  s_add_u32 m0, s38, 6144
  s_add_u32 s35, s34, 589824
  buffer_load_dwordx4 v7, s[16:19], s35 offen lds
  s_add_u32 m0, s38, 7168
  s_add_u32 s35, s34, 590848
  buffer_load_dwordx4 v7, s[16:19], s35 offen lds
  s_waitcnt vmcnt(18)
  s_barrier
  s_mul_i32 s34, s29, 55296
  s_add_u32 s34, s34, 387072
  s_add_u32 s34, s34, s33
  s_mul_i32 s35, s29, 0
  s_add_u32 s35, s35, 0
  s_add_u32 s35, s35, s34
  s_add_u32 m0, s32, 39936
  s_nop 0
  buffer_load_dwordx4 v13, s[20:23], s35 offen lds
  s_add_u32 m0, s32, 40960
  s_nop 0
  buffer_load_dwordx4 v14, s[20:23], s35 offen lds
  s_add_u32 m0, s32, 41984
  s_nop 0
  buffer_load_dwordx4 v15, s[20:23], s35 offen lds
  s_add_u32 m0, s32, 43008
  s_nop 0
  buffer_load_dwordx4 v16, s[20:23], s35 offen lds
  s_mul_i32 s34, s29, 6144
  s_add_u32 s34, s34, 43008
  s_add_u32 s34, s34, s39
  s_add_u32 m0, s38, 39936
  s_add_u32 s35, s34, 590848
  buffer_load_dwordx4 v7, s[16:19], s35 offen lds
  s_mul_i32 s34, s29, 6144
  s_add_u32 s34, s34, 45056
  s_add_u32 s34, s34, s39
  s_add_u32 m0, s38, 36864
  s_add_u32 s35, s34, 0
  buffer_load_dwordx4 v7, s[16:19], s35 offen lds
  s_add_u32 m0, s38, 37888
  s_add_u32 s35, s34, 1024
  buffer_load_dwordx4 v7, s[16:19], s35 offen lds
  s_add_u32 m0, s38, 40960
  s_add_u32 s35, s34, 589824
  buffer_load_dwordx4 v7, s[16:19], s35 offen lds
  s_add_u32 m0, s38, 41984
  s_add_u32 s35, s34, 590848
  buffer_load_dwordx4 v7, s[16:19], s35 offen lds
  s_waitcnt vmcnt(18)
  s_barrier
  s_mul_i32 s34, s29, 129024
  s_add_u32 s34, s34, 368640
  s_add_u32 s34, s34, s33
  s_mul_i32 s35, s29, -36864
  s_add_u32 s35, s35, 36864
  s_add_u32 s35, s35, s34
  s_add_u32 m0, s32, 74752
  s_nop 0
  buffer_load_dwordx4 v13, s[20:23], s35 offen lds
  s_add_u32 m0, s32, 75776
  s_nop 0
  buffer_load_dwordx4 v14, s[20:23], s35 offen lds
  s_add_u32 m0, s32, 76800
  s_nop 0
  buffer_load_dwordx4 v15, s[20:23], s35 offen lds
  s_add_u32 m0, s32, 77824
  s_nop 0
  buffer_load_dwordx4 v16, s[20:23], s35 offen lds
  s_mul_i32 s34, s29, 14336
  s_add_u32 s34, s34, 40960
  s_add_u32 s34, s34, s39
  s_add_u32 m0, s38, 74752
  s_add_u32 s35, s34, 590848
  buffer_load_dwordx4 v7, s[16:19], s35 offen lds
  s_mul_i32 s34, s29, 10240
  s_add_u32 s34, s34, 47104
  s_add_u32 s34, s34, s39
  s_add_u32 m0, s38, 71680
  s_add_u32 s35, s34, 0
  buffer_load_dwordx4 v7, s[16:19], s35 offen lds
  s_add_u32 m0, s38, 72704
  s_add_u32 s35, s34, 1024
  buffer_load_dwordx4 v7, s[16:19], s35 offen lds
  s_add_u32 m0, s38, 75776
  s_add_u32 s35, s34, 589824
  buffer_load_dwordx4 v7, s[16:19], s35 offen lds
  s_add_u32 m0, s38, 76800
  s_add_u32 s35, s34, 590848
  buffer_load_dwordx4 v7, s[16:19], s35 offen lds
  s_waitcnt vmcnt(18)
  s_barrier
  s_mul_i32 s34, s29, 55296
  s_add_u32 s34, s34, 552960
  s_add_u32 s34, s34, s33
  s_mul_i32 s35, s29, 0
  s_add_u32 s35, s35, 0
  s_add_u32 s35, s35, s34
  s_add_u32 m0, s32, 109568
  s_nop 0
  buffer_load_dwordx4 v13, s[20:23], s35 offen lds
  s_add_u32 m0, s32, 110592
  s_nop 0
  buffer_load_dwordx4 v14, s[20:23], s35 offen lds
  s_add_u32 m0, s32, 111616
  s_nop 0
  buffer_load_dwordx4 v15, s[20:23], s35 offen lds
  s_add_u32 m0, s32, 112640
  s_nop 0
  buffer_load_dwordx4 v16, s[20:23], s35 offen lds
  s_mul_i32 s34, s29, 6144
  s_add_u32 s34, s34, 61440
  s_add_u32 s34, s34, s39
  s_add_u32 m0, s38, 109568
  s_add_u32 s35, s34, 590848
  buffer_load_dwordx4 v7, s[16:19], s35 offen lds
  s_mul_i32 s34, s29, 6144
  s_add_u32 s34, s34, 63488
  s_add_u32 s34, s34, s39
  s_add_u32 m0, s38, 106496
  s_add_u32 s35, s34, 0
  buffer_load_dwordx4 v7, s[16:19], s35 offen lds
  s_add_u32 m0, s38, 107520
  s_add_u32 s35, s34, 1024
  buffer_load_dwordx4 v7, s[16:19], s35 offen lds
  s_add_u32 m0, s38, 110592
  s_add_u32 s35, s34, 589824
  buffer_load_dwordx4 v7, s[16:19], s35 offen lds
  s_add_u32 m0, s38, 111616
  s_add_u32 s35, s34, 590848
  buffer_load_dwordx4 v7, s[16:19], s35 offen lds
  s_waitcnt vmcnt(18)
  s_barrier
  s_mul_i32 s34, s29, -55296
  s_add_u32 s34, s34, 534528
  s_add_u32 s34, s34, s33
  s_mul_i32 s35, s29, 110592
  s_add_u32 s35, s35, 36864
  s_add_u32 s35, s35, s34
  s_add_u32 m0, s32, 5120
  s_nop 0
  buffer_load_dwordx4 v13, s[20:23], s35 offen lds
  s_add_u32 m0, s32, 6144
  s_nop 0
  buffer_load_dwordx4 v14, s[20:23], s35 offen lds
  s_add_u32 m0, s32, 7168
  s_nop 0
  buffer_load_dwordx4 v15, s[20:23], s35 offen lds
  s_add_u32 m0, s32, 8192
  s_nop 0
  buffer_load_dwordx4 v16, s[20:23], s35 offen lds
  s_mul_i32 s34, s29, -6144
  s_add_u32 s34, s34, 59392
  s_add_u32 s34, s34, s39
  s_add_u32 m0, s38, 5120
  s_add_u32 s35, s34, 590848
  buffer_load_dwordx4 v7, s[16:19], s35 offen lds
  s_mul_i32 s34, s29, 6144
  s_add_u32 s34, s34, 65536
  s_add_u32 s34, s34, s39
  s_add_u32 m0, s38, 2048
  s_add_u32 s35, s34, 0
  buffer_load_dwordx4 v7, s[16:19], s35 offen lds
  s_add_u32 m0, s38, 3072
  s_add_u32 s35, s34, 1024
  buffer_load_dwordx4 v7, s[16:19], s35 offen lds
  s_add_u32 m0, s38, 6144
  s_add_u32 s35, s34, 589824
  buffer_load_dwordx4 v7, s[16:19], s35 offen lds
  s_add_u32 m0, s38, 7168
  s_add_u32 s35, s34, 590848
  buffer_load_dwordx4 v7, s[16:19], s35 offen lds
  s_waitcnt vmcnt(18)
  s_barrier
  s_mul_i32 s34, s29, 55296
  s_add_u32 s34, s34, 663552
  s_add_u32 s34, s34, s33
  s_mul_i32 s35, s29, 0
  s_add_u32 s35, s35, 0
  s_add_u32 s35, s35, s34
  s_add_u32 m0, s32, 39936
  s_nop 0
  buffer_load_dwordx4 v13, s[20:23], s35 offen lds
  s_add_u32 m0, s32, 40960
  s_nop 0
  buffer_load_dwordx4 v14, s[20:23], s35 offen lds
  s_add_u32 m0, s32, 41984
  s_nop 0
  buffer_load_dwordx4 v15, s[20:23], s35 offen lds
  s_add_u32 m0, s32, 43008
  s_nop 0
  buffer_load_dwordx4 v16, s[20:23], s35 offen lds
  s_mul_i32 s34, s29, 6144
  s_add_u32 s34, s34, 73728
  s_add_u32 s34, s34, s39
  s_add_u32 m0, s38, 39936
  s_add_u32 s35, s34, 590848
  buffer_load_dwordx4 v7, s[16:19], s35 offen lds
  s_mul_i32 s34, s29, 6144
  s_add_u32 s34, s34, 75776
  s_add_u32 s34, s34, s39
  s_add_u32 m0, s38, 36864
  s_add_u32 s35, s34, 0
  buffer_load_dwordx4 v7, s[16:19], s35 offen lds
  s_add_u32 m0, s38, 37888
  s_add_u32 s35, s34, 1024
  buffer_load_dwordx4 v7, s[16:19], s35 offen lds
  s_add_u32 m0, s38, 40960
  s_add_u32 s35, s34, 589824
  buffer_load_dwordx4 v7, s[16:19], s35 offen lds
  s_add_u32 m0, s38, 41984
  s_add_u32 s35, s34, 590848
  buffer_load_dwordx4 v7, s[16:19], s35 offen lds
  s_waitcnt vmcnt(18)
  s_barrier
  s_mul_i32 s34, s29, -73728
  s_add_u32 s34, s34, 774144
  s_add_u32 s34, s34, s33
  s_mul_i32 s35, s29, 36864
  s_add_u32 s35, s35, 0
  s_add_u32 s35, s35, s34
  s_add_u32 m0, s32, 74752
  s_nop 0
  buffer_load_dwordx4 v13, s[20:23], s35 offen lds
  s_add_u32 m0, s32, 75776
  s_nop 0
  buffer_load_dwordx4 v14, s[20:23], s35 offen lds
  s_add_u32 m0, s32, 76800
  s_nop 0
  buffer_load_dwordx4 v15, s[20:23], s35 offen lds
  s_add_u32 m0, s32, 77824
  s_nop 0
  buffer_load_dwordx4 v16, s[20:23], s35 offen lds
  s_mul_i32 s34, s29, -8192
  s_add_u32 s34, s34, 86016
  s_add_u32 s34, s34, s39
  s_add_u32 m0, s38, 74752
  s_add_u32 s35, s34, 590848
  buffer_load_dwordx4 v7, s[16:19], s35 offen lds
  s_mul_i32 s34, s29, -4096
  s_add_u32 s34, s34, 88064
  s_add_u32 s34, s34, s39
  s_add_u32 m0, s38, 71680
  s_add_u32 s35, s34, 0
  buffer_load_dwordx4 v7, s[16:19], s35 offen lds
  s_add_u32 m0, s38, 72704
  s_add_u32 s35, s34, 1024
  buffer_load_dwordx4 v7, s[16:19], s35 offen lds
  s_add_u32 m0, s38, 75776
  s_add_u32 s35, s34, 589824
  buffer_load_dwordx4 v7, s[16:19], s35 offen lds
  s_add_u32 m0, s38, 76800
  s_add_u32 s35, s34, 590848
  buffer_load_dwordx4 v7, s[16:19], s35 offen lds
  s_waitcnt vmcnt(18)
  s_barrier
  s_mul_i32 s34, s29, 55296
  s_add_u32 s34, s34, 829440
  s_add_u32 s34, s34, s33
  s_mul_i32 s35, s29, 0
  s_add_u32 s35, s35, 0
  s_add_u32 s35, s35, s34
  s_add_u32 m0, s32, 109568
  s_nop 0
  buffer_load_dwordx4 v13, s[20:23], s35 offen lds
  s_add_u32 m0, s32, 110592
  s_nop 0
  buffer_load_dwordx4 v14, s[20:23], s35 offen lds
  s_add_u32 m0, s32, 111616
  s_nop 0
  buffer_load_dwordx4 v15, s[20:23], s35 offen lds
  s_add_u32 m0, s32, 112640
  s_nop 0
  buffer_load_dwordx4 v16, s[20:23], s35 offen lds
  s_mul_i32 s34, s29, 6144
  s_add_u32 s34, s34, 92160
  s_add_u32 s34, s34, s39
  s_add_u32 m0, s38, 109568
  s_add_u32 s35, s34, 590848
  buffer_load_dwordx4 v7, s[16:19], s35 offen lds
  s_mul_i32 s34, s29, 6144
  s_add_u32 s34, s34, 94208
  s_add_u32 s34, s34, s39
  s_add_u32 m0, s38, 106496
  s_add_u32 s35, s34, 0
  buffer_load_dwordx4 v7, s[16:19], s35 offen lds
  s_add_u32 m0, s38, 107520
  s_add_u32 s35, s34, 1024
  buffer_load_dwordx4 v7, s[16:19], s35 offen lds
  s_add_u32 m0, s38, 110592
  s_add_u32 s35, s34, 589824
  buffer_load_dwordx4 v7, s[16:19], s35 offen lds
  s_add_u32 m0, s38, 111616
  s_add_u32 s35, s34, 590848
  buffer_load_dwordx4 v7, s[16:19], s35 offen lds
  s_waitcnt vmcnt(18)
  s_barrier
  s_mul_i32 s34, s29, -73728
  s_add_u32 s34, s34, 940032
  s_add_u32 s34, s34, s33
  s_mul_i32 s35, s29, 36864
  s_add_u32 s35, s35, 0
  s_add_u32 s35, s35, s34
  s_add_u32 m0, s32, 5120
  s_nop 0
  buffer_load_dwordx4 v13, s[20:23], s35 offen lds
  s_add_u32 m0, s32, 6144
  s_nop 0
  buffer_load_dwordx4 v14, s[20:23], s35 offen lds
  s_add_u32 m0, s32, 7168
  s_nop 0
  buffer_load_dwordx4 v15, s[20:23], s35 offen lds
  s_add_u32 m0, s32, 8192
  s_nop 0
  buffer_load_dwordx4 v16, s[20:23], s35 offen lds
  s_mul_i32 s34, s29, -8192
  s_add_u32 s34, s34, 104448
  s_add_u32 s34, s34, s39
  s_add_u32 m0, s38, 5120
  s_add_u32 s35, s34, 590848
  buffer_load_dwordx4 v7, s[16:19], s35 offen lds
  s_mul_i32 s34, s29, -4096
  s_add_u32 s34, s34, 106496
  s_add_u32 s34, s34, s39
  s_add_u32 m0, s38, 2048
  s_add_u32 s35, s34, 0
  buffer_load_dwordx4 v7, s[16:19], s35 offen lds
  s_add_u32 m0, s38, 3072
  s_add_u32 s35, s34, 1024
  buffer_load_dwordx4 v7, s[16:19], s35 offen lds
  s_add_u32 m0, s38, 6144
  s_add_u32 s35, s34, 589824
  buffer_load_dwordx4 v7, s[16:19], s35 offen lds
  s_add_u32 m0, s38, 7168
  s_add_u32 s35, s34, 590848
  buffer_load_dwordx4 v7, s[16:19], s35 offen lds
  s_waitcnt vmcnt(18)
  s_barrier
  s_mul_i32 s34, s29, 184320
  s_add_u32 s34, s34, 811008
  s_add_u32 s34, s34, s33
  s_mul_i32 s35, s29, -147456
  s_add_u32 s35, s35, 147456
  s_add_u32 s35, s35, s34
  s_add_u32 m0, s32, 39936
  s_nop 0
  buffer_load_dwordx4 v13, s[20:23], s35 offen lds
  s_add_u32 m0, s32, 40960
  s_nop 0
  buffer_load_dwordx4 v14, s[20:23], s35 offen lds
  s_add_u32 m0, s32, 41984
  s_nop 0
  buffer_load_dwordx4 v15, s[20:23], s35 offen lds
  s_add_u32 m0, s32, 43008
  s_nop 0
  buffer_load_dwordx4 v16, s[20:23], s35 offen lds
  s_mul_i32 s34, s29, 20480
  s_add_u32 s34, s34, 90112
  s_add_u32 s34, s34, s39
  s_add_u32 m0, s38, 39936
  s_add_u32 s35, s34, 590848
  buffer_load_dwordx4 v7, s[16:19], s35 offen lds
  s_mul_i32 s34, s29, 4096
  s_add_u32 s34, s34, 108544
  s_add_u32 s34, s34, s39
  s_add_u32 m0, s38, 36864
  s_add_u32 s35, s34, 0
  buffer_load_dwordx4 v7, s[16:19], s35 offen lds
  s_add_u32 m0, s38, 37888
  s_add_u32 s35, s34, 1024
  buffer_load_dwordx4 v7, s[16:19], s35 offen lds
  s_add_u32 m0, s38, 40960
  s_add_u32 s35, s34, 589824
  buffer_load_dwordx4 v7, s[16:19], s35 offen lds
  s_add_u32 m0, s38, 41984
  s_add_u32 s35, s34, 590848
  buffer_load_dwordx4 v7, s[16:19], s35 offen lds
  s_waitcnt vmcnt(18)
  s_barrier
  s_mul_i32 s34, s29, 55296
  s_add_u32 s34, s34, 1050624
  s_add_u32 s34, s34, s33
  s_mul_i32 s35, s29, 0
  s_add_u32 s35, s35, 0
  s_add_u32 s35, s35, s34
  s_add_u32 m0, s32, 74752
  s_nop 0
  buffer_load_dwordx4 v13, s[20:23], s35 offen lds
  s_add_u32 m0, s32, 75776
  s_nop 0
  buffer_load_dwordx4 v14, s[20:23], s35 offen lds
  s_add_u32 m0, s32, 76800
  s_nop 0
  buffer_load_dwordx4 v15, s[20:23], s35 offen lds
  s_add_u32 m0, s32, 77824
  s_nop 0
  buffer_load_dwordx4 v16, s[20:23], s35 offen lds
  s_mul_i32 s34, s29, 6144
  s_add_u32 s34, s34, 116736
  s_add_u32 s34, s34, s39
  s_add_u32 m0, s38, 74752
  s_add_u32 s35, s34, 590848
  buffer_load_dwordx4 v7, s[16:19], s35 offen lds
  s_mul_i32 s34, s29, 6144
  s_add_u32 s34, s34, 118784
  s_add_u32 s34, s34, s39
  s_add_u32 m0, s38, 71680
  s_add_u32 s35, s34, 0
  buffer_load_dwordx4 v7, s[16:19], s35 offen lds
  s_add_u32 m0, s38, 72704
  s_add_u32 s35, s34, 1024
  buffer_load_dwordx4 v7, s[16:19], s35 offen lds
  s_add_u32 m0, s38, 75776
  s_add_u32 s35, s34, 589824
  buffer_load_dwordx4 v7, s[16:19], s35 offen lds
  s_add_u32 m0, s38, 76800
  s_add_u32 s35, s34, 590848
  buffer_load_dwordx4 v7, s[16:19], s35 offen lds
  s_waitcnt vmcnt(18)
  s_barrier
  s_mul_i32 s34, s29, 129024
  s_add_u32 s34, s34, 1032192
  s_add_u32 s34, s34, s33
  s_mul_i32 s35, s29, -36864
  s_add_u32 s35, s35, 36864
  s_add_u32 s35, s35, s34
  s_add_u32 m0, s32, 109568
  s_nop 0
  buffer_load_dwordx4 v13, s[20:23], s35 offen lds
  s_add_u32 m0, s32, 110592
  s_nop 0
  buffer_load_dwordx4 v14, s[20:23], s35 offen lds
  s_add_u32 m0, s32, 111616
  s_nop 0
  buffer_load_dwordx4 v15, s[20:23], s35 offen lds
  s_add_u32 m0, s32, 112640
  s_nop 0
  buffer_load_dwordx4 v16, s[20:23], s35 offen lds
  s_mul_i32 s34, s29, 14336
  s_add_u32 s34, s34, 114688
  s_add_u32 s34, s34, s39
  s_add_u32 m0, s38, 109568
  s_add_u32 s35, s34, 590848
  buffer_load_dwordx4 v7, s[16:19], s35 offen lds
  s_mul_i32 s34, s29, 10240
  s_add_u32 s34, s34, 120832
  s_add_u32 s34, s34, s39
  s_add_u32 m0, s38, 106496
  s_add_u32 s35, s34, 0
  buffer_load_dwordx4 v7, s[16:19], s35 offen lds
  s_add_u32 m0, s38, 107520
  s_add_u32 s35, s34, 1024
  buffer_load_dwordx4 v7, s[16:19], s35 offen lds
  s_add_u32 m0, s38, 110592
  s_add_u32 s35, s34, 589824
  buffer_load_dwordx4 v7, s[16:19], s35 offen lds
  s_add_u32 m0, s38, 111616
  s_add_u32 s35, s34, 590848
  buffer_load_dwordx4 v7, s[16:19], s35 offen lds
  s_waitcnt vmcnt(18)
  s_barrier
  s_mul_i32 s34, s29, 55296
  s_add_u32 s34, s34, 1216512
  s_add_u32 s34, s34, s33
  s_mul_i32 s35, s29, 0
  s_add_u32 s35, s35, 0
  s_add_u32 s35, s35, s34
  s_add_u32 m0, s32, 5120
  s_nop 0
  buffer_load_dwordx4 v13, s[20:23], s35 offen lds
  s_add_u32 m0, s32, 6144
  s_nop 0
  buffer_load_dwordx4 v14, s[20:23], s35 offen lds
  s_add_u32 m0, s32, 7168
  s_nop 0
  buffer_load_dwordx4 v15, s[20:23], s35 offen lds
  s_add_u32 m0, s32, 8192
  s_nop 0
  buffer_load_dwordx4 v16, s[20:23], s35 offen lds
  s_mul_i32 s34, s29, 6144
  s_add_u32 s34, s34, 135168
  s_add_u32 s34, s34, s39
  s_add_u32 m0, s38, 5120
  s_add_u32 s35, s34, 590848
  buffer_load_dwordx4 v7, s[16:19], s35 offen lds
  s_mul_i32 s34, s29, 6144
  s_add_u32 s34, s34, 137216
  s_add_u32 s34, s34, s39
  s_add_u32 m0, s38, 2048
  s_add_u32 s35, s34, 0
  buffer_load_dwordx4 v7, s[16:19], s35 offen lds
  s_add_u32 m0, s38, 3072
  s_add_u32 s35, s34, 1024
  buffer_load_dwordx4 v7, s[16:19], s35 offen lds
  s_add_u32 m0, s38, 6144
  s_add_u32 s35, s34, 589824
  buffer_load_dwordx4 v7, s[16:19], s35 offen lds
  s_add_u32 m0, s38, 7168
  s_add_u32 s35, s34, 590848
  buffer_load_dwordx4 v7, s[16:19], s35 offen lds
  s_waitcnt vmcnt(18)
  s_barrier
  s_mul_i32 s34, s29, -55296
  s_add_u32 s34, s34, 1198080
  s_add_u32 s34, s34, s33
  s_mul_i32 s35, s29, 110592
  s_add_u32 s35, s35, 36864
  s_add_u32 s35, s35, s34
  s_add_u32 m0, s32, 39936
  s_nop 0
  buffer_load_dwordx4 v13, s[20:23], s35 offen lds
  s_add_u32 m0, s32, 40960
  s_nop 0
  buffer_load_dwordx4 v14, s[20:23], s35 offen lds
  s_add_u32 m0, s32, 41984
  s_nop 0
  buffer_load_dwordx4 v15, s[20:23], s35 offen lds
  s_add_u32 m0, s32, 43008
  s_nop 0
  buffer_load_dwordx4 v16, s[20:23], s35 offen lds
  s_mul_i32 s34, s29, -6144
  s_add_u32 s34, s34, 133120
  s_add_u32 s34, s34, s39
  s_add_u32 m0, s38, 39936
  s_add_u32 s35, s34, 590848
  buffer_load_dwordx4 v7, s[16:19], s35 offen lds
  s_mul_i32 s34, s29, 6144
  s_add_u32 s34, s34, 139264
  s_add_u32 s34, s34, s39
  s_add_u32 m0, s38, 36864
  s_add_u32 s35, s34, 0
  buffer_load_dwordx4 v7, s[16:19], s35 offen lds
  s_add_u32 m0, s38, 37888
  s_add_u32 s35, s34, 1024
  buffer_load_dwordx4 v7, s[16:19], s35 offen lds
  s_add_u32 m0, s38, 40960
  s_add_u32 s35, s34, 589824
  buffer_load_dwordx4 v7, s[16:19], s35 offen lds
  s_add_u32 m0, s38, 41984
  s_add_u32 s35, s34, 590848
  buffer_load_dwordx4 v7, s[16:19], s35 offen lds
  s_waitcnt vmcnt(18)
  s_barrier
  s_waitcnt vmcnt(9)
  s_barrier
  s_waitcnt vmcnt(0)
  s_barrier
  s_barrier
  s_branch k4_fin
k4_compute:
  v_lshrrev_b32 v5, 2, v0
  v_mul_u32_u24 v5, 288, v5
  v_and_b32 v6, 3, v0
  v_lshl_add_u32 v5, v6, 3, v5
  s_mul_i32 s34, s15, 9216
  v_add_u32 v1, s34, v5
  v_add_u32 v2, 69632, v1
  s_lshl_b32 s34, s15, 13
  s_lshr_b32 s35, s28, 1
  s_lshl_b32 s35, s35, 12
  s_add_u32 s34, s34, s35
  s_and_b32 s35, s28, 1
  s_lshl_b32 s35, s35, 10
  s_add_u32 s34, s34, s35
  s_add_u32 s34, s34, 18432
  v_lshl_add_u32 v3, v0, 4, s34
  v_add_u32 v4, 69632, v3
  v_add_u32 v5, s35, v3
  v_add_u32 v6, s35, v4
  s_waitcnt lgkmcnt(0)
  s_barrier
  ds_read_b128 v[152:155], v5 offset:0
  ds_read_b128 v[156:159], v5 offset:1024
  s_nop 0
  s_nop 0
  ds_read_b64_tr_b16 v[80:81], v1 offset:0
  ds_read_b64_tr_b16 v[82:83], v1 offset:4608
  ds_read_b64_tr_b16 v[84:85], v1 offset:32
  ds_read_b64_tr_b16 v[86:87], v1 offset:4640
  ds_read_b64_tr_b16 v[88:89], v1 offset:64
  ds_read_b64_tr_b16 v[90:91], v1 offset:4672
  ds_read_b64_tr_b16 v[92:93], v1 offset:96
  ds_read_b64_tr_b16 v[94:95], v1 offset:4704
  ds_read_b64_tr_b16 v[96:97], v1 offset:128
  ds_read_b64_tr_b16 v[98:99], v1 offset:4736
  ds_read_b64_tr_b16 v[100:101], v1 offset:160
  ds_read_b64_tr_b16 v[102:103], v1 offset:4768
  ds_read_b64_tr_b16 v[104:105], v1 offset:192
  ds_read_b64_tr_b16 v[106:107], v1 offset:4800
  ds_read_b64_tr_b16 v[108:109], v1 offset:224
  ds_read_b64_tr_b16 v[110:111], v1 offset:4832
  ds_read_b64_tr_b16 v[112:113], v1 offset:256
  ds_read_b64_tr_b16 v[114:115], v1 offset:4864
  s_waitcnt lgkmcnt(0)
  s_barrier
  s_cmp_eq_u32 s15, 0
  s_cbranch_scc0 k4_a1
  ds_read_b128 v[160:163], v5 offset:34816
  ds_read_b128 v[164:167], v5 offset:35840
  s_nop 0
  s_nop 0
  s_branch k4_b2
k4_a1:
  ds_read_b64 v[160:161], v3 offset:34816
  ds_read_b64 v[162:163], v3 offset:36864
  ds_read_b64 v[164:165], v3 offset:34824
  ds_read_b64 v[166:167], v3 offset:36872
k4_b2:
  ds_read_b64_tr_b16 v[116:117], v1 offset:34816
  ds_read_b64_tr_b16 v[118:119], v1 offset:39424
  v_mfma_f32_16x16x32_bf16 v[8:11], v[80:83], v[152:155], 0
  v_mfma_f32_16x16x32_bf16 v[44:47], v[80:83], v[156:159], 0
  ds_read_b64_tr_b16 v[120:121], v1 offset:34848
  ds_read_b64_tr_b16 v[122:123], v1 offset:39456
  v_mfma_f32_16x16x32_bf16 v[12:15], v[84:87], v[152:155], 0
  v_mfma_f32_16x16x32_bf16 v[48:51], v[84:87], v[156:159], 0
  ds_read_b64_tr_b16 v[124:125], v1 offset:34880
  ds_read_b64_tr_b16 v[126:127], v1 offset:39488
  v_mfma_f32_16x16x32_bf16 v[16:19], v[88:91], v[152:155], 0
  v_mfma_f32_16x16x32_bf16 v[52:55], v[88:91], v[156:159], 0
  ds_read_b64_tr_b16 v[128:129], v1 offset:34912
  ds_read_b64_tr_b16 v[130:131], v1 offset:39520
  v_mfma_f32_16x16x32_bf16 v[20:23], v[92:95], v[152:155], 0
  v_mfma_f32_16x16x32_bf16 v[56:59], v[92:95], v[156:159], 0
  ds_read_b64_tr_b16 v[132:133], v1 offset:34944
  ds_read_b64_tr_b16 v[134:135], v1 offset:39552
  v_mfma_f32_16x16x32_bf16 v[24:27], v[96:99], v[152:155], 0
  v_mfma_f32_16x16x32_bf16 v[60:63], v[96:99], v[156:159], 0
  ds_read_b64_tr_b16 v[136:137], v1 offset:34976
  ds_read_b64_tr_b16 v[138:139], v1 offset:39584
  v_mfma_f32_16x16x32_bf16 v[28:31], v[100:103], v[152:155], 0
  v_mfma_f32_16x16x32_bf16 v[64:67], v[100:103], v[156:159], 0
  ds_read_b64_tr_b16 v[140:141], v1 offset:35008
  ds_read_b64_tr_b16 v[142:143], v1 offset:39616
  v_mfma_f32_16x16x32_bf16 v[32:35], v[104:107], v[152:155], 0
  v_mfma_f32_16x16x32_bf16 v[68:71], v[104:107], v[156:159], 0
  ds_read_b64_tr_b16 v[144:145], v1 offset:35040
  ds_read_b64_tr_b16 v[146:147], v1 offset:39648
  v_mfma_f32_16x16x32_bf16 v[36:39], v[108:111], v[152:155], 0
  v_mfma_f32_16x16x32_bf16 v[72:75], v[108:111], v[156:159], 0
  ds_read_b64_tr_b16 v[148:149], v1 offset:35072
  ds_read_b64_tr_b16 v[150:151], v1 offset:39680
  v_mfma_f32_16x16x32_bf16 v[40:43], v[112:115], v[152:155], 0
  v_mfma_f32_16x16x32_bf16 v[76:79], v[112:115], v[156:159], 0
  s_waitcnt lgkmcnt(0)
  s_barrier
  ds_read_b128 v[152:155], v6 offset:0
  ds_read_b128 v[156:159], v6 offset:1024
  s_nop 0
  s_nop 0
  ds_read_b64_tr_b16 v[80:81], v2 offset:0
  ds_read_b64_tr_b16 v[82:83], v2 offset:4608
  v_mfma_f32_16x16x32_bf16 v[8:11], v[116:119], v[160:163], v[8:11]
  v_mfma_f32_16x16x32_bf16 v[44:47], v[116:119], v[164:167], v[44:47]
  ds_read_b64_tr_b16 v[84:85], v2 offset:32
  ds_read_b64_tr_b16 v[86:87], v2 offset:4640
  v_mfma_f32_16x16x32_bf16 v[12:15], v[120:123], v[160:163], v[12:15]
  v_mfma_f32_16x16x32_bf16 v[48:51], v[120:123], v[164:167], v[48:51]
  ds_read_b64_tr_b16 v[88:89], v2 offset:64
  ds_read_b64_tr_b16 v[90:91], v2 offset:4672
  v_mfma_f32_16x16x32_bf16 v[16:19], v[124:127], v[160:163], v[16:19]
  v_mfma_f32_16x16x32_bf16 v[52:55], v[124:127], v[164:167], v[52:55]
  ds_read_b64_tr_b16 v[92:93], v2 offset:96
  ds_read_b64_tr_b16 v[94:95], v2 offset:4704
  v_mfma_f32_16x16x32_bf16 v[20:23], v[128:131], v[160:163], v[20:23]
  v_mfma_f32_16x16x32_bf16 v[56:59], v[128:131], v[164:167], v[56:59]
  ds_read_b64_tr_b16 v[96:97], v2 offset:128
  ds_read_b64_tr_b16 v[98:99], v2 offset:4736
  v_mfma_f32_16x16x32_bf16 v[24:27], v[132:135], v[160:163], v[24:27]
  v_mfma_f32_16x16x32_bf16 v[60:63], v[132:135], v[164:167], v[60:63]
  ds_read_b64_tr_b16 v[100:101], v2 offset:160
  ds_read_b64_tr_b16 v[102:103], v2 offset:4768
  v_mfma_f32_16x16x32_bf16 v[28:31], v[136:139], v[160:163], v[28:31]
  v_mfma_f32_16x16x32_bf16 v[64:67], v[136:139], v[164:167], v[64:67]
  ds_read_b64_tr_b16 v[104:105], v2 offset:192
  ds_read_b64_tr_b16 v[106:107], v2 offset:4800
  v_mfma_f32_16x16x32_bf16 v[32:35], v[140:143], v[160:163], v[32:35]
  v_mfma_f32_16x16x32_bf16 v[68:71], v[140:143], v[164:167], v[68:71]
  ds_read_b64_tr_b16 v[108:109], v2 offset:224
  ds_read_b64_tr_b16 v[110:111], v2 offset:4832
  v_mfma_f32_16x16x32_bf16 v[36:39], v[144:147], v[160:163], v[36:39]
  v_mfma_f32_16x16x32_bf16 v[72:75], v[144:147], v[164:167], v[72:75]
  ds_read_b64_tr_b16 v[112:113], v2 offset:256
  ds_read_b64_tr_b16 v[114:115], v2 offset:4864
  v_mfma_f32_16x16x32_bf16 v[40:43], v[148:151], v[160:163], v[40:43]
  v_mfma_f32_16x16x32_bf16 v[76:79], v[148:151], v[164:167], v[76:79]
  s_waitcnt lgkmcnt(0)
  s_barrier
  s_cmp_eq_u32 s15, 0
  s_cbranch_scc0 k4_a3
  ds_read_b128 v[160:163], v6 offset:34816
  ds_read_b128 v[164:167], v6 offset:35840
  s_nop 0
  s_nop 0
  s_branch k4_b4
k4_a3:
  ds_read_b64 v[160:161], v4 offset:34816
  ds_read_b64 v[162:163], v4 offset:36864
  ds_read_b64 v[164:165], v4 offset:34824
  ds_read_b64 v[166:167], v4 offset:36872
k4_b4:
  ds_read_b64_tr_b16 v[116:117], v2 offset:34816
  ds_read_b64_tr_b16 v[118:119], v2 offset:39424
  v_mfma_f32_16x16x32_bf16 v[8:11], v[80:83], v[152:155], v[8:11]
  v_mfma_f32_16x16x32_bf16 v[44:47], v[80:83], v[156:159], v[44:47]
  ds_read_b64_tr_b16 v[120:121], v2 offset:34848
  ds_read_b64_tr_b16 v[122:123], v2 offset:39456
  v_mfma_f32_16x16x32_bf16 v[12:15], v[84:87], v[152:155], v[12:15]
  v_mfma_f32_16x16x32_bf16 v[48:51], v[84:87], v[156:159], v[48:51]
  ds_read_b64_tr_b16 v[124:125], v2 offset:34880
  ds_read_b64_tr_b16 v[126:127], v2 offset:39488
  v_mfma_f32_16x16x32_bf16 v[16:19], v[88:91], v[152:155], v[16:19]
  v_mfma_f32_16x16x32_bf16 v[52:55], v[88:91], v[156:159], v[52:55]
  ds_read_b64_tr_b16 v[128:129], v2 offset:34912
  ds_read_b64_tr_b16 v[130:131], v2 offset:39520
  v_mfma_f32_16x16x32_bf16 v[20:23], v[92:95], v[152:155], v[20:23]
  v_mfma_f32_16x16x32_bf16 v[56:59], v[92:95], v[156:159], v[56:59]
  ds_read_b64_tr_b16 v[132:133], v2 offset:34944
  ds_read_b64_tr_b16 v[134:135], v2 offset:39552
  v_mfma_f32_16x16x32_bf16 v[24:27], v[96:99], v[152:155], v[24:27]
  v_mfma_f32_16x16x32_bf16 v[60:63], v[96:99], v[156:159], v[60:63]
  ds_read_b64_tr_b16 v[136:137], v2 offset:34976
  ds_read_b64_tr_b16 v[138:139], v2 offset:39584
  v_mfma_f32_16x16x32_bf16 v[28:31], v[100:103], v[152:155], v[28:31]
  v_mfma_f32_16x16x32_bf16 v[64:67], v[100:103], v[156:159], v[64:67]
  ds_read_b64_tr_b16 v[140:141], v2 offset:35008
  ds_read_b64_tr_b16 v[142:143], v2 offset:39616
  v_mfma_f32_16x16x32_bf16 v[32:35], v[104:107], v[152:155], v[32:35]
  v_mfma_f32_16x16x32_bf16 v[68:71], v[104:107], v[156:159], v[68:71]
  ds_read_b64_tr_b16 v[144:145], v2 offset:35040
  ds_read_b64_tr_b16 v[146:147], v2 offset:39648
  v_mfma_f32_16x16x32_bf16 v[36:39], v[108:111], v[152:155], v[36:39]
  v_mfma_f32_16x16x32_bf16 v[72:75], v[108:111], v[156:159], v[72:75]
  ds_read_b64_tr_b16 v[148:149], v2 offset:35072
  ds_read_b64_tr_b16 v[150:151], v2 offset:39680
  v_mfma_f32_16x16x32_bf16 v[40:43], v[112:115], v[152:155], v[40:43]
  v_mfma_f32_16x16x32_bf16 v[76:79], v[112:115], v[156:159], v[76:79]
  s_waitcnt lgkmcnt(0)
  s_barrier
  s_cmp_eq_u32 s15, 0
  s_cbranch_scc0 k4_a5
  ds_read_b64 v[152:153], v3 offset:0
  ds_read_b64 v[154:155], v3 offset:2048
  ds_read_b64 v[156:157], v3 offset:8
  ds_read_b64 v[158:159], v3 offset:2056
  s_branch k4_b6
k4_a5:
  ds_read_b128 v[152:155], v5 offset:0
  ds_read_b128 v[156:159], v5 offset:1024
  s_nop 0
  s_nop 0
k4_b6:
  ds_read_b64_tr_b16 v[80:81], v1 offset:0
  ds_read_b64_tr_b16 v[82:83], v1 offset:4608
  v_mfma_f32_16x16x32_bf16 v[8:11], v[116:119], v[160:163], v[8:11]
  v_mfma_f32_16x16x32_bf16 v[44:47], v[116:119], v[164:167], v[44:47]
  ds_read_b64_tr_b16 v[84:85], v1 offset:32
  ds_read_b64_tr_b16 v[86:87], v1 offset:4640
  v_mfma_f32_16x16x32_bf16 v[12:15], v[120:123], v[160:163], v[12:15]
  v_mfma_f32_16x16x32_bf16 v[48:51], v[120:123], v[164:167], v[48:51]
  ds_read_b64_tr_b16 v[88:89], v1 offset:64
  ds_read_b64_tr_b16 v[90:91], v1 offset:4672
  v_mfma_f32_16x16x32_bf16 v[16:19], v[124:127], v[160:163], v[16:19]
  v_mfma_f32_16x16x32_bf16 v[52:55], v[124:127], v[164:167], v[52:55]
  ds_read_b64_tr_b16 v[92:93], v1 offset:96
  ds_read_b64_tr_b16 v[94:95], v1 offset:4704
  v_mfma_f32_16x16x32_bf16 v[20:23], v[128:131], v[160:163], v[20:23]
  v_mfma_f32_16x16x32_bf16 v[56:59], v[128:131], v[164:167], v[56:59]
  ds_read_b64_tr_b16 v[96:97], v1 offset:128
  ds_read_b64_tr_b16 v[98:99], v1 offset:4736
  v_mfma_f32_16x16x32_bf16 v[24:27], v[132:135], v[160:163], v[24:27]
  v_mfma_f32_16x16x32_bf16 v[60:63], v[132:135], v[164:167], v[60:63]
  ds_read_b64_tr_b16 v[100:101], v1 offset:160
  ds_read_b64_tr_b16 v[102:103], v1 offset:4768
  v_mfma_f32_16x16x32_bf16 v[28:31], v[136:139], v[160:163], v[28:31]
  v_mfma_f32_16x16x32_bf16 v[64:67], v[136:139], v[164:167], v[64:67]
  ds_read_b64_tr_b16 v[104:105], v1 offset:192
  ds_read_b64_tr_b16 v[106:107], v1 offset:4800
  v_mfma_f32_16x16x32_bf16 v[32:35], v[140:143], v[160:163], v[32:35]
  v_mfma_f32_16x16x32_bf16 v[68:71], v[140:143], v[164:167], v[68:71]
  ds_read_b64_tr_b16 v[108:109], v1 offset:224
  ds_read_b64_tr_b16 v[110:111], v1 offset:4832
  v_mfma_f32_16x16x32_bf16 v[36:39], v[144:147], v[160:163], v[36:39]
  v_mfma_f32_16x16x32_bf16 v[72:75], v[144:147], v[164:167], v[72:75]
  ds_read_b64_tr_b16 v[112:113], v1 offset:256
  ds_read_b64_tr_b16 v[114:115], v1 offset:4864
  v_mfma_f32_16x16x32_bf16 v[40:43], v[148:151], v[160:163], v[40:43]
  v_mfma_f32_16x16x32_bf16 v[76:79], v[148:151], v[164:167], v[76:79]
  s_waitcnt lgkmcnt(0)
  s_barrier
  ds_read_b128 v[160:163], v5 offset:34816
  ds_read_b128 v[164:167], v5 offset:35840
  s_nop 0
  s_nop 0
  ds_read_b64_tr_b16 v[116:117], v1 offset:34816
  ds_read_b64_tr_b16 v[118:119], v1 offset:39424
  v_mfma_f32_16x16x32_bf16 v[8:11], v[80:83], v[152:155], v[8:11]
  v_mfma_f32_16x16x32_bf16 v[44:47], v[80:83], v[156:159], v[44:47]
  ds_read_b64_tr_b16 v[120:121], v1 offset:34848
  ds_read_b64_tr_b16 v[122:123], v1 offset:39456
  v_mfma_f32_16x16x32_bf16 v[12:15], v[84:87], v[152:155], v[12:15]
  v_mfma_f32_16x16x32_bf16 v[48:51], v[84:87], v[156:159], v[48:51]
  ds_read_b64_tr_b16 v[124:125], v1 offset:34880
  ds_read_b64_tr_b16 v[126:127], v1 offset:39488
  v_mfma_f32_16x16x32_bf16 v[16:19], v[88:91], v[152:155], v[16:19]
  v_mfma_f32_16x16x32_bf16 v[52:55], v[88:91], v[156:159], v[52:55]
  ds_read_b64_tr_b16 v[128:129], v1 offset:34912
  ds_read_b64_tr_b16 v[130:131], v1 offset:39520
  v_mfma_f32_16x16x32_bf16 v[20:23], v[92:95], v[152:155], v[20:23]
  v_mfma_f32_16x16x32_bf16 v[56:59], v[92:95], v[156:159], v[56:59]
  ds_read_b64_tr_b16 v[132:133], v1 offset:34944
  ds_read_b64_tr_b16 v[134:135], v1 offset:39552
  v_mfma_f32_16x16x32_bf16 v[24:27], v[96:99], v[152:155], v[24:27]
  v_mfma_f32_16x16x32_bf16 v[60:63], v[96:99], v[156:159], v[60:63]
  ds_read_b64_tr_b16 v[136:137], v1 offset:34976
  ds_read_b64_tr_b16 v[138:139], v1 offset:39584
  v_mfma_f32_16x16x32_bf16 v[28:31], v[100:103], v[152:155], v[28:31]
  v_mfma_f32_16x16x32_bf16 v[64:67], v[100:103], v[156:159], v[64:67]
  ds_read_b64_tr_b16 v[140:141], v1 offset:35008
  ds_read_b64_tr_b16 v[142:143], v1 offset:39616
  v_mfma_f32_16x16x32_bf16 v[32:35], v[104:107], v[152:155], v[32:35]
  v_mfma_f32_16x16x32_bf16 v[68:71], v[104:107], v[156:159], v[68:71]
  ds_read_b64_tr_b16 v[144:145], v1 offset:35040
  ds_read_b64_tr_b16 v[146:147], v1 offset:39648
  v_mfma_f32_16x16x32_bf16 v[36:39], v[108:111], v[152:155], v[36:39]
  v_mfma_f32_16x16x32_bf16 v[72:75], v[108:111], v[156:159], v[72:75]
  ds_read_b64_tr_b16 v[148:149], v1 offset:35072
  ds_read_b64_tr_b16 v[150:151], v1 offset:39680
  v_mfma_f32_16x16x32_bf16 v[40:43], v[112:115], v[152:155], v[40:43]
  v_mfma_f32_16x16x32_bf16 v[76:79], v[112:115], v[156:159], v[76:79]
  s_waitcnt lgkmcnt(0)
  s_barrier
  s_cmp_eq_u32 s15, 0
  s_cbranch_scc0 k4_a7
  ds_read_b64 v[152:153], v4 offset:0
  ds_read_b64 v[154:155], v4 offset:2048
  ds_read_b64 v[156:157], v4 offset:8
  ds_read_b64 v[158:159], v4 offset:2056
  s_branch k4_b8
k4_a7:
  ds_read_b128 v[152:155], v6 offset:0
  ds_read_b128 v[156:159], v6 offset:1024
  s_nop 0
  s_nop 0
k4_b8:
  ds_read_b64_tr_b16 v[80:81], v2 offset:0
  ds_read_b64_tr_b16 v[82:83], v2 offset:4608
  v_mfma_f32_16x16x32_bf16 v[8:11], v[116:119], v[160:163], v[8:11]
  v_mfma_f32_16x16x32_bf16 v[44:47], v[116:119], v[164:167], v[44:47]
  ds_read_b64_tr_b16 v[84:85], v2 offset:32
  ds_read_b64_tr_b16 v[86:87], v2 offset:4640
  v_mfma_f32_16x16x32_bf16 v[12:15], v[120:123], v[160:163], v[12:15]
  v_mfma_f32_16x16x32_bf16 v[48:51], v[120:123], v[164:167], v[48:51]
  ds_read_b64_tr_b16 v[88:89], v2 offset:64
  ds_read_b64_tr_b16 v[90:91], v2 offset:4672
  v_mfma_f32_16x16x32_bf16 v[16:19], v[124:127], v[160:163], v[16:19]
  v_mfma_f32_16x16x32_bf16 v[52:55], v[124:127], v[164:167], v[52:55]
  ds_read_b64_tr_b16 v[92:93], v2 offset:96
  ds_read_b64_tr_b16 v[94:95], v2 offset:4704
  v_mfma_f32_16x16x32_bf16 v[20:23], v[128:131], v[160:163], v[20:23]
  v_mfma_f32_16x16x32_bf16 v[56:59], v[128:131], v[164:167], v[56:59]
  ds_read_b64_tr_b16 v[96:97], v2 offset:128
  ds_read_b64_tr_b16 v[98:99], v2 offset:4736
  v_mfma_f32_16x16x32_bf16 v[24:27], v[132:135], v[160:163], v[24:27]
  v_mfma_f32_16x16x32_bf16 v[60:63], v[132:135], v[164:167], v[60:63]
  ds_read_b64_tr_b16 v[100:101], v2 offset:160
  ds_read_b64_tr_b16 v[102:103], v2 offset:4768
  v_mfma_f32_16x16x32_bf16 v[28:31], v[136:139], v[160:163], v[28:31]
  v_mfma_f32_16x16x32_bf16 v[64:67], v[136:139], v[164:167], v[64:67]
  ds_read_b64_tr_b16 v[104:105], v2 offset:192
  ds_read_b64_tr_b16 v[106:107], v2 offset:4800
  v_mfma_f32_16x16x32_bf16 v[32:35], v[140:143], v[160:163], v[32:35]
  v_mfma_f32_16x16x32_bf16 v[68:71], v[140:143], v[164:167], v[68:71]
  ds_read_b64_tr_b16 v[108:109], v2 offset:224
  ds_read_b64_tr_b16 v[110:111], v2 offset:4832
  v_mfma_f32_16x16x32_bf16 v[36:39], v[144:147], v[160:163], v[36:39]
  v_mfma_f32_16x16x32_bf16 v[72:75], v[144:147], v[164:167], v[72:75]
  ds_read_b64_tr_b16 v[112:113], v2 offset:256
  ds_read_b64_tr_b16 v[114:115], v2 offset:4864
  v_mfma_f32_16x16x32_bf16 v[40:43], v[148:151], v[160:163], v[40:43]
  v_mfma_f32_16x16x32_bf16 v[76:79], v[148:151], v[164:167], v[76:79]
  s_waitcnt lgkmcnt(0)
  s_barrier
  ds_read_b128 v[160:163], v6 offset:34816
  ds_read_b128 v[164:167], v6 offset:35840
  s_nop 0
  s_nop 0
  ds_read_b64_tr_b16 v[116:117], v2 offset:34816
  ds_read_b64_tr_b16 v[118:119], v2 offset:39424
  v_mfma_f32_16x16x32_bf16 v[8:11], v[80:83], v[152:155], v[8:11]
  v_mfma_f32_16x16x32_bf16 v[44:47], v[80:83], v[156:159], v[44:47]
  ds_read_b64_tr_b16 v[120:121], v2 offset:34848
  ds_read_b64_tr_b16 v[122:123], v2 offset:39456
  v_mfma_f32_16x16x32_bf16 v[12:15], v[84:87], v[152:155], v[12:15]
  v_mfma_f32_16x16x32_bf16 v[48:51], v[84:87], v[156:159], v[48:51]
  ds_read_b64_tr_b16 v[124:125], v2 offset:34880
  ds_read_b64_tr_b16 v[126:127], v2 offset:39488
  v_mfma_f32_16x16x32_bf16 v[16:19], v[88:91], v[152:155], v[16:19]
  v_mfma_f32_16x16x32_bf16 v[52:55], v[88:91], v[156:159], v[52:55]
  ds_read_b64_tr_b16 v[128:129], v2 offset:34912
  ds_read_b64_tr_b16 v[130:131], v2 offset:39520
  v_mfma_f32_16x16x32_bf16 v[20:23], v[92:95], v[152:155], v[20:23]
  v_mfma_f32_16x16x32_bf16 v[56:59], v[92:95], v[156:159], v[56:59]
  ds_read_b64_tr_b16 v[132:133], v2 offset:34944
  ds_read_b64_tr_b16 v[134:135], v2 offset:39552
  v_mfma_f32_16x16x32_bf16 v[24:27], v[96:99], v[152:155], v[24:27]
  v_mfma_f32_16x16x32_bf16 v[60:63], v[96:99], v[156:159], v[60:63]
  ds_read_b64_tr_b16 v[136:137], v2 offset:34976
  ds_read_b64_tr_b16 v[138:139], v2 offset:39584
  v_mfma_f32_16x16x32_bf16 v[28:31], v[100:103], v[152:155], v[28:31]
  v_mfma_f32_16x16x32_bf16 v[64:67], v[100:103], v[156:159], v[64:67]
  ds_read_b64_tr_b16 v[140:141], v2 offset:35008
  ds_read_b64_tr_b16 v[142:143], v2 offset:39616
  v_mfma_f32_16x16x32_bf16 v[32:35], v[104:107], v[152:155], v[32:35]
  v_mfma_f32_16x16x32_bf16 v[68:71], v[104:107], v[156:159], v[68:71]
  ds_read_b64_tr_b16 v[144:145], v2 offset:35040
  ds_read_b64_tr_b16 v[146:147], v2 offset:39648
  v_mfma_f32_16x16x32_bf16 v[36:39], v[108:111], v[152:155], v[36:39]
  v_mfma_f32_16x16x32_bf16 v[72:75], v[108:111], v[156:159], v[72:75]
  ds_read_b64_tr_b16 v[148:149], v2 offset:35072
  ds_read_b64_tr_b16 v[150:151], v2 offset:39680
  v_mfma_f32_16x16x32_bf16 v[40:43], v[112:115], v[152:155], v[40:43]
  v_mfma_f32_16x16x32_bf16 v[76:79], v[112:115], v[156:159], v[76:79]
  s_waitcnt lgkmcnt(0)
  s_barrier
  ds_read_b64 v[152:153], v3 offset:0
  ds_read_b64 v[154:155], v3 offset:2048
  ds_read_b64 v[156:157], v3 offset:8
  ds_read_b64 v[158:159], v3 offset:2056
  ds_read_b64_tr_b16 v[80:81], v1 offset:0
  ds_read_b64_tr_b16 v[82:83], v1 offset:4608
  v_mfma_f32_16x16x32_bf16 v[8:11], v[116:119], v[160:163], v[8:11]
  v_mfma_f32_16x16x32_bf16 v[44:47], v[116:119], v[164:167], v[44:47]
  ds_read_b64_tr_b16 v[84:85], v1 offset:32
  ds_read_b64_tr_b16 v[86:87], v1 offset:4640
  v_mfma_f32_16x16x32_bf16 v[12:15], v[120:123], v[160:163], v[12:15]
  v_mfma_f32_16x16x32_bf16 v[48:51], v[120:123], v[164:167], v[48:51]
  ds_read_b64_tr_b16 v[88:89], v1 offset:64
  ds_read_b64_tr_b16 v[90:91], v1 offset:4672
  v_mfma_f32_16x16x32_bf16 v[16:19], v[124:127], v[160:163], v[16:19]
  v_mfma_f32_16x16x32_bf16 v[52:55], v[124:127], v[164:167], v[52:55]
  ds_read_b64_tr_b16 v[92:93], v1 offset:96
  ds_read_b64_tr_b16 v[94:95], v1 offset:4704
  v_mfma_f32_16x16x32_bf16 v[20:23], v[128:131], v[160:163], v[20:23]
  v_mfma_f32_16x16x32_bf16 v[56:59], v[128:131], v[164:167], v[56:59]
  ds_read_b64_tr_b16 v[96:97], v1 offset:128
  ds_read_b64_tr_b16 v[98:99], v1 offset:4736
  v_mfma_f32_16x16x32_bf16 v[24:27], v[132:135], v[160:163], v[24:27]
  v_mfma_f32_16x16x32_bf16 v[60:63], v[132:135], v[164:167], v[60:63]
  ds_read_b64_tr_b16 v[100:101], v1 offset:160
  ds_read_b64_tr_b16 v[102:103], v1 offset:4768
  v_mfma_f32_16x16x32_bf16 v[28:31], v[136:139], v[160:163], v[28:31]
  v_mfma_f32_16x16x32_bf16 v[64:67], v[136:139], v[164:167], v[64:67]
  ds_read_b64_tr_b16 v[104:105], v1 offset:192
  ds_read_b64_tr_b16 v[106:107], v1 offset:4800
  v_mfma_f32_16x16x32_bf16 v[32:35], v[140:143], v[160:163], v[32:35]
  v_mfma_f32_16x16x32_bf16 v[68:71], v[140:143], v[164:167], v[68:71]
  ds_read_b64_tr_b16 v[108:109], v1 offset:224
  ds_read_b64_tr_b16 v[110:111], v1 offset:4832
  v_mfma_f32_16x16x32_bf16 v[36:39], v[144:147], v[160:163], v[36:39]
  v_mfma_f32_16x16x32_bf16 v[72:75], v[144:147], v[164:167], v[72:75]
  ds_read_b64_tr_b16 v[112:113], v1 offset:256
  ds_read_b64_tr_b16 v[114:115], v1 offset:4864
  v_mfma_f32_16x16x32_bf16 v[40:43], v[148:151], v[160:163], v[40:43]
  v_mfma_f32_16x16x32_bf16 v[76:79], v[148:151], v[164:167], v[76:79]
  s_waitcnt lgkmcnt(0)
  s_barrier
  ds_read_b128 v[160:163], v5 offset:34816
  ds_read_b128 v[164:167], v5 offset:35840
  s_nop 0
  s_nop 0
  ds_read_b64_tr_b16 v[116:117], v1 offset:34816
  ds_read_b64_tr_b16 v[118:119], v1 offset:39424
  v_mfma_f32_16x16x32_bf16 v[8:11], v[80:83], v[152:155], v[8:11]
  v_mfma_f32_16x16x32_bf16 v[44:47], v[80:83], v[156:159], v[44:47]
  ds_read_b64_tr_b16 v[120:121], v1 offset:34848
  ds_read_b64_tr_b16 v[122:123], v1 offset:39456
  v_mfma_f32_16x16x32_bf16 v[12:15], v[84:87], v[152:155], v[12:15]
  v_mfma_f32_16x16x32_bf16 v[48:51], v[84:87], v[156:159], v[48:51]
  ds_read_b64_tr_b16 v[124:125], v1 offset:34880
  ds_read_b64_tr_b16 v[126:127], v1 offset:39488
  v_mfma_f32_16x16x32_bf16 v[16:19], v[88:91], v[152:155], v[16:19]
  v_mfma_f32_16x16x32_bf16 v[52:55], v[88:91], v[156:159], v[52:55]
  ds_read_b64_tr_b16 v[128:129], v1 offset:34912
  ds_read_b64_tr_b16 v[130:131], v1 offset:39520
  v_mfma_f32_16x16x32_bf16 v[20:23], v[92:95], v[152:155], v[20:23]
  v_mfma_f32_16x16x32_bf16 v[56:59], v[92:95], v[156:159], v[56:59]
  ds_read_b64_tr_b16 v[132:133], v1 offset:34944
  ds_read_b64_tr_b16 v[134:135], v1 offset:39552
  v_mfma_f32_16x16x32_bf16 v[24:27], v[96:99], v[152:155], v[24:27]
  v_mfma_f32_16x16x32_bf16 v[60:63], v[96:99], v[156:159], v[60:63]
  ds_read_b64_tr_b16 v[136:137], v1 offset:34976
  ds_read_b64_tr_b16 v[138:139], v1 offset:39584
  v_mfma_f32_16x16x32_bf16 v[28:31], v[100:103], v[152:155], v[28:31]
  v_mfma_f32_16x16x32_bf16 v[64:67], v[100:103], v[156:159], v[64:67]
  ds_read_b64_tr_b16 v[140:141], v1 offset:35008
  ds_read_b64_tr_b16 v[142:143], v1 offset:39616
  v_mfma_f32_16x16x32_bf16 v[32:35], v[104:107], v[152:155], v[32:35]
  v_mfma_f32_16x16x32_bf16 v[68:71], v[104:107], v[156:159], v[68:71]
  ds_read_b64_tr_b16 v[144:145], v1 offset:35040
  ds_read_b64_tr_b16 v[146:147], v1 offset:39648
  v_mfma_f32_16x16x32_bf16 v[36:39], v[108:111], v[152:155], v[36:39]
  v_mfma_f32_16x16x32_bf16 v[72:75], v[108:111], v[156:159], v[72:75]
  ds_read_b64_tr_b16 v[148:149], v1 offset:35072
  ds_read_b64_tr_b16 v[150:151], v1 offset:39680
  v_mfma_f32_16x16x32_bf16 v[40:43], v[112:115], v[152:155], v[40:43]
  v_mfma_f32_16x16x32_bf16 v[76:79], v[112:115], v[156:159], v[76:79]
  s_waitcnt lgkmcnt(0)
  s_barrier
  s_cmp_eq_u32 s15, 0
  s_cbranch_scc0 k4_a9
  ds_read_b128 v[152:155], v6 offset:0
  ds_read_b128 v[156:159], v6 offset:1024
  s_nop 0
  s_nop 0
  s_branch k4_b10
k4_a9:
  ds_read_b64 v[152:153], v4 offset:0
  ds_read_b64 v[154:155], v4 offset:2048
  ds_read_b64 v[156:157], v4 offset:8
  ds_read_b64 v[158:159], v4 offset:2056
k4_b10:
  ds_read_b64_tr_b16 v[80:81], v2 offset:0
  ds_read_b64_tr_b16 v[82:83], v2 offset:4608
  v_mfma_f32_16x16x32_bf16 v[8:11], v[116:119], v[160:163], v[8:11]
  v_mfma_f32_16x16x32_bf16 v[44:47], v[116:119], v[164:167], v[44:47]
  ds_read_b64_tr_b16 v[84:85], v2 offset:32
  ds_read_b64_tr_b16 v[86:87], v2 offset:4640
  v_mfma_f32_16x16x32_bf16 v[12:15], v[120:123], v[160:163], v[12:15]
  v_mfma_f32_16x16x32_bf16 v[48:51], v[120:123], v[164:167], v[48:51]
  ds_read_b64_tr_b16 v[88:89], v2 offset:64
  ds_read_b64_tr_b16 v[90:91], v2 offset:4672
  v_mfma_f32_16x16x32_bf16 v[16:19], v[124:127], v[160:163], v[16:19]
  v_mfma_f32_16x16x32_bf16 v[52:55], v[124:127], v[164:167], v[52:55]
  ds_read_b64_tr_b16 v[92:93], v2 offset:96
  ds_read_b64_tr_b16 v[94:95], v2 offset:4704
  v_mfma_f32_16x16x32_bf16 v[20:23], v[128:131], v[160:163], v[20:23]
  v_mfma_f32_16x16x32_bf16 v[56:59], v[128:131], v[164:167], v[56:59]
  ds_read_b64_tr_b16 v[96:97], v2 offset:128
  ds_read_b64_tr_b16 v[98:99], v2 offset:4736
  v_mfma_f32_16x16x32_bf16 v[24:27], v[132:135], v[160:163], v[24:27]
  v_mfma_f32_16x16x32_bf16 v[60:63], v[132:135], v[164:167], v[60:63]
  ds_read_b64_tr_b16 v[100:101], v2 offset:160
  ds_read_b64_tr_b16 v[102:103], v2 offset:4768
  v_mfma_f32_16x16x32_bf16 v[28:31], v[136:139], v[160:163], v[28:31]
  v_mfma_f32_16x16x32_bf16 v[64:67], v[136:139], v[164:167], v[64:67]
  ds_read_b64_tr_b16 v[104:105], v2 offset:192
  ds_read_b64_tr_b16 v[106:107], v2 offset:4800
  v_mfma_f32_16x16x32_bf16 v[32:35], v[140:143], v[160:163], v[32:35]
  v_mfma_f32_16x16x32_bf16 v[68:71], v[140:143], v[164:167], v[68:71]
  ds_read_b64_tr_b16 v[108:109], v2 offset:224
  ds_read_b64_tr_b16 v[110:111], v2 offset:4832
  v_mfma_f32_16x16x32_bf16 v[36:39], v[144:147], v[160:163], v[36:39]
  v_mfma_f32_16x16x32_bf16 v[72:75], v[144:147], v[164:167], v[72:75]
  ds_read_b64_tr_b16 v[112:113], v2 offset:256
  ds_read_b64_tr_b16 v[114:115], v2 offset:4864
  v_mfma_f32_16x16x32_bf16 v[40:43], v[148:151], v[160:163], v[40:43]
  v_mfma_f32_16x16x32_bf16 v[76:79], v[148:151], v[164:167], v[76:79]
  s_waitcnt lgkmcnt(0)
  s_barrier
  ds_read_b128 v[160:163], v6 offset:34816
  ds_read_b128 v[164:167], v6 offset:35840
  s_nop 0
  s_nop 0
  ds_read_b64_tr_b16 v[116:117], v2 offset:34816
  ds_read_b64_tr_b16 v[118:119], v2 offset:39424
  v_mfma_f32_16x16x32_bf16 v[8:11], v[80:83], v[152:155], v[8:11]
  v_mfma_f32_16x16x32_bf16 v[44:47], v[80:83], v[156:159], v[44:47]
  ds_read_b64_tr_b16 v[120:121], v2 offset:34848
  ds_read_b64_tr_b16 v[122:123], v2 offset:39456
  v_mfma_f32_16x16x32_bf16 v[12:15], v[84:87], v[152:155], v[12:15]
  v_mfma_f32_16x16x32_bf16 v[48:51], v[84:87], v[156:159], v[48:51]
  ds_read_b64_tr_b16 v[124:125], v2 offset:34880
  ds_read_b64_tr_b16 v[126:127], v2 offset:39488
  v_mfma_f32_16x16x32_bf16 v[16:19], v[88:91], v[152:155], v[16:19]
  v_mfma_f32_16x16x32_bf16 v[52:55], v[88:91], v[156:159], v[52:55]
  ds_read_b64_tr_b16 v[128:129], v2 offset:34912
  ds_read_b64_tr_b16 v[130:131], v2 offset:39520
  v_mfma_f32_16x16x32_bf16 v[20:23], v[92:95], v[152:155], v[20:23]
  v_mfma_f32_16x16x32_bf16 v[56:59], v[92:95], v[156:159], v[56:59]
  ds_read_b64_tr_b16 v[132:133], v2 offset:34944
  ds_read_b64_tr_b16 v[134:135], v2 offset:39552
  v_mfma_f32_16x16x32_bf16 v[24:27], v[96:99], v[152:155], v[24:27]
  v_mfma_f32_16x16x32_bf16 v[60:63], v[96:99], v[156:159], v[60:63]
  ds_read_b64_tr_b16 v[136:137], v2 offset:34976
  ds_read_b64_tr_b16 v[138:139], v2 offset:39584
  v_mfma_f32_16x16x32_bf16 v[28:31], v[100:103], v[152:155], v[28:31]
  v_mfma_f32_16x16x32_bf16 v[64:67], v[100:103], v[156:159], v[64:67]
  ds_read_b64_tr_b16 v[140:141], v2 offset:35008
  ds_read_b64_tr_b16 v[142:143], v2 offset:39616
  v_mfma_f32_16x16x32_bf16 v[32:35], v[104:107], v[152:155], v[32:35]
  v_mfma_f32_16x16x32_bf16 v[68:71], v[104:107], v[156:159], v[68:71]
  ds_read_b64_tr_b16 v[144:145], v2 offset:35040
  ds_read_b64_tr_b16 v[146:147], v2 offset:39648
  v_mfma_f32_16x16x32_bf16 v[36:39], v[108:111], v[152:155], v[36:39]
  v_mfma_f32_16x16x32_bf16 v[72:75], v[108:111], v[156:159], v[72:75]
  ds_read_b64_tr_b16 v[148:149], v2 offset:35072
  ds_read_b64_tr_b16 v[150:151], v2 offset:39680
  v_mfma_f32_16x16x32_bf16 v[40:43], v[112:115], v[152:155], v[40:43]
  v_mfma_f32_16x16x32_bf16 v[76:79], v[112:115], v[156:159], v[76:79]
  s_waitcnt lgkmcnt(0)
  s_barrier
  s_cmp_eq_u32 s15, 0
  s_cbranch_scc0 k4_a11
  ds_read_b128 v[152:155], v5 offset:0
  ds_read_b128 v[156:159], v5 offset:1024
  s_nop 0
  s_nop 0
  s_branch k4_b12
k4_a11:
  ds_read_b64 v[152:153], v3 offset:0
  ds_read_b64 v[154:155], v3 offset:2048
  ds_read_b64 v[156:157], v3 offset:8
  ds_read_b64 v[158:159], v3 offset:2056
k4_b12:
  ds_read_b64_tr_b16 v[80:81], v1 offset:0
  ds_read_b64_tr_b16 v[82:83], v1 offset:4608
  v_mfma_f32_16x16x32_bf16 v[8:11], v[116:119], v[160:163], v[8:11]
  v_mfma_f32_16x16x32_bf16 v[44:47], v[116:119], v[164:167], v[44:47]
  ds_read_b64_tr_b16 v[84:85], v1 offset:32
  ds_read_b64_tr_b16 v[86:87], v1 offset:4640
  v_mfma_f32_16x16x32_bf16 v[12:15], v[120:123], v[160:163], v[12:15]
  v_mfma_f32_16x16x32_bf16 v[48:51], v[120:123], v[164:167], v[48:51]
  ds_read_b64_tr_b16 v[88:89], v1 offset:64
  ds_read_b64_tr_b16 v[90:91], v1 offset:4672
  v_mfma_f32_16x16x32_bf16 v[16:19], v[124:127], v[160:163], v[16:19]
  v_mfma_f32_16x16x32_bf16 v[52:55], v[124:127], v[164:167], v[52:55]
  ds_read_b64_tr_b16 v[92:93], v1 offset:96
  ds_read_b64_tr_b16 v[94:95], v1 offset:4704
  v_mfma_f32_16x16x32_bf16 v[20:23], v[128:131], v[160:163], v[20:23]
  v_mfma_f32_16x16x32_bf16 v[56:59], v[128:131], v[164:167], v[56:59]
  ds_read_b64_tr_b16 v[96:97], v1 offset:128
  ds_read_b64_tr_b16 v[98:99], v1 offset:4736
  v_mfma_f32_16x16x32_bf16 v[24:27], v[132:135], v[160:163], v[24:27]
  v_mfma_f32_16x16x32_bf16 v[60:63], v[132:135], v[164:167], v[60:63]
  ds_read_b64_tr_b16 v[100:101], v1 offset:160
  ds_read_b64_tr_b16 v[102:103], v1 offset:4768
  v_mfma_f32_16x16x32_bf16 v[28:31], v[136:139], v[160:163], v[28:31]
  v_mfma_f32_16x16x32_bf16 v[64:67], v[136:139], v[164:167], v[64:67]
  ds_read_b64_tr_b16 v[104:105], v1 offset:192
  ds_read_b64_tr_b16 v[106:107], v1 offset:4800
  v_mfma_f32_16x16x32_bf16 v[32:35], v[140:143], v[160:163], v[32:35]
  v_mfma_f32_16x16x32_bf16 v[68:71], v[140:143], v[164:167], v[68:71]
  ds_read_b64_tr_b16 v[108:109], v1 offset:224
  ds_read_b64_tr_b16 v[110:111], v1 offset:4832
  v_mfma_f32_16x16x32_bf16 v[36:39], v[144:147], v[160:163], v[36:39]
  v_mfma_f32_16x16x32_bf16 v[72:75], v[144:147], v[164:167], v[72:75]
  ds_read_b64_tr_b16 v[112:113], v1 offset:256
  ds_read_b64_tr_b16 v[114:115], v1 offset:4864
  v_mfma_f32_16x16x32_bf16 v[40:43], v[148:151], v[160:163], v[40:43]
  v_mfma_f32_16x16x32_bf16 v[76:79], v[148:151], v[164:167], v[76:79]
  s_waitcnt lgkmcnt(0)
  s_barrier
  s_cmp_eq_u32 s15, 0
  s_cbranch_scc0 k4_a13
  ds_read_b64 v[160:161], v3 offset:34816
  ds_read_b64 v[162:163], v3 offset:36864
  ds_read_b64 v[164:165], v3 offset:34824
  ds_read_b64 v[166:167], v3 offset:36872
  s_branch k4_b14
k4_a13:
  ds_read_b128 v[160:163], v5 offset:34816
  ds_read_b128 v[164:167], v5 offset:35840
  s_nop 0
  s_nop 0
k4_b14:
  ds_read_b64_tr_b16 v[116:117], v1 offset:34816
  ds_read_b64_tr_b16 v[118:119], v1 offset:39424
  v_mfma_f32_16x16x32_bf16 v[8:11], v[80:83], v[152:155], v[8:11]
  v_mfma_f32_16x16x32_bf16 v[44:47], v[80:83], v[156:159], v[44:47]
  ds_read_b64_tr_b16 v[120:121], v1 offset:34848
  ds_read_b64_tr_b16 v[122:123], v1 offset:39456
  v_mfma_f32_16x16x32_bf16 v[12:15], v[84:87], v[152:155], v[12:15]
  v_mfma_f32_16x16x32_bf16 v[48:51], v[84:87], v[156:159], v[48:51]
  ds_read_b64_tr_b16 v[124:125], v1 offset:34880
  ds_read_b64_tr_b16 v[126:127], v1 offset:39488
  v_mfma_f32_16x16x32_bf16 v[16:19], v[88:91], v[152:155], v[16:19]
  v_mfma_f32_16x16x32_bf16 v[52:55], v[88:91], v[156:159], v[52:55]
  ds_read_b64_tr_b16 v[128:129], v1 offset:34912
  ds_read_b64_tr_b16 v[130:131], v1 offset:39520
  v_mfma_f32_16x16x32_bf16 v[20:23], v[92:95], v[152:155], v[20:23]
  v_mfma_f32_16x16x32_bf16 v[56:59], v[92:95], v[156:159], v[56:59]
  ds_read_b64_tr_b16 v[132:133], v1 offset:34944
  ds_read_b64_tr_b16 v[134:135], v1 offset:39552
  v_mfma_f32_16x16x32_bf16 v[24:27], v[96:99], v[152:155], v[24:27]
  v_mfma_f32_16x16x32_bf16 v[60:63], v[96:99], v[156:159], v[60:63]
  ds_read_b64_tr_b16 v[136:137], v1 offset:34976
  ds_read_b64_tr_b16 v[138:139], v1 offset:39584
  v_mfma_f32_16x16x32_bf16 v[28:31], v[100:103], v[152:155], v[28:31]
  v_mfma_f32_16x16x32_bf16 v[64:67], v[100:103], v[156:159], v[64:67]
  ds_read_b64_tr_b16 v[140:141], v1 offset:35008
  ds_read_b64_tr_b16 v[142:143], v1 offset:39616
  v_mfma_f32_16x16x32_bf16 v[32:35], v[104:107], v[152:155], v[32:35]
  v_mfma_f32_16x16x32_bf16 v[68:71], v[104:107], v[156:159], v[68:71]
  ds_read_b64_tr_b16 v[144:145], v1 offset:35040
  ds_read_b64_tr_b16 v[146:147], v1 offset:39648
  v_mfma_f32_16x16x32_bf16 v[36:39], v[108:111], v[152:155], v[36:39]
  v_mfma_f32_16x16x32_bf16 v[72:75], v[108:111], v[156:159], v[72:75]
  ds_read_b64_tr_b16 v[148:149], v1 offset:35072
  ds_read_b64_tr_b16 v[150:151], v1 offset:39680
  v_mfma_f32_16x16x32_bf16 v[40:43], v[112:115], v[152:155], v[40:43]
  v_mfma_f32_16x16x32_bf16 v[76:79], v[112:115], v[156:159], v[76:79]
  s_waitcnt lgkmcnt(0)
  s_barrier
  ds_read_b128 v[152:155], v6 offset:0
  ds_read_b128 v[156:159], v6 offset:1024
  s_nop 0
  s_nop 0
  ds_read_b64_tr_b16 v[80:81], v2 offset:0
  ds_read_b64_tr_b16 v[82:83], v2 offset:4608
  v_mfma_f32_16x16x32_bf16 v[8:11], v[116:119], v[160:163], v[8:11]
  v_mfma_f32_16x16x32_bf16 v[44:47], v[116:119], v[164:167], v[44:47]
  ds_read_b64_tr_b16 v[84:85], v2 offset:32
  ds_read_b64_tr_b16 v[86:87], v2 offset:4640
  v_mfma_f32_16x16x32_bf16 v[12:15], v[120:123], v[160:163], v[12:15]
  v_mfma_f32_16x16x32_bf16 v[48:51], v[120:123], v[164:167], v[48:51]
  ds_read_b64_tr_b16 v[88:89], v2 offset:64
  ds_read_b64_tr_b16 v[90:91], v2 offset:4672
  v_mfma_f32_16x16x32_bf16 v[16:19], v[124:127], v[160:163], v[16:19]
  v_mfma_f32_16x16x32_bf16 v[52:55], v[124:127], v[164:167], v[52:55]
  ds_read_b64_tr_b16 v[92:93], v2 offset:96
  ds_read_b64_tr_b16 v[94:95], v2 offset:4704
  v_mfma_f32_16x16x32_bf16 v[20:23], v[128:131], v[160:163], v[20:23]
  v_mfma_f32_16x16x32_bf16 v[56:59], v[128:131], v[164:167], v[56:59]
  ds_read_b64_tr_b16 v[96:97], v2 offset:128
  ds_read_b64_tr_b16 v[98:99], v2 offset:4736
  v_mfma_f32_16x16x32_bf16 v[24:27], v[132:135], v[160:163], v[24:27]
  v_mfma_f32_16x16x32_bf16 v[60:63], v[132:135], v[164:167], v[60:63]
  ds_read_b64_tr_b16 v[100:101], v2 offset:160
  ds_read_b64_tr_b16 v[102:103], v2 offset:4768
  v_mfma_f32_16x16x32_bf16 v[28:31], v[136:139], v[160:163], v[28:31]
  v_mfma_f32_16x16x32_bf16 v[64:67], v[136:139], v[164:167], v[64:67]
  ds_read_b64_tr_b16 v[104:105], v2 offset:192
  ds_read_b64_tr_b16 v[106:107], v2 offset:4800
  v_mfma_f32_16x16x32_bf16 v[32:35], v[140:143], v[160:163], v[32:35]
  v_mfma_f32_16x16x32_bf16 v[68:71], v[140:143], v[164:167], v[68:71]
  ds_read_b64_tr_b16 v[108:109], v2 offset:224
  ds_read_b64_tr_b16 v[110:111], v2 offset:4832
  v_mfma_f32_16x16x32_bf16 v[36:39], v[144:147], v[160:163], v[36:39]
  v_mfma_f32_16x16x32_bf16 v[72:75], v[144:147], v[164:167], v[72:75]
  ds_read_b64_tr_b16 v[112:113], v2 offset:256
  ds_read_b64_tr_b16 v[114:115], v2 offset:4864
  v_mfma_f32_16x16x32_bf16 v[40:43], v[148:151], v[160:163], v[40:43]
  v_mfma_f32_16x16x32_bf16 v[76:79], v[148:151], v[164:167], v[76:79]
  s_waitcnt lgkmcnt(0)
  s_barrier
  s_cmp_eq_u32 s15, 0
  s_cbranch_scc0 k4_a15
  ds_read_b64 v[160:161], v4 offset:34816
  ds_read_b64 v[162:163], v4 offset:36864
  ds_read_b64 v[164:165], v4 offset:34824
  ds_read_b64 v[166:167], v4 offset:36872
  s_branch k4_b16
k4_a15:
  ds_read_b128 v[160:163], v6 offset:34816
  ds_read_b128 v[164:167], v6 offset:35840
  s_nop 0
  s_nop 0
k4_b16:
  ds_read_b64_tr_b16 v[116:117], v2 offset:34816
  ds_read_b64_tr_b16 v[118:119], v2 offset:39424
  v_mfma_f32_16x16x32_bf16 v[8:11], v[80:83], v[152:155], v[8:11]
  v_mfma_f32_16x16x32_bf16 v[44:47], v[80:83], v[156:159], v[44:47]
  ds_read_b64_tr_b16 v[120:121], v2 offset:34848
  ds_read_b64_tr_b16 v[122:123], v2 offset:39456
  v_mfma_f32_16x16x32_bf16 v[12:15], v[84:87], v[152:155], v[12:15]
  v_mfma_f32_16x16x32_bf16 v[48:51], v[84:87], v[156:159], v[48:51]
  ds_read_b64_tr_b16 v[124:125], v2 offset:34880
  ds_read_b64_tr_b16 v[126:127], v2 offset:39488
  v_mfma_f32_16x16x32_bf16 v[16:19], v[88:91], v[152:155], v[16:19]
  v_mfma_f32_16x16x32_bf16 v[52:55], v[88:91], v[156:159], v[52:55]
  ds_read_b64_tr_b16 v[128:129], v2 offset:34912
  ds_read_b64_tr_b16 v[130:131], v2 offset:39520
  v_mfma_f32_16x16x32_bf16 v[20:23], v[92:95], v[152:155], v[20:23]
  v_mfma_f32_16x16x32_bf16 v[56:59], v[92:95], v[156:159], v[56:59]
  ds_read_b64_tr_b16 v[132:133], v2 offset:34944
  ds_read_b64_tr_b16 v[134:135], v2 offset:39552
  v_mfma_f32_16x16x32_bf16 v[24:27], v[96:99], v[152:155], v[24:27]
  v_mfma_f32_16x16x32_bf16 v[60:63], v[96:99], v[156:159], v[60:63]
  ds_read_b64_tr_b16 v[136:137], v2 offset:34976
  ds_read_b64_tr_b16 v[138:139], v2 offset:39584
  v_mfma_f32_16x16x32_bf16 v[28:31], v[100:103], v[152:155], v[28:31]
  v_mfma_f32_16x16x32_bf16 v[64:67], v[100:103], v[156:159], v[64:67]
  ds_read_b64_tr_b16 v[140:141], v2 offset:35008
  ds_read_b64_tr_b16 v[142:143], v2 offset:39616
  v_mfma_f32_16x16x32_bf16 v[32:35], v[104:107], v[152:155], v[32:35]
  v_mfma_f32_16x16x32_bf16 v[68:71], v[104:107], v[156:159], v[68:71]
  ds_read_b64_tr_b16 v[144:145], v2 offset:35040
  ds_read_b64_tr_b16 v[146:147], v2 offset:39648
  v_mfma_f32_16x16x32_bf16 v[36:39], v[108:111], v[152:155], v[36:39]
  v_mfma_f32_16x16x32_bf16 v[72:75], v[108:111], v[156:159], v[72:75]
  ds_read_b64_tr_b16 v[148:149], v2 offset:35072
  ds_read_b64_tr_b16 v[150:151], v2 offset:39680
  v_mfma_f32_16x16x32_bf16 v[40:43], v[112:115], v[152:155], v[40:43]
  v_mfma_f32_16x16x32_bf16 v[76:79], v[112:115], v[156:159], v[76:79]
  s_waitcnt lgkmcnt(0)
  s_barrier
  ds_read_b128 v[152:155], v5 offset:0
  ds_read_b128 v[156:159], v5 offset:1024
  s_nop 0
  s_nop 0
  ds_read_b64_tr_b16 v[80:81], v1 offset:0
  ds_read_b64_tr_b16 v[82:83], v1 offset:4608
  v_mfma_f32_16x16x32_bf16 v[8:11], v[116:119], v[160:163], v[8:11]
  v_mfma_f32_16x16x32_bf16 v[44:47], v[116:119], v[164:167], v[44:47]
  ds_read_b64_tr_b16 v[84:85], v1 offset:32
  ds_read_b64_tr_b16 v[86:87], v1 offset:4640
  v_mfma_f32_16x16x32_bf16 v[12:15], v[120:123], v[160:163], v[12:15]
  v_mfma_f32_16x16x32_bf16 v[48:51], v[120:123], v[164:167], v[48:51]
  ds_read_b64_tr_b16 v[88:89], v1 offset:64
  ds_read_b64_tr_b16 v[90:91], v1 offset:4672
  v_mfma_f32_16x16x32_bf16 v[16:19], v[124:127], v[160:163], v[16:19]
  v_mfma_f32_16x16x32_bf16 v[52:55], v[124:127], v[164:167], v[52:55]
  ds_read_b64_tr_b16 v[92:93], v1 offset:96
  ds_read_b64_tr_b16 v[94:95], v1 offset:4704
  v_mfma_f32_16x16x32_bf16 v[20:23], v[128:131], v[160:163], v[20:23]
  v_mfma_f32_16x16x32_bf16 v[56:59], v[128:131], v[164:167], v[56:59]
  ds_read_b64_tr_b16 v[96:97], v1 offset:128
  ds_read_b64_tr_b16 v[98:99], v1 offset:4736
  v_mfma_f32_16x16x32_bf16 v[24:27], v[132:135], v[160:163], v[24:27]
  v_mfma_f32_16x16x32_bf16 v[60:63], v[132:135], v[164:167], v[60:63]
  ds_read_b64_tr_b16 v[100:101], v1 offset:160
  ds_read_b64_tr_b16 v[102:103], v1 offset:4768
  v_mfma_f32_16x16x32_bf16 v[28:31], v[136:139], v[160:163], v[28:31]
  v_mfma_f32_16x16x32_bf16 v[64:67], v[136:139], v[164:167], v[64:67]
  ds_read_b64_tr_b16 v[104:105], v1 offset:192
  ds_read_b64_tr_b16 v[106:107], v1 offset:4800
  v_mfma_f32_16x16x32_bf16 v[32:35], v[140:143], v[160:163], v[32:35]
  v_mfma_f32_16x16x32_bf16 v[68:71], v[140:143], v[164:167], v[68:71]
  ds_read_b64_tr_b16 v[108:109], v1 offset:224
  ds_read_b64_tr_b16 v[110:111], v1 offset:4832
  v_mfma_f32_16x16x32_bf16 v[36:39], v[144:147], v[160:163], v[36:39]
  v_mfma_f32_16x16x32_bf16 v[72:75], v[144:147], v[164:167], v[72:75]
  ds_read_b64_tr_b16 v[112:113], v1 offset:256
  ds_read_b64_tr_b16 v[114:115], v1 offset:4864
  v_mfma_f32_16x16x32_bf16 v[40:43], v[148:151], v[160:163], v[40:43]
  v_mfma_f32_16x16x32_bf16 v[76:79], v[148:151], v[164:167], v[76:79]
  s_waitcnt lgkmcnt(0)
  s_barrier
  ds_read_b64 v[160:161], v3 offset:34816
  ds_read_b64 v[162:163], v3 offset:36864
  ds_read_b64 v[164:165], v3 offset:34824
  ds_read_b64 v[166:167], v3 offset:36872
  ds_read_b64_tr_b16 v[116:117], v1 offset:34816
  ds_read_b64_tr_b16 v[118:119], v1 offset:39424
  v_mfma_f32_16x16x32_bf16 v[8:11], v[80:83], v[152:155], v[8:11]
  v_mfma_f32_16x16x32_bf16 v[44:47], v[80:83], v[156:159], v[44:47]
  ds_read_b64_tr_b16 v[120:121], v1 offset:34848
  ds_read_b64_tr_b16 v[122:123], v1 offset:39456
  v_mfma_f32_16x16x32_bf16 v[12:15], v[84:87], v[152:155], v[12:15]
  v_mfma_f32_16x16x32_bf16 v[48:51], v[84:87], v[156:159], v[48:51]
  ds_read_b64_tr_b16 v[124:125], v1 offset:34880
  ds_read_b64_tr_b16 v[126:127], v1 offset:39488
  v_mfma_f32_16x16x32_bf16 v[16:19], v[88:91], v[152:155], v[16:19]
  v_mfma_f32_16x16x32_bf16 v[52:55], v[88:91], v[156:159], v[52:55]
  ds_read_b64_tr_b16 v[128:129], v1 offset:34912
  ds_read_b64_tr_b16 v[130:131], v1 offset:39520
  v_mfma_f32_16x16x32_bf16 v[20:23], v[92:95], v[152:155], v[20:23]
  v_mfma_f32_16x16x32_bf16 v[56:59], v[92:95], v[156:159], v[56:59]
  ds_read_b64_tr_b16 v[132:133], v1 offset:34944
  ds_read_b64_tr_b16 v[134:135], v1 offset:39552
  v_mfma_f32_16x16x32_bf16 v[24:27], v[96:99], v[152:155], v[24:27]
  v_mfma_f32_16x16x32_bf16 v[60:63], v[96:99], v[156:159], v[60:63]
  ds_read_b64_tr_b16 v[136:137], v1 offset:34976
  ds_read_b64_tr_b16 v[138:139], v1 offset:39584
  v_mfma_f32_16x16x32_bf16 v[28:31], v[100:103], v[152:155], v[28:31]
  v_mfma_f32_16x16x32_bf16 v[64:67], v[100:103], v[156:159], v[64:67]
  ds_read_b64_tr_b16 v[140:141], v1 offset:35008
  ds_read_b64_tr_b16 v[142:143], v1 offset:39616
  v_mfma_f32_16x16x32_bf16 v[32:35], v[104:107], v[152:155], v[32:35]
  v_mfma_f32_16x16x32_bf16 v[68:71], v[104:107], v[156:159], v[68:71]
  ds_read_b64_tr_b16 v[144:145], v1 offset:35040
  ds_read_b64_tr_b16 v[146:147], v1 offset:39648
  v_mfma_f32_16x16x32_bf16 v[36:39], v[108:111], v[152:155], v[36:39]
  v_mfma_f32_16x16x32_bf16 v[72:75], v[108:111], v[156:159], v[72:75]
  ds_read_b64_tr_b16 v[148:149], v1 offset:35072
  ds_read_b64_tr_b16 v[150:151], v1 offset:39680
  v_mfma_f32_16x16x32_bf16 v[40:43], v[112:115], v[152:155], v[40:43]
  v_mfma_f32_16x16x32_bf16 v[76:79], v[112:115], v[156:159], v[76:79]
  s_waitcnt lgkmcnt(0)
  v_mfma_f32_16x16x32_bf16 v[8:11], v[116:119], v[160:163], v[8:11]
  v_mfma_f32_16x16x32_bf16 v[44:47], v[116:119], v[164:167], v[44:47]
  v_mfma_f32_16x16x32_bf16 v[12:15], v[120:123], v[160:163], v[12:15]
  v_mfma_f32_16x16x32_bf16 v[48:51], v[120:123], v[164:167], v[48:51]
  v_mfma_f32_16x16x32_bf16 v[16:19], v[124:127], v[160:163], v[16:19]
  v_mfma_f32_16x16x32_bf16 v[52:55], v[124:127], v[164:167], v[52:55]
  v_mfma_f32_16x16x32_bf16 v[20:23], v[128:131], v[160:163], v[20:23]
  v_mfma_f32_16x16x32_bf16 v[56:59], v[128:131], v[164:167], v[56:59]
  v_mfma_f32_16x16x32_bf16 v[24:27], v[132:135], v[160:163], v[24:27]
  v_mfma_f32_16x16x32_bf16 v[60:63], v[132:135], v[164:167], v[60:63]
  v_mfma_f32_16x16x32_bf16 v[28:31], v[136:139], v[160:163], v[28:31]
  v_mfma_f32_16x16x32_bf16 v[64:67], v[136:139], v[164:167], v[64:67]
  v_mfma_f32_16x16x32_bf16 v[32:35], v[140:143], v[160:163], v[32:35]
  v_mfma_f32_16x16x32_bf16 v[68:71], v[140:143], v[164:167], v[68:71]
  v_mfma_f32_16x16x32_bf16 v[36:39], v[144:147], v[160:163], v[36:39]
  v_mfma_f32_16x16x32_bf16 v[72:75], v[144:147], v[164:167], v[72:75]
  v_mfma_f32_16x16x32_bf16 v[40:43], v[148:151], v[160:163], v[40:43]
  v_mfma_f32_16x16x32_bf16 v[76:79], v[148:151], v[164:167], v[76:79]
  s_waitcnt lgkmcnt(0)
  v_lshlrev_b32 v1, 4, v0
  s_mul_i32 s34, s3, 9216
  s_add_u32 s34, s34, 69632
  v_add_u32 v2, s34, v1
  s_xor_b32 s36, s3, 4
  s_mul_i32 s36, s36, 9216
  s_add_u32 s36, s36, 69632
  v_add_u32 v3, s36, v1
  s_nop 7
  s_cmp_eq_u32 s15, 0
  s_cbranch_scc0 k4_ra17
  ds_write_b128 v2, v[44:47] offset:0
  ds_write_b128 v2, v[48:51] offset:1024
  ds_write_b128 v2, v[52:55] offset:2048
  ds_write_b128 v2, v[56:59] offset:3072
  ds_write_b128 v2, v[60:63] offset:4096
  ds_write_b128 v2, v[64:67] offset:5120
  ds_write_b128 v2, v[68:71] offset:6144
  ds_write_b128 v2, v[72:75] offset:7168
  ds_write_b128 v2, v[76:79] offset:8192
  s_branch k4_rb18
k4_ra17:
  ds_write_b128 v2, v[8:11] offset:0
  ds_write_b128 v2, v[12:15] offset:1024
  ds_write_b128 v2, v[16:19] offset:2048
  ds_write_b128 v2, v[20:23] offset:3072
  ds_write_b128 v2, v[24:27] offset:4096
  ds_write_b128 v2, v[28:31] offset:5120
  ds_write_b128 v2, v[32:35] offset:6144
  ds_write_b128 v2, v[36:39] offset:7168
  ds_write_b128 v2, v[40:43] offset:8192
  s_nop 1
  v_mov_b32 v8, v44
  v_mov_b32 v9, v45
  v_mov_b32 v10, v46
  v_mov_b32 v11, v47
  v_mov_b32 v12, v48
  v_mov_b32 v13, v49
  v_mov_b32 v14, v50
  v_mov_b32 v15, v51
  v_mov_b32 v16, v52
  v_mov_b32 v17, v53
  v_mov_b32 v18, v54
  v_mov_b32 v19, v55
  v_mov_b32 v20, v56
  v_mov_b32 v21, v57
  v_mov_b32 v22, v58
  v_mov_b32 v23, v59
  v_mov_b32 v24, v60
  v_mov_b32 v25, v61
  v_mov_b32 v26, v62
  v_mov_b32 v27, v63
  v_mov_b32 v28, v64
  v_mov_b32 v29, v65
  v_mov_b32 v30, v66
  v_mov_b32 v31, v67
  v_mov_b32 v32, v68
  v_mov_b32 v33, v69
  v_mov_b32 v34, v70
  v_mov_b32 v35, v71
  v_mov_b32 v36, v72
  v_mov_b32 v37, v73
  v_mov_b32 v38, v74
  v_mov_b32 v39, v75
  v_mov_b32 v40, v76
  v_mov_b32 v41, v77
  v_mov_b32 v42, v78
  v_mov_b32 v43, v79
k4_rb18:
  s_waitcnt lgkmcnt(0)
  s_barrier
  ds_read_b128 v[80:83], v3 offset:0
  ds_read_b128 v[84:87], v3 offset:1024
  ds_read_b128 v[88:91], v3 offset:2048
  ds_read_b128 v[92:95], v3 offset:3072
  ds_read_b128 v[96:99], v3 offset:4096
  ds_read_b128 v[100:103], v3 offset:5120
  ds_read_b128 v[104:107], v3 offset:6144
  ds_read_b128 v[108:111], v3 offset:7168
  ds_read_b128 v[112:115], v3 offset:8192
  s_add_u32 s24, s10, 0x1800000
  s_addc_u32 s25, s11, 0
  s_mov_b32 s26, 0x900000
  s_mov_b32 s27, 0x00020000
  s_lshl_b32 s30, s14, 2
  s_add_u32 s30, s30, s13
  s_lshl_b32 s31, s28, 1
  s_add_u32 s31, s31, s15
  s_lshl_b32 s34, s30, 5
  s_add_u32 s34, s34, s31
  s_mul_i32 s44, s34, 4608
  s_mul_i32 s35, s12, 36864
  s_add_u32 s35, s35, s44
  v_lshlrev_b32 v4, 3, v0
  s_waitcnt lgkmcnt(8)
  v_add_f32 v8, v8, v80
  v_add_f32 v9, v9, v81
  v_add_f32 v10, v10, v82
  v_add_f32 v11, v11, v83
  s_waitcnt lgkmcnt(7)
  v_add_f32 v12, v12, v84
  v_add_f32 v13, v13, v85
  v_add_f32 v14, v14, v86
  v_add_f32 v15, v15, v87
  s_waitcnt lgkmcnt(6)
  v_add_f32 v16, v16, v88
  v_add_f32 v17, v17, v89
  v_add_f32 v18, v18, v90
  v_add_f32 v19, v19, v91
  s_waitcnt lgkmcnt(5)
  v_add_f32 v20, v20, v92
  v_add_f32 v21, v21, v93
  v_add_f32 v22, v22, v94
  v_add_f32 v23, v23, v95
  s_waitcnt lgkmcnt(4)
  v_add_f32 v24, v24, v96
  v_add_f32 v25, v25, v97
  v_add_f32 v26, v26, v98
  v_add_f32 v27, v27, v99
  s_waitcnt lgkmcnt(3)
  v_add_f32 v28, v28, v100
  v_add_f32 v29, v29, v101
  v_add_f32 v30, v30, v102
  v_add_f32 v31, v31, v103
  s_waitcnt lgkmcnt(2)
  v_add_f32 v32, v32, v104
  v_add_f32 v33, v33, v105
  v_add_f32 v34, v34, v106
  v_add_f32 v35, v35, v107
  s_waitcnt lgkmcnt(1)
  v_add_f32 v36, v36, v108
  v_add_f32 v37, v37, v109
  v_add_f32 v38, v38, v110
  v_add_f32 v39, v39, v111
  s_waitcnt lgkmcnt(0)
  v_add_f32 v40, v40, v112
  v_add_f32 v41, v41, v113
  v_add_f32 v42, v42, v114
  v_add_f32 v43, v43, v115
  s_cmp_eq_u32 s28, s12
  s_cbranch_scc1 k4_own19
  v_mov_b32 v5, 0xfffffffe
  v_cvt_pk_bf16_f32 v80, v8, v9
  v_cvt_pk_bf16_f32 v81, v10, v11
  v_min_u32 v80, v5, v80
  v_min_u32 v81, v5, v81
  v_cvt_pk_bf16_f32 v82, v12, v13
  v_cvt_pk_bf16_f32 v83, v14, v15
  v_min_u32 v82, v5, v82
  v_min_u32 v83, v5, v83
  buffer_store_dwordx4 v[80:83], v1, s[24:27], s35 offen offset:0 sc1
  v_cvt_pk_bf16_f32 v84, v16, v17
  v_cvt_pk_bf16_f32 v85, v18, v19
  v_min_u32 v84, v5, v84
  v_min_u32 v85, v5, v85
  v_cvt_pk_bf16_f32 v86, v20, v21
  v_cvt_pk_bf16_f32 v87, v22, v23
  v_min_u32 v86, v5, v86
  v_min_u32 v87, v5, v87
  buffer_store_dwordx4 v[84:87], v1, s[24:27], s35 offen offset:1024 sc1
  v_cvt_pk_bf16_f32 v88, v24, v25
  v_cvt_pk_bf16_f32 v89, v26, v27
  v_min_u32 v88, v5, v88
  v_min_u32 v89, v5, v89
  v_cvt_pk_bf16_f32 v90, v28, v29
  v_cvt_pk_bf16_f32 v91, v30, v31
  v_min_u32 v90, v5, v90
  v_min_u32 v91, v5, v91
  buffer_store_dwordx4 v[88:91], v1, s[24:27], s35 offen offset:2048 sc1
  v_cvt_pk_bf16_f32 v92, v32, v33
  v_cvt_pk_bf16_f32 v93, v34, v35
  v_min_u32 v92, v5, v92
  v_min_u32 v93, v5, v93
  v_cvt_pk_bf16_f32 v94, v36, v37
  v_cvt_pk_bf16_f32 v95, v38, v39
  v_min_u32 v94, v5, v94
  v_min_u32 v95, v5, v95
  buffer_store_dwordx4 v[92:95], v1, s[24:27], s35 offen offset:3072 sc1
  v_cvt_pk_bf16_f32 v96, v40, v41
  v_cvt_pk_bf16_f32 v97, v42, v43
  v_min_u32 v96, v5, v96
  v_min_u32 v97, v5, v97
  s_add_u32 s34, s35, 4096
  buffer_store_dwordx2 v[96:97], v4, s[24:27], s34 offen sc1
  s_branch k4_fin
k4_own19:
  s_add_u32 s48, s10, 0x240000
  s_addc_u32 s49, s11, 0
  s_mov_b32 s50, 0x240000
  s_mov_b32 s51, 0x00020000
  s_mov_b32 s52, s6
  s_mov_b32 s53, s7
  s_mov_b32 s54, 0x240000
  s_mov_b32 s55, 0x00020000
  v_and_b32 v2, 15, v0
  s_lshl_b32 s34, s14, 3
  s_add_u32 s34, s34, s31
  s_lshl_b32 s34, s34, 4
  v_add_u32 v2, s34, v2
  v_mul_u32_u24 v2, 1152, v2
  v_lshrrev_b32 v3, 4, v0
  v_lshl_add_u32 v2, v3, 3, v2
  s_mul_i32 s34, s13, 288
  v_add_u32 v2, s34, v2
  buffer_load_dwordx2 v[44:45], v2, s[48:51], 0 offen offset:0
  buffer_load_dwordx2 v[46:47], v2, s[48:51], 0 offen offset:32
  buffer_load_dwordx2 v[48:49], v2, s[48:51], 0 offen offset:64
  buffer_load_dwordx2 v[50:51], v2, s[48:51], 0 offen offset:96
  buffer_load_dwordx2 v[52:53], v2, s[48:51], 0 offen offset:128
  buffer_load_dwordx2 v[54:55], v2, s[48:51], 0 offen offset:160
  buffer_load_dwordx2 v[56:57], v2, s[48:51], 0 offen offset:192
  buffer_load_dwordx2 v[58:59], v2, s[48:51], 0 offen offset:224
  buffer_load_dwordx2 v[60:61], v2, s[48:51], 0 offen offset:256
  s_add_u32 s34, s12, 1
  s_and_b32 s34, s34, 3
  s_mul_i32 s34, s34, 36864
  s_add_u32 s60, s34, s44
  s_add_u32 s64, s60, 4096
  s_add_u32 s34, s12, 2
  s_and_b32 s34, s34, 3
  s_mul_i32 s34, s34, 36864
  s_add_u32 s61, s34, s44
  s_add_u32 s65, s61, 4096
  s_add_u32 s34, s12, 3
  s_and_b32 s34, s34, 3
  s_mul_i32 s34, s34, 36864
  s_add_u32 s62, s34, s44
  s_add_u32 s66, s62, 4096
  s_mov_b32 s33, 0
k4_poll20:
  s_sleep 38
  buffer_load_dwordx4 v[80:83], v1, s[24:27], s60 offen offset:0 sc1
  buffer_load_dwordx4 v[84:87], v1, s[24:27], s60 offen offset:1024 sc1
  buffer_load_dwordx4 v[88:91], v1, s[24:27], s60 offen offset:2048 sc1
  buffer_load_dwordx4 v[92:95], v1, s[24:27], s60 offen offset:3072 sc1
  buffer_load_dwordx2 v[96:97], v4, s[24:27], s64 offen sc1
  buffer_load_dwordx4 v[100:103], v1, s[24:27], s61 offen offset:0 sc1
  buffer_load_dwordx4 v[104:107], v1, s[24:27], s61 offen offset:1024 sc1
  buffer_load_dwordx4 v[108:111], v1, s[24:27], s61 offen offset:2048 sc1
  buffer_load_dwordx4 v[112:115], v1, s[24:27], s61 offen offset:3072 sc1
  buffer_load_dwordx2 v[116:117], v4, s[24:27], s65 offen sc1
  buffer_load_dwordx4 v[120:123], v1, s[24:27], s62 offen offset:0 sc1
  buffer_load_dwordx4 v[124:127], v1, s[24:27], s62 offen offset:1024 sc1
  buffer_load_dwordx4 v[128:131], v1, s[24:27], s62 offen offset:2048 sc1
  buffer_load_dwordx4 v[132:135], v1, s[24:27], s62 offen offset:3072 sc1
  buffer_load_dwordx2 v[136:137], v4, s[24:27], s66 offen sc1
  s_waitcnt vmcnt(0)
  v_max_u32 v64, v80, v81
  v_max3_u32 v64, v64, v82, v83
  v_max3_u32 v64, v64, v84, v85
  v_max3_u32 v64, v64, v86, v87
  v_max3_u32 v64, v64, v88, v89
  v_max3_u32 v64, v64, v90, v91
  v_max3_u32 v64, v64, v92, v93
  v_max3_u32 v64, v64, v94, v95
  v_max3_u32 v64, v64, v96, v97
  v_max3_u32 v64, v64, v100, v101
  v_max3_u32 v64, v64, v102, v103
  v_max3_u32 v64, v64, v104, v105
  v_max3_u32 v64, v64, v106, v107
  v_max3_u32 v64, v64, v108, v109
  v_max3_u32 v64, v64, v110, v111
  v_max3_u32 v64, v64, v112, v113
  v_max3_u32 v64, v64, v114, v115
  v_max3_u32 v64, v64, v116, v117
  v_max3_u32 v64, v64, v120, v121
  v_max3_u32 v64, v64, v122, v123
  v_max3_u32 v64, v64, v124, v125
  v_max3_u32 v64, v64, v126, v127
  v_max3_u32 v64, v64, v128, v129
  v_max3_u32 v64, v64, v130, v131
  v_max3_u32 v64, v64, v132, v133
  v_max3_u32 v64, v64, v134, v135
  v_max3_u32 v64, v64, v136, v137
  v_cmp_eq_u32 vcc, -1, v64
  s_cbranch_vccz k4_done21
  s_add_u32 s33, s33, 1
  s_cmp_lt_u32 s33, 0x8000
  s_cbranch_scc1 k4_poll20
k4_done21:
  v_lshlrev_b32 v64, 16, v80
  v_and_b32 v65, 0xffff0000, v80
  v_add_f32 v8, v8, v64
  v_add_f32 v9, v9, v65
  v_lshlrev_b32 v64, 16, v81
  v_and_b32 v65, 0xffff0000, v81
  v_add_f32 v10, v10, v64
  v_add_f32 v11, v11, v65
  v_lshlrev_b32 v64, 16, v82
  v_and_b32 v65, 0xffff0000, v82
  v_add_f32 v12, v12, v64
  v_add_f32 v13, v13, v65
  v_lshlrev_b32 v64, 16, v83
  v_and_b32 v65, 0xffff0000, v83
  v_add_f32 v14, v14, v64
  v_add_f32 v15, v15, v65
  v_lshlrev_b32 v64, 16, v84
  v_and_b32 v65, 0xffff0000, v84
  v_add_f32 v16, v16, v64
  v_add_f32 v17, v17, v65
  v_lshlrev_b32 v64, 16, v85
  v_and_b32 v65, 0xffff0000, v85
  v_add_f32 v18, v18, v64
  v_add_f32 v19, v19, v65
  v_lshlrev_b32 v64, 16, v86
  v_and_b32 v65, 0xffff0000, v86
  v_add_f32 v20, v20, v64
  v_add_f32 v21, v21, v65
  v_lshlrev_b32 v64, 16, v87
  v_and_b32 v65, 0xffff0000, v87
  v_add_f32 v22, v22, v64
  v_add_f32 v23, v23, v65
  v_lshlrev_b32 v64, 16, v88
  v_and_b32 v65, 0xffff0000, v88
  v_add_f32 v24, v24, v64
  v_add_f32 v25, v25, v65
  v_lshlrev_b32 v64, 16, v89
  v_and_b32 v65, 0xffff0000, v89
  v_add_f32 v26, v26, v64
  v_add_f32 v27, v27, v65
  v_lshlrev_b32 v64, 16, v90
  v_and_b32 v65, 0xffff0000, v90
  v_add_f32 v28, v28, v64
  v_add_f32 v29, v29, v65
  v_lshlrev_b32 v64, 16, v91
  v_and_b32 v65, 0xffff0000, v91
  v_add_f32 v30, v30, v64
  v_add_f32 v31, v31, v65
  v_lshlrev_b32 v64, 16, v92
  v_and_b32 v65, 0xffff0000, v92
  v_add_f32 v32, v32, v64
  v_add_f32 v33, v33, v65
  v_lshlrev_b32 v64, 16, v93
  v_and_b32 v65, 0xffff0000, v93
  v_add_f32 v34, v34, v64
  v_add_f32 v35, v35, v65
  v_lshlrev_b32 v64, 16, v94
  v_and_b32 v65, 0xffff0000, v94
  v_add_f32 v36, v36, v64
  v_add_f32 v37, v37, v65
  v_lshlrev_b32 v64, 16, v95
  v_and_b32 v65, 0xffff0000, v95
  v_add_f32 v38, v38, v64
  v_add_f32 v39, v39, v65
  v_lshlrev_b32 v64, 16, v96
  v_and_b32 v65, 0xffff0000, v96
  v_add_f32 v40, v40, v64
  v_add_f32 v41, v41, v65
  v_lshlrev_b32 v64, 16, v97
  v_and_b32 v65, 0xffff0000, v97
  v_add_f32 v42, v42, v64
  v_add_f32 v43, v43, v65
  v_lshlrev_b32 v64, 16, v100
  v_and_b32 v65, 0xffff0000, v100
  v_add_f32 v8, v8, v64
  v_add_f32 v9, v9, v65
  v_lshlrev_b32 v64, 16, v101
  v_and_b32 v65, 0xffff0000, v101
  v_add_f32 v10, v10, v64
  v_add_f32 v11, v11, v65
  v_lshlrev_b32 v64, 16, v102
  v_and_b32 v65, 0xffff0000, v102
  v_add_f32 v12, v12, v64
  v_add_f32 v13, v13, v65
  v_lshlrev_b32 v64, 16, v103
  v_and_b32 v65, 0xffff0000, v103
  v_add_f32 v14, v14, v64
  v_add_f32 v15, v15, v65
  v_lshlrev_b32 v64, 16, v104
  v_and_b32 v65, 0xffff0000, v104
  v_add_f32 v16, v16, v64
  v_add_f32 v17, v17, v65
  v_lshlrev_b32 v64, 16, v105
  v_and_b32 v65, 0xffff0000, v105
  v_add_f32 v18, v18, v64
  v_add_f32 v19, v19, v65
  v_lshlrev_b32 v64, 16, v106
  v_and_b32 v65, 0xffff0000, v106
  v_add_f32 v20, v20, v64
  v_add_f32 v21, v21, v65
  v_lshlrev_b32 v64, 16, v107
  v_and_b32 v65, 0xffff0000, v107
  v_add_f32 v22, v22, v64
  v_add_f32 v23, v23, v65
  v_lshlrev_b32 v64, 16, v108
  v_and_b32 v65, 0xffff0000, v108
  v_add_f32 v24, v24, v64
  v_add_f32 v25, v25, v65
  v_lshlrev_b32 v64, 16, v109
  v_and_b32 v65, 0xffff0000, v109
  v_add_f32 v26, v26, v64
  v_add_f32 v27, v27, v65
  v_lshlrev_b32 v64, 16, v110
  v_and_b32 v65, 0xffff0000, v110
  v_add_f32 v28, v28, v64
  v_add_f32 v29, v29, v65
  v_lshlrev_b32 v64, 16, v111
  v_and_b32 v65, 0xffff0000, v111
  v_add_f32 v30, v30, v64
  v_add_f32 v31, v31, v65
  v_lshlrev_b32 v64, 16, v112
  v_and_b32 v65, 0xffff0000, v112
  v_add_f32 v32, v32, v64
  v_add_f32 v33, v33, v65
  v_lshlrev_b32 v64, 16, v113
  v_and_b32 v65, 0xffff0000, v113
  v_add_f32 v34, v34, v64
  v_add_f32 v35, v35, v65
  v_lshlrev_b32 v64, 16, v114
  v_and_b32 v65, 0xffff0000, v114
  v_add_f32 v36, v36, v64
  v_add_f32 v37, v37, v65
  v_lshlrev_b32 v64, 16, v115
  v_and_b32 v65, 0xffff0000, v115
  v_add_f32 v38, v38, v64
  v_add_f32 v39, v39, v65
  v_lshlrev_b32 v64, 16, v116
  v_and_b32 v65, 0xffff0000, v116
  v_add_f32 v40, v40, v64
  v_add_f32 v41, v41, v65
  v_lshlrev_b32 v64, 16, v117
  v_and_b32 v65, 0xffff0000, v117
  v_add_f32 v42, v42, v64
  v_add_f32 v43, v43, v65
  v_lshlrev_b32 v64, 16, v120
  v_and_b32 v65, 0xffff0000, v120
  v_add_f32 v8, v8, v64
  v_add_f32 v9, v9, v65
  v_lshlrev_b32 v64, 16, v121
  v_and_b32 v65, 0xffff0000, v121
  v_add_f32 v10, v10, v64
  v_add_f32 v11, v11, v65
  v_lshlrev_b32 v64, 16, v122
  v_and_b32 v65, 0xffff0000, v122
  v_add_f32 v12, v12, v64
  v_add_f32 v13, v13, v65
  v_lshlrev_b32 v64, 16, v123
  v_and_b32 v65, 0xffff0000, v123
  v_add_f32 v14, v14, v64
  v_add_f32 v15, v15, v65
  v_lshlrev_b32 v64, 16, v124
  v_and_b32 v65, 0xffff0000, v124
  v_add_f32 v16, v16, v64
  v_add_f32 v17, v17, v65
  v_lshlrev_b32 v64, 16, v125
  v_and_b32 v65, 0xffff0000, v125
  v_add_f32 v18, v18, v64
  v_add_f32 v19, v19, v65
  v_lshlrev_b32 v64, 16, v126
  v_and_b32 v65, 0xffff0000, v126
  v_add_f32 v20, v20, v64
  v_add_f32 v21, v21, v65
  v_lshlrev_b32 v64, 16, v127
  v_and_b32 v65, 0xffff0000, v127
  v_add_f32 v22, v22, v64
  v_add_f32 v23, v23, v65
  v_lshlrev_b32 v64, 16, v128
  v_and_b32 v65, 0xffff0000, v128
  v_add_f32 v24, v24, v64
  v_add_f32 v25, v25, v65
  v_lshlrev_b32 v64, 16, v129
  v_and_b32 v65, 0xffff0000, v129
  v_add_f32 v26, v26, v64
  v_add_f32 v27, v27, v65
  v_lshlrev_b32 v64, 16, v130
  v_and_b32 v65, 0xffff0000, v130
  v_add_f32 v28, v28, v64
  v_add_f32 v29, v29, v65
  v_lshlrev_b32 v64, 16, v131
  v_and_b32 v65, 0xffff0000, v131
  v_add_f32 v30, v30, v64
  v_add_f32 v31, v31, v65
  v_lshlrev_b32 v64, 16, v132
  v_and_b32 v65, 0xffff0000, v132
  v_add_f32 v32, v32, v64
  v_add_f32 v33, v33, v65
  v_lshlrev_b32 v64, 16, v133
  v_and_b32 v65, 0xffff0000, v133
  v_add_f32 v34, v34, v64
  v_add_f32 v35, v35, v65
  v_lshlrev_b32 v64, 16, v134
  v_and_b32 v65, 0xffff0000, v134
  v_add_f32 v36, v36, v64
  v_add_f32 v37, v37, v65
  v_lshlrev_b32 v64, 16, v135
  v_and_b32 v65, 0xffff0000, v135
  v_add_f32 v38, v38, v64
  v_add_f32 v39, v39, v65
  v_lshlrev_b32 v64, 16, v136
  v_and_b32 v65, 0xffff0000, v136
  v_add_f32 v40, v40, v64
  v_add_f32 v41, v41, v65
  v_lshlrev_b32 v64, 16, v137
  v_and_b32 v65, 0xffff0000, v137
  v_add_f32 v42, v42, v64
  v_add_f32 v43, v43, v65
  v_lshlrev_b32 v64, 16, v44
  v_and_b32 v65, 0xffff0000, v44
  v_lshlrev_b32 v66, 16, v45
  v_and_b32 v67, 0xffff0000, v45
  v_add_f32 v8, v8, v64
  v_add_f32 v9, v9, v65
  v_add_f32 v10, v10, v66
  v_add_f32 v11, v11, v67
  v_cvt_pk_bf16_f32 v44, v8, v9
  v_cvt_pk_bf16_f32 v45, v10, v11
  buffer_store_dwordx2 v[44:45], v2, s[52:55], 0 offen offset:0
  v_lshlrev_b32 v64, 16, v46
  v_and_b32 v65, 0xffff0000, v46
  v_lshlrev_b32 v66, 16, v47
  v_and_b32 v67, 0xffff0000, v47
  v_add_f32 v12, v12, v64
  v_add_f32 v13, v13, v65
  v_add_f32 v14, v14, v66
  v_add_f32 v15, v15, v67
  v_cvt_pk_bf16_f32 v46, v12, v13
  v_cvt_pk_bf16_f32 v47, v14, v15
  buffer_store_dwordx2 v[46:47], v2, s[52:55], 0 offen offset:32
  v_lshlrev_b32 v64, 16, v48
  v_and_b32 v65, 0xffff0000, v48
  v_lshlrev_b32 v66, 16, v49
  v_and_b32 v67, 0xffff0000, v49
  v_add_f32 v16, v16, v64
  v_add_f32 v17, v17, v65
  v_add_f32 v18, v18, v66
  v_add_f32 v19, v19, v67
  v_cvt_pk_bf16_f32 v48, v16, v17
  v_cvt_pk_bf16_f32 v49, v18, v19
  buffer_store_dwordx2 v[48:49], v2, s[52:55], 0 offen offset:64
  v_lshlrev_b32 v64, 16, v50
  v_and_b32 v65, 0xffff0000, v50
  v_lshlrev_b32 v66, 16, v51
  v_and_b32 v67, 0xffff0000, v51
  v_add_f32 v20, v20, v64
  v_add_f32 v21, v21, v65
  v_add_f32 v22, v22, v66
  v_add_f32 v23, v23, v67
  v_cvt_pk_bf16_f32 v50, v20, v21
  v_cvt_pk_bf16_f32 v51, v22, v23
  buffer_store_dwordx2 v[50:51], v2, s[52:55], 0 offen offset:96
  v_lshlrev_b32 v64, 16, v52
  v_and_b32 v65, 0xffff0000, v52
  v_lshlrev_b32 v66, 16, v53
  v_and_b32 v67, 0xffff0000, v53
  v_add_f32 v24, v24, v64
  v_add_f32 v25, v25, v65
  v_add_f32 v26, v26, v66
  v_add_f32 v27, v27, v67
  v_cvt_pk_bf16_f32 v52, v24, v25
  v_cvt_pk_bf16_f32 v53, v26, v27
  buffer_store_dwordx2 v[52:53], v2, s[52:55], 0 offen offset:128
  v_lshlrev_b32 v64, 16, v54
  v_and_b32 v65, 0xffff0000, v54
  v_lshlrev_b32 v66, 16, v55
  v_and_b32 v67, 0xffff0000, v55
  v_add_f32 v28, v28, v64
  v_add_f32 v29, v29, v65
  v_add_f32 v30, v30, v66
  v_add_f32 v31, v31, v67
  v_cvt_pk_bf16_f32 v54, v28, v29
  v_cvt_pk_bf16_f32 v55, v30, v31
  buffer_store_dwordx2 v[54:55], v2, s[52:55], 0 offen offset:160
  v_lshlrev_b32 v64, 16, v56
  v_and_b32 v65, 0xffff0000, v56
  v_lshlrev_b32 v66, 16, v57
  v_and_b32 v67, 0xffff0000, v57
  v_add_f32 v32, v32, v64
  v_add_f32 v33, v33, v65
  v_add_f32 v34, v34, v66
  v_add_f32 v35, v35, v67
  v_cvt_pk_bf16_f32 v56, v32, v33
  v_cvt_pk_bf16_f32 v57, v34, v35
  buffer_store_dwordx2 v[56:57], v2, s[52:55], 0 offen offset:192
  v_lshlrev_b32 v64, 16, v58
  v_and_b32 v65, 0xffff0000, v58
  v_lshlrev_b32 v66, 16, v59
  v_and_b32 v67, 0xffff0000, v59
  v_add_f32 v36, v36, v64
  v_add_f32 v37, v37, v65
  v_add_f32 v38, v38, v66
  v_add_f32 v39, v39, v67
  v_cvt_pk_bf16_f32 v58, v36, v37
  v_cvt_pk_bf16_f32 v59, v38, v39
  buffer_store_dwordx2 v[58:59], v2, s[52:55], 0 offen offset:224
  v_lshlrev_b32 v64, 16, v60
  v_and_b32 v65, 0xffff0000, v60
  v_lshlrev_b32 v66, 16, v61
  v_and_b32 v67, 0xffff0000, v61
  v_add_f32 v40, v40, v64
  v_add_f32 v41, v41, v65
  v_add_f32 v42, v42, v66
  v_add_f32 v43, v43, v67
  v_cvt_pk_bf16_f32 v60, v40, v41
  v_cvt_pk_bf16_f32 v61, v42, v43
  buffer_store_dwordx2 v[60:61], v2, s[52:55], 0 offen offset:256
k4_fin:
k4_end:
  s_endpgm
.section .rodata,"a"
.p2align 6
.amdhsa_kernel k1_kernel
  .amdhsa_next_free_vgpr 192
  .amdhsa_next_free_sgpr 102
  .amdhsa_accum_offset 192
  .amdhsa_group_segment_fixed_size 0
  .amdhsa_kernarg_size 80
  .amdhsa_user_sgpr_count 2
  .amdhsa_user_sgpr_kernarg_segment_ptr 1
  .amdhsa_system_sgpr_workgroup_id_x 1
.end_amdhsa_kernel
.p2align 6
.amdhsa_kernel k2_kernel
  .amdhsa_next_free_vgpr 464
  .amdhsa_next_free_sgpr 102
  .amdhsa_accum_offset 256
  .amdhsa_group_segment_fixed_size 0
  .amdhsa_kernarg_size 80
  .amdhsa_user_sgpr_count 2
  .amdhsa_user_sgpr_kernarg_segment_ptr 1
  .amdhsa_system_sgpr_workgroup_id_x 1
.end_amdhsa_kernel
.p2align 6
.amdhsa_kernel k3_kernel
  .amdhsa_next_free_vgpr 168
  .amdhsa_next_free_sgpr 102
  .amdhsa_accum_offset 168
  .amdhsa_group_segment_fixed_size 0
  .amdhsa_kernarg_size 80
  .amdhsa_user_sgpr_count 2
  .amdhsa_user_sgpr_kernarg_segment_ptr 1
  .amdhsa_system_sgpr_workgroup_id_x 1
.end_amdhsa_kernel
.p2align 6
.amdhsa_kernel k4_kernel
  .amdhsa_next_free_vgpr 168
  .amdhsa_next_free_sgpr 102
  .amdhsa_accum_offset 168
  .amdhsa_group_segment_fixed_size 0
  .amdhsa_kernarg_size 80
  .amdhsa_user_sgpr_count 2
  .amdhsa_user_sgpr_kernarg_segment_ptr 1
  .amdhsa_system_sgpr_workgroup_id_x 1
.end_amdhsa_kernel
```
